```python
import torch

def _softmax(x, axis=-1):
    return torch.softmax(x, dim=axis)

def _gelu(x):
    return torch.nn.functional.gelu(x, approximate='tanh')

def _silu(x):
    return torch.nn.functional.silu(x)

def _sigmoid(x):
    return torch.sigmoid(x)

def _layernorm(x, axis=-1, eps=1e-05):
    m = x.mean(dim=axis, keepdim=True)
    v = x.var(dim=axis, keepdim=True, unbiased=False)
    return (x - m) / torch.sqrt(v + eps)

def _scatter_add(tgt, idx, src, axis=0):
    return tgt.clone().index_add_(axis, idx, src)

def _segment_sum(src, seg, n):
    out = torch.zeros((n,) + src.shape[1:], dtype=src.dtype)
    return out.index_add_(0, seg, src)

def _pad(x, pw):
    flat = tuple((v for pair in reversed(pw) for v in pair))
    return torch.nn.functional.pad(x, flat)
kernel_name = 'adaLN_cond__memory_aug_recurrent_mem_tr__glu_gated_swiglu__prompt'

def setup_inputs():

    _w = lambda a: (lambda t: t.to(torch.bfloat16) if t.is_floating_point() else t)(torch.as_tensor(a))

    def _A_setup():
        B, S, Dm = (1, 2048, 640)
        H, Dh = (32, 128)
        M, seg = (8, 32)
        seg = min(seg, S)
        S = S // seg * seg
        return {'x': _w((lambda *s: torch.randn(*s, dtype=torch.bfloat16) * 0.05)(B, S, Dm)), 'mem0': _w((lambda *s: torch.randn(*s, dtype=torch.bfloat16) * 0.8)(B, M, Dm)), 'Wq': _w((lambda *s: torch.randn(*s, dtype=torch.bfloat16) * 0.8)(Dm, H, Dh) * Dm ** (-0.5)), 'Wk': _w((lambda *s: torch.randn(*s, dtype=torch.bfloat16) * 0.8)(Dm, H, Dh) * Dm ** (-0.5)), 'Wv': _w((lambda *s: torch.randn(*s, dtype=torch.bfloat16) * 0.8)(Dm, H, Dh) * Dm ** (-0.5)), 'Wo': _w((lambda *s: torch.randn(*s, dtype=torch.bfloat16) * 0.8)(H, Dh, Dm) * (H * Dh) ** (-0.5)), 'seg_len': seg}
    _A_in = _A_setup()

    def _B_setup():
        B, S, D, F = (1, 2048, 640, 1728)
        return {'x': _w((lambda *s: torch.randn(*s, dtype=torch.bfloat16) * 0.05)(B, S, D)), 'w1': _w((lambda *s: torch.randn(*s, dtype=torch.bfloat16) * 0.4)(D, F) * (2.0 / D) ** 0.5), 'w3': _w((lambda *s: torch.randn(*s, dtype=torch.bfloat16) * 0.4)(D, F) * (2.0 / D) ** 0.5), 'w2': _w((lambda *s: torch.randn(*s, dtype=torch.bfloat16) * 0.4)(F, D) * (2.0 / F) ** 0.5)}
    _B_in = _B_setup()
    return {'A_x': _A_in['x'], 'A_mem0': _A_in['mem0'], 'A_Wq': _A_in['Wq'], 'A_Wk': _A_in['Wk'], 'A_Wv': _A_in['Wv'], 'A_Wo': _A_in['Wo'], 'A_seg_len': _A_in['seg_len'], 'B_x': _B_in['x'], 'B_w1': _B_in['w1'], 'B_w3': _B_in['w3'], 'B_w2': _B_in['w2'], 'c': _w((lambda *s: torch.randn(*s, dtype=torch.bfloat16) * 0.1)(1, 640) * 8.0), 'w_mod': _w((lambda *s: torch.randn(*s, dtype=torch.bfloat16) * 0.1)(640, 6 * 640) * 640 ** (-0.5) * 8.0)}

def reference(A_x, A_mem0, A_Wq, A_Wk, A_Wv, A_Wo, A_seg_len, B_x, B_w1, B_w3, B_w2, c, w_mod):

    def _A_ref(x, mem0, Wq, Wk, Wv, Wo, seg_len):
        B, S, Dm = x.shape
        H, Dh = (Wq.shape[1], Wq.shape[2])
        M = mem0.shape[1]
        scale = Dh ** (-0.5)
        n_seg = S // seg_len
        L = M + seg_len
        idx = torch.arange(L)
        mask = (idx[:, None] < M) | (idx[:, None] >= idx[None, :])
        mem = mem0
        outs = []
        for s in range(n_seg):
            xs = x[:, s * seg_len:(s + 1) * seg_len, :].clone()
            h = torch.concatenate([mem, xs], axis=1)
            q = torch.einsum('btd,dhe->bhte', h, Wq)
            k = torch.einsum('btd,dhe->bhte', h, Wk)
            v = torch.einsum('btd,dhe->bhte', h, Wv)
            scores = torch.einsum('bhqe,bhke->bhqk', q, k) * scale
            scores = torch.where(mask[None, None], scores, -1000000000.0)
            p = _softmax(scores, axis=-1)
            o = torch.einsum('bhqk,bhke->bhqe', p, v)
            o = torch.einsum('bhte,hed->btd', o, Wo)
            mem = o[:, :M, :].clone()
            outs.append(o[:, M:, :])
        return torch.concatenate(outs, axis=1)

    def _B_ref(x, w1, w3, w2):
        gate = torch.einsum('bsd,df->bsf', x, w1)
        up = torch.einsum('bsd,df->bsf', x, w3)
        h = _silu(gate) * up
        out = torch.einsum('bsf,fd->bsd', h, w2)
        return out
    x = A_x
    mod = (_silu(c) @ w_mod).reshape(c.shape[0], 6, 1, -1)
    sa, ca, ga, sb, cb, gb = (mod[:, 0].clone(), mod[:, 1].clone(), mod[:, 2].clone(), mod[:, 3].clone(), mod[:, 4].clone(), mod[:, 5].clone())
    h = _layernorm(x, axis=-1) * (1 + ca) + sa
    x = x + ga * _A_ref(h, A_mem0, A_Wq, A_Wk, A_Wv, A_Wo, A_seg_len)
    h = _layernorm(x, axis=-1) * (1 + cb) + sb
    x = x + gb * _B_ref(h, B_w1, B_w3, B_w2)
    return x
```

```asm
; @launch kernel=mega_kernel grid=(256,1,1) block=(256,1,1) lds=82176
.amdgcn_target "amdgcn-amd-amdhsa--gfx950"
.text
.globl mega_kernel
.p2align 8
.type mega_kernel,@function
mega_kernel:
    s_cmp_ge_u32 s2, 256
    s_cbranch_scc1 L_mega_exit
    s_getreg_b32 s20, hwreg(HW_REG_XCC_ID)
    s_and_b32 s20, s20, 7
    s_load_dwordx2 s[84:85], s[0:1], 112
    s_load_dwordx2 s[12:13], s[0:1], 120
    v_lshrrev_b32 v1, 6, v0
    s_nop 0
    v_readfirstlane_b32 s22, v1
    v_and_b32 v1, 63, v0
    v_and_b32 v2, 15, v1
    v_lshrrev_b32 v3, 4, v1
    s_waitcnt lgkmcnt(0)
    s_mov_b32 s86, 256
    s_mov_b32 s87, 0x00020000
    s_mov_b32 s14, 268435456
    s_mov_b32 s15, 0x00020000
    v_cmp_eq_u32 vcc, 0, v0
    s_and_saveexec_b64 s[24:25], vcc
    s_cbranch_execz L_mega_noatom
    v_mov_b32 v4, 1
    s_lshl_b32 s26, s20, 2
    v_mov_b32 v5, s26
    buffer_atomic_add v4, v5, s[84:87], 0 offen sc0
    s_waitcnt vmcnt(0)
    v_mov_b32 v5, 81920
    ds_write_b32 v5, v4
    s_waitcnt lgkmcnt(0)
L_mega_noatom:
    s_mov_b64 exec, s[24:25]
    s_barrier
    v_mov_b32 v5, 81920
    ds_read_b32 v4, v5
    s_waitcnt lgkmcnt(0)
    v_readfirstlane_b32 s21, v4
    s_cmp_ge_u32 s21, 32
    s_cbranch_scc1 L_mega_done
    s_cmp_ge_u32 s20, 2
    s_cbranch_scc1 L_mega_bulk
    s_getpc_b64 s[24:25]
    v_lshlrev_b32 v4, 7, v0
    v_mov_b32 v5, 0
    v_mov_b32 v6, s25
    v_add_co_u32 v4, vcc, s24, v4
    s_nop 1
    v_addc_co_u32 v5, vcc, v6, v5, vcc
    global_load_dword v255, v[4:5], off
    v_add_co_u32 v4, vcc, 0x8000, v4
    s_nop 1
    v_addc_co_u32 v5, vcc, 0, v5, vcc
    global_load_dword v255, v[4:5], off
    s_add_u32 s24, s12, 136314879
    s_and_b32 s24, s24, 0xffe00000
    s_sub_u32 s24, s24, s12
    s_lshl_b32 s25, s20, 21
    s_add_u32 s60, s24, s25
    s_xor_b32 s25, s25, 0x200000
    s_add_u32 s61, s24, s25
    s_load_dwordx2 s[8:9], s[0:1], 8
    s_mov_b32 s34, 0x05040100
    s_mov_b32 s35, 0x07060302
    s_lshr_b32 s51, s21, 1
    s_lshl_b32 s24, s20, 4
    s_add_u32 s51, s51, s24
    s_and_b32 s52, s21, 1
    s_mul_i32 s24, s22, 5
    s_add_u32 s24, s24, 1
    s_lshr_b32 s24, s24, 1
    s_add_u32 s25, s24, 0
    s_sub_u32 s26, s25, 10
    s_cmp_ge_u32 s25, 10
    s_cselect_b32 s25, s26, s25
    s_lshl_b32 s64, s25, 10
    s_add_u32 s25, s24, 1
    s_sub_u32 s26, s25, 10
    s_cmp_ge_u32 s25, 10
    s_cselect_b32 s25, s26, s25
    s_lshl_b32 s65, s25, 10
    s_add_u32 s25, s24, 2
    s_sub_u32 s26, s25, 10
    s_cmp_ge_u32 s25, 10
    s_cselect_b32 s25, s26, s25
    s_lshl_b32 s66, s25, 10
    s_add_u32 s25, s24, 3
    s_sub_u32 s26, s25, 10
    s_cmp_ge_u32 s25, 10
    s_cselect_b32 s25, s26, s25
    s_lshl_b32 s67, s25, 10
    s_add_u32 s25, s24, 4
    s_sub_u32 s26, s25, 10
    s_cmp_ge_u32 s25, 10
    s_cselect_b32 s25, s26, s25
    s_lshl_b32 s68, s25, 10
    s_add_u32 s25, s24, 5
    s_sub_u32 s26, s25, 10
    s_cmp_ge_u32 s25, 10
    s_cselect_b32 s25, s26, s25
    s_lshl_b32 s69, s25, 10
    s_add_u32 s25, s24, 6
    s_sub_u32 s26, s25, 10
    s_cmp_ge_u32 s25, 10
    s_cselect_b32 s25, s26, s25
    s_lshl_b32 s70, s25, 10
    s_add_u32 s25, s24, 7
    s_sub_u32 s26, s25, 10
    s_cmp_ge_u32 s25, 10
    s_cselect_b32 s25, s26, s25
    s_lshl_b32 s71, s25, 10
    s_add_u32 s25, s24, 8
    s_sub_u32 s26, s25, 10
    s_cmp_ge_u32 s25, 10
    s_cselect_b32 s25, s26, s25
    s_lshl_b32 s72, s25, 10
    s_add_u32 s25, s24, 9
    s_sub_u32 s26, s25, 10
    s_cmp_ge_u32 s25, 10
    s_cselect_b32 s25, s26, s25
    s_lshl_b32 s73, s25, 10
    v_lshrrev_b32 v4, 1, v3
    v_lshlrev_b32 v4, 4, v4
    v_and_b32 v5, 1, v3
    v_lshl_add_u32 v4, v5, 2, v4
    v_lshlrev_b32 v5, 4, v1
    s_cmp_lt_u32 s21, 3
    s_cbranch_scc0 L_rec_nocal
    s_cmp_eq_u32 s22, 0
    s_cbranch_scc0 L_rec_nocal2
    v_mov_b32 v24, 0
    s_lshl_b32 s25, s21, 16
    s_add_u32 s25, s25, s60
    s_add_u32 s25, s25, 1572864
    s_mov_b64 exec, 1
    buffer_load_dword v25, v24, s[12:15], s25 offen sc1
    s_add_u32 s25, s25, 16384
    s_mov_b32 s26, -1
    s_mov_b32 s27, -1
    s_waitcnt vmcnt(0)
    s_memtime s[28:29]
    s_waitcnt lgkmcnt(0)
    buffer_load_dword v25, v24, s[12:15], s25 offen sc1
    s_waitcnt vmcnt(0)
    s_memtime s[30:31]
    s_waitcnt lgkmcnt(0)
    s_sub_u32 s28, s30, s28
    s_min_u32 s26, s26, s28
    s_add_u32 s25, s25, 8192
    s_memtime s[28:29]
    s_waitcnt lgkmcnt(0)
    buffer_load_dword v25, v24, s[12:15], s25 offen sc1
    s_waitcnt vmcnt(0)
    s_memtime s[30:31]
    s_waitcnt lgkmcnt(0)
    s_sub_u32 s28, s30, s28
    s_min_u32 s27, s27, s28
    s_add_u32 s25, s25, 8192
    s_memtime s[28:29]
    s_waitcnt lgkmcnt(0)
    buffer_load_dword v25, v24, s[12:15], s25 offen sc1
    s_waitcnt vmcnt(0)
    s_memtime s[30:31]
    s_waitcnt lgkmcnt(0)
    s_sub_u32 s28, s30, s28
    s_min_u32 s26, s26, s28
    s_add_u32 s25, s25, 8192
    s_memtime s[28:29]
    s_waitcnt lgkmcnt(0)
    buffer_load_dword v25, v24, s[12:15], s25 offen sc1
    s_waitcnt vmcnt(0)
    s_memtime s[30:31]
    s_waitcnt lgkmcnt(0)
    s_sub_u32 s28, s30, s28
    s_min_u32 s27, s27, s28
    s_add_u32 s25, s25, 8192
    s_cmp_lt_u32 s26, s27
    s_cselect_b32 s24, 16, 17
    v_mov_b32 v25, s24
    s_lshl_b32 s24, s20, 2
    s_add_u32 s24, s24, 224
    buffer_atomic_add v25, v24, s[84:87], s24 offen sc1
    s_mov_b64 exec, -1
L_rec_nocal2:
    s_barrier
L_rec_nocal:
    v_mov_b32 v24, -1
    v_mov_b32 v25, -1
    v_mov_b32 v26, -1
    v_mov_b32 v27, -1
    v_lshlrev_b32 v28, 4, v0
    s_lshl_b32 s24, s20, 5
    s_add_u32 s24, s24, s21
    s_mul_i32 s24, s24, 10240
    s_add_u32 s24, s24, 100663296
    s_mul_i32 s25, s20, 20480
    s_add_u32 s25, s25, 101359616
    s_mul_i32 s26, s21, 40960
    s_add_u32 s26, s26, s60
    buffer_store_dwordx4 v[24:27], v28, s[12:15], s26 offen sc1
    s_add_u32 s26, s26, 4096
    buffer_store_dwordx4 v[24:27], v28, s[12:15], s26 offen sc1
    s_add_u32 s26, s26, 4096
    buffer_store_dwordx4 v[24:27], v28, s[12:15], s26 offen sc1
    s_add_u32 s26, s26, 4096
    buffer_store_dwordx4 v[24:27], v28, s[12:15], s26 offen sc1
    s_add_u32 s26, s26, 4096
    buffer_store_dwordx4 v[24:27], v28, s[12:15], s26 offen sc1
    s_add_u32 s26, s26, 4096
    buffer_store_dwordx4 v[24:27], v28, s[12:15], s26 offen sc1
    s_add_u32 s26, s26, 4096
    buffer_store_dwordx4 v[24:27], v28, s[12:15], s26 offen sc1
    s_add_u32 s26, s26, 4096
    buffer_store_dwordx4 v[24:27], v28, s[12:15], s26 offen sc1
    s_add_u32 s26, s26, 4096
    buffer_store_dwordx4 v[24:27], v28, s[12:15], s26 offen sc1
    s_add_u32 s26, s26, 4096
    buffer_store_dwordx4 v[24:27], v28, s[12:15], s26 offen sc1
    s_add_u32 s26, s26, 4096
    buffer_store_dwordx4 v[24:27], v28, s[12:15], s24 offen
    s_add_u32 s24, s24, 4096
    buffer_store_dwordx4 v[24:27], v28, s[12:15], s24 offen
    s_add_u32 s24, s24, 4096
    s_cmp_lt_u32 s22, 2
    s_cbranch_scc0 L_nf_1
    buffer_store_dwordx4 v[24:27], v28, s[12:15], s24 offen
L_nf_1:
    s_cmp_eq_u32 s21, 3
    s_cbranch_scc0 L_rec_nofill
    s_mov_b32 s24, s25
    buffer_store_dwordx4 v[24:27], v28, s[12:15], s24 offen
    s_add_u32 s24, s24, 4096
    buffer_store_dwordx4 v[24:27], v28, s[12:15], s24 offen
    s_add_u32 s24, s24, 4096
    s_cmp_lt_u32 s22, 2
    s_cbranch_scc0 L_nf_2
    buffer_store_dwordx4 v[24:27], v28, s[12:15], s24 offen
L_nf_2:
L_rec_nofill:
    s_load_dwordx2 s[4:5], s[0:1], 24
    s_load_dwordx2 s[16:17], s[0:1], 16
    s_load_dwordx2 s[36:37], s[0:1], 32
    s_load_dwordx2 s[40:41], s[0:1], 40
    v_lshlrev_b32 v108, 13, v4
    v_lshl_add_u32 v108, v2, 3, v108
    s_lshl_b32 s25, s51, 8
    s_lshl_b32 s26, s52, 7
    s_add_u32 s25, s25, s26
    s_mul_i32 s26, s22, 1310720
    s_add_u32 s25, s25, s26
    v_add_u32 v108, s25, v108
    v_lshlrev_b32 v6, 13, v4
    v_lshl_add_u32 v6, v2, 4, v6
    s_lshl_b32 s25, s51, 8
    v_add_u32 v10, s25, v6
    v_lshrrev_b32 v11, 2, v2
    s_mov_b32 s25, 20512
    v_mul_lo_u32 v11, v11, s25
    v_lshl_add_u32 v11, v3, 8, v11
    v_and_b32 v8, 3, v2
    v_lshl_add_u32 v11, v8, 6, v11
    v_bfe_u32 v8, v2, 1, 1
    v_lshl_add_u32 v11, v8, 4, v11
    v_bfe_u32 v8, v1, 3, 1
    v_xor_b32 v12, v8, v1
    v_lshlrev_b32 v12, 4, v12
    s_add_u32 s24, s22, 0
    s_min_u32 s53, s24, 9
    s_add_u32 s24, s22, 4
    s_min_u32 s54, s24, 9
    s_add_u32 s24, s22, 8
    s_min_u32 s55, s24, 9
    s_waitcnt lgkmcnt(0)
    s_mov_b32 s6, 5242880
    s_mov_b32 s7, 0x00020000
    s_mov_b32 s18, 5242880
    s_mov_b32 s19, 0x00020000
    s_mov_b32 s38, 5242880
    s_mov_b32 s39, 0x00020000
    s_mov_b32 s42, 5242880
    s_mov_b32 s43, 0x00020000
    s_mov_b32 s10, 10240
    s_mov_b32 s11, 0x00020000
    s_mov_b32 s27, 0
    buffer_load_dwordx2 v[16:17], v108, s[4:7], s27 offen
    s_mov_b32 s27, 8192
    buffer_load_dwordx2 v[18:19], v108, s[4:7], s27 offen
    s_mov_b32 s27, 65536
    buffer_load_dwordx2 v[20:21], v108, s[4:7], s27 offen
    s_mov_b32 s27, 73728
    buffer_load_dwordx2 v[22:23], v108, s[4:7], s27 offen
    s_mov_b32 s27, 16384
    buffer_load_dwordx2 v[24:25], v108, s[4:7], s27 offen
    s_mov_b32 s27, 24576
    buffer_load_dwordx2 v[26:27], v108, s[4:7], s27 offen
    s_mov_b32 s27, 81920
    buffer_load_dwordx2 v[28:29], v108, s[4:7], s27 offen
    s_mov_b32 s27, 90112
    buffer_load_dwordx2 v[30:31], v108, s[4:7], s27 offen
    s_mov_b32 s27, 262144
    buffer_load_dwordx2 v[32:33], v108, s[4:7], s27 offen
    s_mov_b32 s27, 270336
    buffer_load_dwordx2 v[34:35], v108, s[4:7], s27 offen
    s_mov_b32 s27, 327680
    buffer_load_dwordx2 v[36:37], v108, s[4:7], s27 offen
    s_mov_b32 s27, 335872
    buffer_load_dwordx2 v[38:39], v108, s[4:7], s27 offen
    s_mov_b32 s27, 278528
    buffer_load_dwordx2 v[40:41], v108, s[4:7], s27 offen
    s_mov_b32 s27, 286720
    buffer_load_dwordx2 v[42:43], v108, s[4:7], s27 offen
    s_mov_b32 s27, 344064
    buffer_load_dwordx2 v[44:45], v108, s[4:7], s27 offen
    s_mov_b32 s27, 352256
    buffer_load_dwordx2 v[46:47], v108, s[4:7], s27 offen
    s_mov_b32 s27, 524288
    buffer_load_dwordx2 v[48:49], v108, s[4:7], s27 offen
    s_mov_b32 s27, 532480
    buffer_load_dwordx2 v[50:51], v108, s[4:7], s27 offen
    s_mov_b32 s27, 589824
    buffer_load_dwordx2 v[52:53], v108, s[4:7], s27 offen
    s_mov_b32 s27, 598016
    buffer_load_dwordx2 v[54:55], v108, s[4:7], s27 offen
    s_mov_b32 s27, 540672
    buffer_load_dwordx2 v[56:57], v108, s[4:7], s27 offen
    s_mov_b32 s27, 548864
    buffer_load_dwordx2 v[58:59], v108, s[4:7], s27 offen
    s_mov_b32 s27, 606208
    buffer_load_dwordx2 v[60:61], v108, s[4:7], s27 offen
    s_mov_b32 s27, 614400
    buffer_load_dwordx2 v[62:63], v108, s[4:7], s27 offen
    s_mov_b32 s27, 786432
    buffer_load_dwordx2 v[64:65], v108, s[4:7], s27 offen
    s_mov_b32 s27, 794624
    buffer_load_dwordx2 v[66:67], v108, s[4:7], s27 offen
    s_mov_b32 s27, 851968
    buffer_load_dwordx2 v[68:69], v108, s[4:7], s27 offen
    s_mov_b32 s27, 860160
    buffer_load_dwordx2 v[70:71], v108, s[4:7], s27 offen
    s_mov_b32 s27, 802816
    buffer_load_dwordx2 v[72:73], v108, s[4:7], s27 offen
    s_mov_b32 s27, 811008
    buffer_load_dwordx2 v[74:75], v108, s[4:7], s27 offen
    s_mov_b32 s27, 868352
    buffer_load_dwordx2 v[76:77], v108, s[4:7], s27 offen
    s_mov_b32 s27, 876544
    buffer_load_dwordx2 v[78:79], v108, s[4:7], s27 offen
    s_mov_b32 s27, 1048576
    buffer_load_dwordx2 v[80:81], v108, s[4:7], s27 offen
    s_mov_b32 s27, 1056768
    buffer_load_dwordx2 v[82:83], v108, s[4:7], s27 offen
    s_mov_b32 s27, 1114112
    buffer_load_dwordx2 v[84:85], v108, s[4:7], s27 offen
    s_mov_b32 s27, 1122304
    buffer_load_dwordx2 v[86:87], v108, s[4:7], s27 offen
    s_mov_b32 s27, 1064960
    buffer_load_dwordx2 v[88:89], v108, s[4:7], s27 offen
    s_mov_b32 s27, 1073152
    buffer_load_dwordx2 v[90:91], v108, s[4:7], s27 offen
    s_mov_b32 s27, 1130496
    buffer_load_dwordx2 v[92:93], v108, s[4:7], s27 offen
    s_mov_b32 s27, 1138688
    buffer_load_dwordx2 v[94:95], v108, s[4:7], s27 offen
    s_add_u32 s24, s53, 0
    s_mul_i32 s24, s24, 262144
    v_add_u32 v6, s24, v10
    s_mov_b32 s27, 0
    buffer_load_dwordx4 v[112:115], v6, s[16:19], s27 offen
    s_mov_b32 s27, 8192
    buffer_load_dwordx4 v[116:119], v6, s[16:19], s27 offen
    s_mov_b32 s27, 65536
    buffer_load_dwordx4 v[120:123], v6, s[16:19], s27 offen
    s_mov_b32 s27, 73728
    buffer_load_dwordx4 v[124:127], v6, s[16:19], s27 offen
    s_mov_b32 s27, 16384
    buffer_load_dwordx4 v[128:131], v6, s[16:19], s27 offen
    s_mov_b32 s27, 24576
    buffer_load_dwordx4 v[132:135], v6, s[16:19], s27 offen
    s_mov_b32 s27, 81920
    buffer_load_dwordx4 v[136:139], v6, s[16:19], s27 offen
    s_mov_b32 s27, 90112
    buffer_load_dwordx4 v[140:143], v6, s[16:19], s27 offen
    s_add_u32 s24, s54, 0
    s_mul_i32 s24, s24, 262144
    v_add_u32 v6, s24, v10
    s_mov_b32 s27, 0
    buffer_load_dwordx4 v[144:147], v6, s[16:19], s27 offen
    s_mov_b32 s27, 8192
    buffer_load_dwordx4 v[148:151], v6, s[16:19], s27 offen
    s_mov_b32 s27, 65536
    buffer_load_dwordx4 v[152:155], v6, s[16:19], s27 offen
    s_mov_b32 s27, 73728
    buffer_load_dwordx4 v[156:159], v6, s[16:19], s27 offen
    s_mov_b32 s27, 16384
    buffer_load_dwordx4 v[160:163], v6, s[16:19], s27 offen
    s_mov_b32 s27, 24576
    buffer_load_dwordx4 v[164:167], v6, s[16:19], s27 offen
    s_mov_b32 s27, 81920
    buffer_load_dwordx4 v[168:171], v6, s[16:19], s27 offen
    s_mov_b32 s27, 90112
    buffer_load_dwordx4 v[172:175], v6, s[16:19], s27 offen
    s_add_u32 s24, s55, 0
    s_mul_i32 s24, s24, 262144
    v_add_u32 v6, s24, v10
    s_mov_b32 s27, 0
    buffer_load_dwordx4 v[176:179], v6, s[16:19], s27 offen
    s_mov_b32 s27, 8192
    buffer_load_dwordx4 v[180:183], v6, s[16:19], s27 offen
    s_mov_b32 s27, 65536
    buffer_load_dwordx4 v[184:187], v6, s[16:19], s27 offen
    s_mov_b32 s27, 73728
    buffer_load_dwordx4 v[188:191], v6, s[16:19], s27 offen
    s_mov_b32 s27, 16384
    buffer_load_dwordx4 v[192:195], v6, s[16:19], s27 offen
    s_mov_b32 s27, 24576
    buffer_load_dwordx4 v[196:199], v6, s[16:19], s27 offen
    s_mov_b32 s27, 81920
    buffer_load_dwordx4 v[200:203], v6, s[16:19], s27 offen
    s_mov_b32 s27, 90112
    buffer_load_dwordx4 v[204:207], v6, s[16:19], s27 offen
    s_mul_i32 s26, s22, 5120
    v_add_u32 v7, s26, v11
    v_xor_b32 v8, 16, v7
    s_barrier
    s_waitcnt vmcnt(56)
    v_lshlrev_b32 v104, 16, v16
    v_lshlrev_b32 v105, 16, v18
    v_cvt_pk_f16_f32 v96, v104, v105
    v_lshlrev_b32 v106, 16, v20
    v_lshlrev_b32 v107, 16, v22
    v_cvt_pk_f16_f32 v97, v106, v107
    v_lshlrev_b32 v104, 16, v24
    v_lshlrev_b32 v105, 16, v26
    v_cvt_pk_f16_f32 v98, v104, v105
    v_lshlrev_b32 v106, 16, v28
    v_lshlrev_b32 v107, 16, v30
    v_cvt_pk_f16_f32 v99, v106, v107
    ds_write_b128 v7, v[96:99] offset:0
    v_and_b32 v104, 0xffff0000, v16
    v_and_b32 v105, 0xffff0000, v18
    v_cvt_pk_f16_f32 v100, v104, v105
    v_and_b32 v106, 0xffff0000, v20
    v_and_b32 v107, 0xffff0000, v22
    v_cvt_pk_f16_f32 v101, v106, v107
    v_and_b32 v104, 0xffff0000, v24
    v_and_b32 v105, 0xffff0000, v26
    v_cvt_pk_f16_f32 v102, v104, v105
    v_and_b32 v106, 0xffff0000, v28
    v_and_b32 v107, 0xffff0000, v30
    v_cvt_pk_f16_f32 v103, v106, v107
    ds_write_b128 v8, v[100:103] offset:0
    v_lshlrev_b32 v104, 16, v17
    v_lshlrev_b32 v105, 16, v19
    v_cvt_pk_f16_f32 v96, v104, v105
    v_lshlrev_b32 v106, 16, v21
    v_lshlrev_b32 v107, 16, v23
    v_cvt_pk_f16_f32 v97, v106, v107
    v_lshlrev_b32 v104, 16, v25
    v_lshlrev_b32 v105, 16, v27
    v_cvt_pk_f16_f32 v98, v104, v105
    v_lshlrev_b32 v106, 16, v29
    v_lshlrev_b32 v107, 16, v31
    v_cvt_pk_f16_f32 v99, v106, v107
    ds_write_b128 v7, v[96:99] offset:32
    v_and_b32 v104, 0xffff0000, v17
    v_and_b32 v105, 0xffff0000, v19
    v_cvt_pk_f16_f32 v100, v104, v105
    v_and_b32 v106, 0xffff0000, v21
    v_and_b32 v107, 0xffff0000, v23
    v_cvt_pk_f16_f32 v101, v106, v107
    v_and_b32 v104, 0xffff0000, v25
    v_and_b32 v105, 0xffff0000, v27
    v_cvt_pk_f16_f32 v102, v104, v105
    v_and_b32 v106, 0xffff0000, v29
    v_and_b32 v107, 0xffff0000, v31
    v_cvt_pk_f16_f32 v103, v106, v107
    ds_write_b128 v8, v[100:103] offset:32
    s_waitcnt vmcnt(48)
    v_lshlrev_b32 v104, 16, v32
    v_lshlrev_b32 v105, 16, v34
    v_cvt_pk_f16_f32 v96, v104, v105
    v_lshlrev_b32 v106, 16, v36
    v_lshlrev_b32 v107, 16, v38
    v_cvt_pk_f16_f32 v97, v106, v107
    v_lshlrev_b32 v104, 16, v40
    v_lshlrev_b32 v105, 16, v42
    v_cvt_pk_f16_f32 v98, v104, v105
    v_lshlrev_b32 v106, 16, v44
    v_lshlrev_b32 v107, 16, v46
    v_cvt_pk_f16_f32 v99, v106, v107
    ds_write_b128 v7, v[96:99] offset:1024
    v_and_b32 v104, 0xffff0000, v32
    v_and_b32 v105, 0xffff0000, v34
    v_cvt_pk_f16_f32 v100, v104, v105
    v_and_b32 v106, 0xffff0000, v36
    v_and_b32 v107, 0xffff0000, v38
    v_cvt_pk_f16_f32 v101, v106, v107
    v_and_b32 v104, 0xffff0000, v40
    v_and_b32 v105, 0xffff0000, v42
    v_cvt_pk_f16_f32 v102, v104, v105
    v_and_b32 v106, 0xffff0000, v44
    v_and_b32 v107, 0xffff0000, v46
    v_cvt_pk_f16_f32 v103, v106, v107
    ds_write_b128 v8, v[100:103] offset:1024
    v_lshlrev_b32 v104, 16, v33
    v_lshlrev_b32 v105, 16, v35
    v_cvt_pk_f16_f32 v96, v104, v105
    v_lshlrev_b32 v106, 16, v37
    v_lshlrev_b32 v107, 16, v39
    v_cvt_pk_f16_f32 v97, v106, v107
    v_lshlrev_b32 v104, 16, v41
    v_lshlrev_b32 v105, 16, v43
    v_cvt_pk_f16_f32 v98, v104, v105
    v_lshlrev_b32 v106, 16, v45
    v_lshlrev_b32 v107, 16, v47
    v_cvt_pk_f16_f32 v99, v106, v107
    ds_write_b128 v7, v[96:99] offset:1056
    v_and_b32 v104, 0xffff0000, v33
    v_and_b32 v105, 0xffff0000, v35
    v_cvt_pk_f16_f32 v100, v104, v105
    v_and_b32 v106, 0xffff0000, v37
    v_and_b32 v107, 0xffff0000, v39
    v_cvt_pk_f16_f32 v101, v106, v107
    v_and_b32 v104, 0xffff0000, v41
    v_and_b32 v105, 0xffff0000, v43
    v_cvt_pk_f16_f32 v102, v104, v105
    v_and_b32 v106, 0xffff0000, v45
    v_and_b32 v107, 0xffff0000, v47
    v_cvt_pk_f16_f32 v103, v106, v107
    ds_write_b128 v8, v[100:103] offset:1056
    s_waitcnt vmcnt(40)
    v_lshlrev_b32 v104, 16, v48
    v_lshlrev_b32 v105, 16, v50
    v_cvt_pk_f16_f32 v96, v104, v105
    v_lshlrev_b32 v106, 16, v52
    v_lshlrev_b32 v107, 16, v54
    v_cvt_pk_f16_f32 v97, v106, v107
    v_lshlrev_b32 v104, 16, v56
    v_lshlrev_b32 v105, 16, v58
    v_cvt_pk_f16_f32 v98, v104, v105
    v_lshlrev_b32 v106, 16, v60
    v_lshlrev_b32 v107, 16, v62
    v_cvt_pk_f16_f32 v99, v106, v107
    ds_write_b128 v7, v[96:99] offset:2048
    v_and_b32 v104, 0xffff0000, v48
    v_and_b32 v105, 0xffff0000, v50
    v_cvt_pk_f16_f32 v100, v104, v105
    v_and_b32 v106, 0xffff0000, v52
    v_and_b32 v107, 0xffff0000, v54
    v_cvt_pk_f16_f32 v101, v106, v107
    v_and_b32 v104, 0xffff0000, v56
    v_and_b32 v105, 0xffff0000, v58
    v_cvt_pk_f16_f32 v102, v104, v105
    v_and_b32 v106, 0xffff0000, v60
    v_and_b32 v107, 0xffff0000, v62
    v_cvt_pk_f16_f32 v103, v106, v107
    ds_write_b128 v8, v[100:103] offset:2048
    v_lshlrev_b32 v104, 16, v49
    v_lshlrev_b32 v105, 16, v51
    v_cvt_pk_f16_f32 v96, v104, v105
    v_lshlrev_b32 v106, 16, v53
    v_lshlrev_b32 v107, 16, v55
    v_cvt_pk_f16_f32 v97, v106, v107
    v_lshlrev_b32 v104, 16, v57
    v_lshlrev_b32 v105, 16, v59
    v_cvt_pk_f16_f32 v98, v104, v105
    v_lshlrev_b32 v106, 16, v61
    v_lshlrev_b32 v107, 16, v63
    v_cvt_pk_f16_f32 v99, v106, v107
    ds_write_b128 v7, v[96:99] offset:2080
    v_and_b32 v104, 0xffff0000, v49
    v_and_b32 v105, 0xffff0000, v51
    v_cvt_pk_f16_f32 v100, v104, v105
    v_and_b32 v106, 0xffff0000, v53
    v_and_b32 v107, 0xffff0000, v55
    v_cvt_pk_f16_f32 v101, v106, v107
    v_and_b32 v104, 0xffff0000, v57
    v_and_b32 v105, 0xffff0000, v59
    v_cvt_pk_f16_f32 v102, v104, v105
    v_and_b32 v106, 0xffff0000, v61
    v_and_b32 v107, 0xffff0000, v63
    v_cvt_pk_f16_f32 v103, v106, v107
    ds_write_b128 v8, v[100:103] offset:2080
    s_waitcnt vmcnt(32)
    v_lshlrev_b32 v104, 16, v64
    v_lshlrev_b32 v105, 16, v66
    v_cvt_pk_f16_f32 v96, v104, v105
    v_lshlrev_b32 v106, 16, v68
    v_lshlrev_b32 v107, 16, v70
    v_cvt_pk_f16_f32 v97, v106, v107
    v_lshlrev_b32 v104, 16, v72
    v_lshlrev_b32 v105, 16, v74
    v_cvt_pk_f16_f32 v98, v104, v105
    v_lshlrev_b32 v106, 16, v76
    v_lshlrev_b32 v107, 16, v78
    v_cvt_pk_f16_f32 v99, v106, v107
    ds_write_b128 v7, v[96:99] offset:3072
    v_and_b32 v104, 0xffff0000, v64
    v_and_b32 v105, 0xffff0000, v66
    v_cvt_pk_f16_f32 v100, v104, v105
    v_and_b32 v106, 0xffff0000, v68
    v_and_b32 v107, 0xffff0000, v70
    v_cvt_pk_f16_f32 v101, v106, v107
    v_and_b32 v104, 0xffff0000, v72
    v_and_b32 v105, 0xffff0000, v74
    v_cvt_pk_f16_f32 v102, v104, v105
    v_and_b32 v106, 0xffff0000, v76
    v_and_b32 v107, 0xffff0000, v78
    v_cvt_pk_f16_f32 v103, v106, v107
    ds_write_b128 v8, v[100:103] offset:3072
    v_lshlrev_b32 v104, 16, v65
    v_lshlrev_b32 v105, 16, v67
    v_cvt_pk_f16_f32 v96, v104, v105
    v_lshlrev_b32 v106, 16, v69
    v_lshlrev_b32 v107, 16, v71
    v_cvt_pk_f16_f32 v97, v106, v107
    v_lshlrev_b32 v104, 16, v73
    v_lshlrev_b32 v105, 16, v75
    v_cvt_pk_f16_f32 v98, v104, v105
    v_lshlrev_b32 v106, 16, v77
    v_lshlrev_b32 v107, 16, v79
    v_cvt_pk_f16_f32 v99, v106, v107
    ds_write_b128 v7, v[96:99] offset:3104
    v_and_b32 v104, 0xffff0000, v65
    v_and_b32 v105, 0xffff0000, v67
    v_cvt_pk_f16_f32 v100, v104, v105
    v_and_b32 v106, 0xffff0000, v69
    v_and_b32 v107, 0xffff0000, v71
    v_cvt_pk_f16_f32 v101, v106, v107
    v_and_b32 v104, 0xffff0000, v73
    v_and_b32 v105, 0xffff0000, v75
    v_cvt_pk_f16_f32 v102, v104, v105
    v_and_b32 v106, 0xffff0000, v77
    v_and_b32 v107, 0xffff0000, v79
    v_cvt_pk_f16_f32 v103, v106, v107
    ds_write_b128 v8, v[100:103] offset:3104
    s_waitcnt vmcnt(24)
    v_lshlrev_b32 v104, 16, v80
    v_lshlrev_b32 v105, 16, v82
    v_cvt_pk_f16_f32 v96, v104, v105
    v_lshlrev_b32 v106, 16, v84
    v_lshlrev_b32 v107, 16, v86
    v_cvt_pk_f16_f32 v97, v106, v107
    v_lshlrev_b32 v104, 16, v88
    v_lshlrev_b32 v105, 16, v90
    v_cvt_pk_f16_f32 v98, v104, v105
    v_lshlrev_b32 v106, 16, v92
    v_lshlrev_b32 v107, 16, v94
    v_cvt_pk_f16_f32 v99, v106, v107
    ds_write_b128 v7, v[96:99] offset:4096
    v_and_b32 v104, 0xffff0000, v80
    v_and_b32 v105, 0xffff0000, v82
    v_cvt_pk_f16_f32 v100, v104, v105
    v_and_b32 v106, 0xffff0000, v84
    v_and_b32 v107, 0xffff0000, v86
    v_cvt_pk_f16_f32 v101, v106, v107
    v_and_b32 v104, 0xffff0000, v88
    v_and_b32 v105, 0xffff0000, v90
    v_cvt_pk_f16_f32 v102, v104, v105
    v_and_b32 v106, 0xffff0000, v92
    v_and_b32 v107, 0xffff0000, v94
    v_cvt_pk_f16_f32 v103, v106, v107
    ds_write_b128 v8, v[100:103] offset:4096
    v_lshlrev_b32 v104, 16, v81
    v_lshlrev_b32 v105, 16, v83
    v_cvt_pk_f16_f32 v96, v104, v105
    v_lshlrev_b32 v106, 16, v85
    v_lshlrev_b32 v107, 16, v87
    v_cvt_pk_f16_f32 v97, v106, v107
    v_lshlrev_b32 v104, 16, v89
    v_lshlrev_b32 v105, 16, v91
    v_cvt_pk_f16_f32 v98, v104, v105
    v_lshlrev_b32 v106, 16, v93
    v_lshlrev_b32 v107, 16, v95
    v_cvt_pk_f16_f32 v99, v106, v107
    ds_write_b128 v7, v[96:99] offset:4128
    v_and_b32 v104, 0xffff0000, v81
    v_and_b32 v105, 0xffff0000, v83
    v_cvt_pk_f16_f32 v100, v104, v105
    v_and_b32 v106, 0xffff0000, v85
    v_and_b32 v107, 0xffff0000, v87
    v_cvt_pk_f16_f32 v101, v106, v107
    v_and_b32 v104, 0xffff0000, v89
    v_and_b32 v105, 0xffff0000, v91
    v_cvt_pk_f16_f32 v102, v104, v105
    v_and_b32 v106, 0xffff0000, v93
    v_and_b32 v107, 0xffff0000, v95
    v_cvt_pk_f16_f32 v103, v106, v107
    ds_write_b128 v8, v[100:103] offset:4128
    s_add_u32 s24, s53, 10
    s_mul_i32 s24, s24, 262144
    v_add_u32 v6, s24, v10
    s_mov_b32 s27, 0
    buffer_load_dwordx4 v[16:19], v6, s[16:19], s27 offen
    s_mov_b32 s27, 8192
    buffer_load_dwordx4 v[20:23], v6, s[16:19], s27 offen
    s_mov_b32 s27, 65536
    buffer_load_dwordx4 v[24:27], v6, s[16:19], s27 offen
    s_mov_b32 s27, 73728
    buffer_load_dwordx4 v[28:31], v6, s[16:19], s27 offen
    s_mov_b32 s27, 16384
    buffer_load_dwordx4 v[32:35], v6, s[16:19], s27 offen
    s_mov_b32 s27, 24576
    buffer_load_dwordx4 v[36:39], v6, s[16:19], s27 offen
    s_mov_b32 s27, 81920
    buffer_load_dwordx4 v[40:43], v6, s[16:19], s27 offen
    s_mov_b32 s27, 90112
    buffer_load_dwordx4 v[44:47], v6, s[16:19], s27 offen
    s_add_u32 s24, s54, 10
    s_mul_i32 s24, s24, 262144
    v_add_u32 v6, s24, v10
    s_mov_b32 s27, 0
    buffer_load_dwordx4 v[48:51], v6, s[16:19], s27 offen
    s_mov_b32 s27, 8192
    buffer_load_dwordx4 v[52:55], v6, s[16:19], s27 offen
    s_mov_b32 s27, 65536
    buffer_load_dwordx4 v[56:59], v6, s[16:19], s27 offen
    s_mov_b32 s27, 73728
    buffer_load_dwordx4 v[60:63], v6, s[16:19], s27 offen
    s_mov_b32 s27, 16384
    buffer_load_dwordx4 v[64:67], v6, s[16:19], s27 offen
    s_mov_b32 s27, 24576
    buffer_load_dwordx4 v[68:71], v6, s[16:19], s27 offen
    s_mov_b32 s27, 81920
    buffer_load_dwordx4 v[72:75], v6, s[16:19], s27 offen
    s_mov_b32 s27, 90112
    buffer_load_dwordx4 v[76:79], v6, s[16:19], s27 offen
    s_add_u32 s24, s55, 10
    s_mul_i32 s24, s24, 262144
    v_add_u32 v6, s24, v10
    s_mov_b32 s27, 0
    buffer_load_dwordx4 v[208:211], v6, s[16:19], s27 offen
    s_mov_b32 s27, 8192
    buffer_load_dwordx4 v[212:215], v6, s[16:19], s27 offen
    s_mov_b32 s27, 65536
    buffer_load_dwordx4 v[216:219], v6, s[16:19], s27 offen
    s_mov_b32 s27, 73728
    buffer_load_dwordx4 v[220:223], v6, s[16:19], s27 offen
    s_mov_b32 s27, 16384
    buffer_load_dwordx4 v[224:227], v6, s[16:19], s27 offen
    s_mov_b32 s27, 24576
    buffer_load_dwordx4 v[228:231], v6, s[16:19], s27 offen
    s_mov_b32 s27, 81920
    buffer_load_dwordx4 v[232:235], v6, s[16:19], s27 offen
    s_mov_b32 s27, 90112
    buffer_load_dwordx4 v[236:239], v6, s[16:19], s27 offen
    s_waitcnt lgkmcnt(0)
    s_barrier
    s_mul_i32 s24, s22, 20512
    s_lshl_b32 s25, s64, 1
    s_add_u32 s25, s25, s24
    v_add_u32 v9, s25, v12
    ds_read_b128 a[0:3], v9 offset:0
    ds_read_b128 a[4:7], v9 offset:1024
    s_lshl_b32 s25, s65, 1
    s_add_u32 s25, s25, s24
    v_add_u32 v9, s25, v12
    ds_read_b128 a[8:11], v9 offset:0
    ds_read_b128 a[12:15], v9 offset:1024
    s_lshl_b32 s25, s66, 1
    s_add_u32 s25, s25, s24
    v_add_u32 v9, s25, v12
    ds_read_b128 a[16:19], v9 offset:0
    ds_read_b128 a[20:23], v9 offset:1024
    s_lshl_b32 s25, s67, 1
    s_add_u32 s25, s25, s24
    v_add_u32 v9, s25, v12
    ds_read_b128 a[24:27], v9 offset:0
    ds_read_b128 a[28:31], v9 offset:1024
    s_lshl_b32 s25, s68, 1
    s_add_u32 s25, s25, s24
    v_add_u32 v9, s25, v12
    ds_read_b128 a[32:35], v9 offset:0
    ds_read_b128 a[36:39], v9 offset:1024
    s_lshl_b32 s25, s69, 1
    s_add_u32 s25, s25, s24
    v_add_u32 v9, s25, v12
    ds_read_b128 a[40:43], v9 offset:0
    ds_read_b128 a[44:47], v9 offset:1024
    s_lshl_b32 s25, s70, 1
    s_add_u32 s25, s25, s24
    v_add_u32 v9, s25, v12
    ds_read_b128 a[48:51], v9 offset:0
    ds_read_b128 a[52:55], v9 offset:1024
    s_lshl_b32 s25, s71, 1
    s_add_u32 s25, s25, s24
    v_add_u32 v9, s25, v12
    ds_read_b128 a[56:59], v9 offset:0
    ds_read_b128 a[60:63], v9 offset:1024
    s_lshl_b32 s25, s72, 1
    s_add_u32 s25, s25, s24
    v_add_u32 v9, s25, v12
    ds_read_b128 a[64:67], v9 offset:0
    ds_read_b128 a[68:71], v9 offset:1024
    s_lshl_b32 s25, s73, 1
    s_add_u32 s25, s25, s24
    v_add_u32 v9, s25, v12
    ds_read_b128 a[72:75], v9 offset:0
    ds_read_b128 a[76:79], v9 offset:1024
    s_waitcnt lgkmcnt(0)
    s_cmp_eq_u32 s22, 0
    s_cbranch_scc0 L_rec_nosig
    v_mov_b32 v104, 0
    v_mov_b32 v105, 1
    s_mov_b64 exec, 1
    buffer_atomic_add v105, v104, s[84:87], 0 offen offset:96 sc1
    s_mov_b64 exec, -1
L_rec_nosig:
    s_barrier
    s_waitcnt vmcnt(40)
    s_lshl_b32 s24, s53, 10
    v_add_u32 v7, s24, v11
    v_xor_b32 v8, 16, v7
    v_lshlrev_b32 v104, 16, v112
    v_lshlrev_b32 v105, 16, v116
    v_cvt_pk_f16_f32 v96, v104, v105
    v_lshlrev_b32 v106, 16, v120
    v_lshlrev_b32 v107, 16, v124
    v_cvt_pk_f16_f32 v97, v106, v107
    v_lshlrev_b32 v104, 16, v128
    v_lshlrev_b32 v105, 16, v132
    v_cvt_pk_f16_f32 v98, v104, v105
    v_lshlrev_b32 v106, 16, v136
    v_lshlrev_b32 v107, 16, v140
    v_cvt_pk_f16_f32 v99, v106, v107
    ds_write_b128 v7, v[96:99] offset:0
    v_and_b32 v104, 0xffff0000, v112
    v_and_b32 v105, 0xffff0000, v116
    v_cvt_pk_f16_f32 v100, v104, v105
    v_and_b32 v106, 0xffff0000, v120
    v_and_b32 v107, 0xffff0000, v124
    v_cvt_pk_f16_f32 v101, v106, v107
    v_and_b32 v104, 0xffff0000, v128
    v_and_b32 v105, 0xffff0000, v132
    v_cvt_pk_f16_f32 v102, v104, v105
    v_and_b32 v106, 0xffff0000, v136
    v_and_b32 v107, 0xffff0000, v140
    v_cvt_pk_f16_f32 v103, v106, v107
    ds_write_b128 v7, v[100:103] offset:10240
    v_lshlrev_b32 v104, 16, v113
    v_lshlrev_b32 v105, 16, v117
    v_cvt_pk_f16_f32 v96, v104, v105
    v_lshlrev_b32 v106, 16, v121
    v_lshlrev_b32 v107, 16, v125
    v_cvt_pk_f16_f32 v97, v106, v107
    v_lshlrev_b32 v104, 16, v129
    v_lshlrev_b32 v105, 16, v133
    v_cvt_pk_f16_f32 v98, v104, v105
    v_lshlrev_b32 v106, 16, v137
    v_lshlrev_b32 v107, 16, v141
    v_cvt_pk_f16_f32 v99, v106, v107
    ds_write_b128 v8, v[96:99] offset:0
    v_and_b32 v104, 0xffff0000, v113
    v_and_b32 v105, 0xffff0000, v117
    v_cvt_pk_f16_f32 v100, v104, v105
    v_and_b32 v106, 0xffff0000, v121
    v_and_b32 v107, 0xffff0000, v125
    v_cvt_pk_f16_f32 v101, v106, v107
    v_and_b32 v104, 0xffff0000, v129
    v_and_b32 v105, 0xffff0000, v133
    v_cvt_pk_f16_f32 v102, v104, v105
    v_and_b32 v106, 0xffff0000, v137
    v_and_b32 v107, 0xffff0000, v141
    v_cvt_pk_f16_f32 v103, v106, v107
    ds_write_b128 v8, v[100:103] offset:10240
    v_lshlrev_b32 v104, 16, v114
    v_lshlrev_b32 v105, 16, v118
    v_cvt_pk_f16_f32 v96, v104, v105
    v_lshlrev_b32 v106, 16, v122
    v_lshlrev_b32 v107, 16, v126
    v_cvt_pk_f16_f32 v97, v106, v107
    v_lshlrev_b32 v104, 16, v130
    v_lshlrev_b32 v105, 16, v134
    v_cvt_pk_f16_f32 v98, v104, v105
    v_lshlrev_b32 v106, 16, v138
    v_lshlrev_b32 v107, 16, v142
    v_cvt_pk_f16_f32 v99, v106, v107
    ds_write_b128 v7, v[96:99] offset:32
    v_and_b32 v104, 0xffff0000, v114
    v_and_b32 v105, 0xffff0000, v118
    v_cvt_pk_f16_f32 v100, v104, v105
    v_and_b32 v106, 0xffff0000, v122
    v_and_b32 v107, 0xffff0000, v126
    v_cvt_pk_f16_f32 v101, v106, v107
    v_and_b32 v104, 0xffff0000, v130
    v_and_b32 v105, 0xffff0000, v134
    v_cvt_pk_f16_f32 v102, v104, v105
    v_and_b32 v106, 0xffff0000, v138
    v_and_b32 v107, 0xffff0000, v142
    v_cvt_pk_f16_f32 v103, v106, v107
    ds_write_b128 v7, v[100:103] offset:10272
    v_lshlrev_b32 v104, 16, v115
    v_lshlrev_b32 v105, 16, v119
    v_cvt_pk_f16_f32 v96, v104, v105
    v_lshlrev_b32 v106, 16, v123
    v_lshlrev_b32 v107, 16, v127
    v_cvt_pk_f16_f32 v97, v106, v107
    v_lshlrev_b32 v104, 16, v131
    v_lshlrev_b32 v105, 16, v135
    v_cvt_pk_f16_f32 v98, v104, v105
    v_lshlrev_b32 v106, 16, v139
    v_lshlrev_b32 v107, 16, v143
    v_cvt_pk_f16_f32 v99, v106, v107
    ds_write_b128 v8, v[96:99] offset:32
    v_and_b32 v104, 0xffff0000, v115
    v_and_b32 v105, 0xffff0000, v119
    v_cvt_pk_f16_f32 v100, v104, v105
    v_and_b32 v106, 0xffff0000, v123
    v_and_b32 v107, 0xffff0000, v127
    v_cvt_pk_f16_f32 v101, v106, v107
    v_and_b32 v104, 0xffff0000, v131
    v_and_b32 v105, 0xffff0000, v135
    v_cvt_pk_f16_f32 v102, v104, v105
    v_and_b32 v106, 0xffff0000, v139
    v_and_b32 v107, 0xffff0000, v143
    v_cvt_pk_f16_f32 v103, v106, v107
    ds_write_b128 v8, v[100:103] offset:10272
    s_waitcnt vmcnt(32)
    s_lshl_b32 s24, s54, 10
    v_add_u32 v7, s24, v11
    v_xor_b32 v8, 16, v7
    v_lshlrev_b32 v104, 16, v144
    v_lshlrev_b32 v105, 16, v148
    v_cvt_pk_f16_f32 v96, v104, v105
    v_lshlrev_b32 v106, 16, v152
    v_lshlrev_b32 v107, 16, v156
    v_cvt_pk_f16_f32 v97, v106, v107
    v_lshlrev_b32 v104, 16, v160
    v_lshlrev_b32 v105, 16, v164
    v_cvt_pk_f16_f32 v98, v104, v105
    v_lshlrev_b32 v106, 16, v168
    v_lshlrev_b32 v107, 16, v172
    v_cvt_pk_f16_f32 v99, v106, v107
    ds_write_b128 v7, v[96:99] offset:0
    v_and_b32 v104, 0xffff0000, v144
    v_and_b32 v105, 0xffff0000, v148
    v_cvt_pk_f16_f32 v100, v104, v105
    v_and_b32 v106, 0xffff0000, v152
    v_and_b32 v107, 0xffff0000, v156
    v_cvt_pk_f16_f32 v101, v106, v107
    v_and_b32 v104, 0xffff0000, v160
    v_and_b32 v105, 0xffff0000, v164
    v_cvt_pk_f16_f32 v102, v104, v105
    v_and_b32 v106, 0xffff0000, v168
    v_and_b32 v107, 0xffff0000, v172
    v_cvt_pk_f16_f32 v103, v106, v107
    ds_write_b128 v7, v[100:103] offset:10240
    v_lshlrev_b32 v104, 16, v145
    v_lshlrev_b32 v105, 16, v149
    v_cvt_pk_f16_f32 v96, v104, v105
    v_lshlrev_b32 v106, 16, v153
    v_lshlrev_b32 v107, 16, v157
    v_cvt_pk_f16_f32 v97, v106, v107
    v_lshlrev_b32 v104, 16, v161
    v_lshlrev_b32 v105, 16, v165
    v_cvt_pk_f16_f32 v98, v104, v105
    v_lshlrev_b32 v106, 16, v169
    v_lshlrev_b32 v107, 16, v173
    v_cvt_pk_f16_f32 v99, v106, v107
    ds_write_b128 v8, v[96:99] offset:0
    v_and_b32 v104, 0xffff0000, v145
    v_and_b32 v105, 0xffff0000, v149
    v_cvt_pk_f16_f32 v100, v104, v105
    v_and_b32 v106, 0xffff0000, v153
    v_and_b32 v107, 0xffff0000, v157
    v_cvt_pk_f16_f32 v101, v106, v107
    v_and_b32 v104, 0xffff0000, v161
    v_and_b32 v105, 0xffff0000, v165
    v_cvt_pk_f16_f32 v102, v104, v105
    v_and_b32 v106, 0xffff0000, v169
    v_and_b32 v107, 0xffff0000, v173
    v_cvt_pk_f16_f32 v103, v106, v107
    ds_write_b128 v8, v[100:103] offset:10240
    v_lshlrev_b32 v104, 16, v146
    v_lshlrev_b32 v105, 16, v150
    v_cvt_pk_f16_f32 v96, v104, v105
    v_lshlrev_b32 v106, 16, v154
    v_lshlrev_b32 v107, 16, v158
    v_cvt_pk_f16_f32 v97, v106, v107
    v_lshlrev_b32 v104, 16, v162
    v_lshlrev_b32 v105, 16, v166
    v_cvt_pk_f16_f32 v98, v104, v105
    v_lshlrev_b32 v106, 16, v170
    v_lshlrev_b32 v107, 16, v174
    v_cvt_pk_f16_f32 v99, v106, v107
    ds_write_b128 v7, v[96:99] offset:32
    v_and_b32 v104, 0xffff0000, v146
    v_and_b32 v105, 0xffff0000, v150
    v_cvt_pk_f16_f32 v100, v104, v105
    v_and_b32 v106, 0xffff0000, v154
    v_and_b32 v107, 0xffff0000, v158
    v_cvt_pk_f16_f32 v101, v106, v107
    v_and_b32 v104, 0xffff0000, v162
    v_and_b32 v105, 0xffff0000, v166
    v_cvt_pk_f16_f32 v102, v104, v105
    v_and_b32 v106, 0xffff0000, v170
    v_and_b32 v107, 0xffff0000, v174
    v_cvt_pk_f16_f32 v103, v106, v107
    ds_write_b128 v7, v[100:103] offset:10272
    v_lshlrev_b32 v104, 16, v147
    v_lshlrev_b32 v105, 16, v151
    v_cvt_pk_f16_f32 v96, v104, v105
    v_lshlrev_b32 v106, 16, v155
    v_lshlrev_b32 v107, 16, v159
    v_cvt_pk_f16_f32 v97, v106, v107
    v_lshlrev_b32 v104, 16, v163
    v_lshlrev_b32 v105, 16, v167
    v_cvt_pk_f16_f32 v98, v104, v105
    v_lshlrev_b32 v106, 16, v171
    v_lshlrev_b32 v107, 16, v175
    v_cvt_pk_f16_f32 v99, v106, v107
    ds_write_b128 v8, v[96:99] offset:32
    v_and_b32 v104, 0xffff0000, v147
    v_and_b32 v105, 0xffff0000, v151
    v_cvt_pk_f16_f32 v100, v104, v105
    v_and_b32 v106, 0xffff0000, v155
    v_and_b32 v107, 0xffff0000, v159
    v_cvt_pk_f16_f32 v101, v106, v107
    v_and_b32 v104, 0xffff0000, v163
    v_and_b32 v105, 0xffff0000, v167
    v_cvt_pk_f16_f32 v102, v104, v105
    v_and_b32 v106, 0xffff0000, v171
    v_and_b32 v107, 0xffff0000, v175
    v_cvt_pk_f16_f32 v103, v106, v107
    ds_write_b128 v8, v[100:103] offset:10272
    s_waitcnt vmcnt(24)
    s_lshl_b32 s24, s55, 10
    v_add_u32 v7, s24, v11
    v_xor_b32 v8, 16, v7
    v_lshlrev_b32 v104, 16, v176
    v_lshlrev_b32 v105, 16, v180
    v_cvt_pk_f16_f32 v96, v104, v105
    v_lshlrev_b32 v106, 16, v184
    v_lshlrev_b32 v107, 16, v188
    v_cvt_pk_f16_f32 v97, v106, v107
    v_lshlrev_b32 v104, 16, v192
    v_lshlrev_b32 v105, 16, v196
    v_cvt_pk_f16_f32 v98, v104, v105
    v_lshlrev_b32 v106, 16, v200
    v_lshlrev_b32 v107, 16, v204
    v_cvt_pk_f16_f32 v99, v106, v107
    ds_write_b128 v7, v[96:99] offset:0
    v_and_b32 v104, 0xffff0000, v176
    v_and_b32 v105, 0xffff0000, v180
    v_cvt_pk_f16_f32 v100, v104, v105
    v_and_b32 v106, 0xffff0000, v184
    v_and_b32 v107, 0xffff0000, v188
    v_cvt_pk_f16_f32 v101, v106, v107
    v_and_b32 v104, 0xffff0000, v192
    v_and_b32 v105, 0xffff0000, v196
    v_cvt_pk_f16_f32 v102, v104, v105
    v_and_b32 v106, 0xffff0000, v200
    v_and_b32 v107, 0xffff0000, v204
    v_cvt_pk_f16_f32 v103, v106, v107
    ds_write_b128 v7, v[100:103] offset:10240
    v_lshlrev_b32 v104, 16, v177
    v_lshlrev_b32 v105, 16, v181
    v_cvt_pk_f16_f32 v96, v104, v105
    v_lshlrev_b32 v106, 16, v185
    v_lshlrev_b32 v107, 16, v189
    v_cvt_pk_f16_f32 v97, v106, v107
    v_lshlrev_b32 v104, 16, v193
    v_lshlrev_b32 v105, 16, v197
    v_cvt_pk_f16_f32 v98, v104, v105
    v_lshlrev_b32 v106, 16, v201
    v_lshlrev_b32 v107, 16, v205
    v_cvt_pk_f16_f32 v99, v106, v107
    ds_write_b128 v8, v[96:99] offset:0
    v_and_b32 v104, 0xffff0000, v177
    v_and_b32 v105, 0xffff0000, v181
    v_cvt_pk_f16_f32 v100, v104, v105
    v_and_b32 v106, 0xffff0000, v185
    v_and_b32 v107, 0xffff0000, v189
    v_cvt_pk_f16_f32 v101, v106, v107
    v_and_b32 v104, 0xffff0000, v193
    v_and_b32 v105, 0xffff0000, v197
    v_cvt_pk_f16_f32 v102, v104, v105
    v_and_b32 v106, 0xffff0000, v201
    v_and_b32 v107, 0xffff0000, v205
    v_cvt_pk_f16_f32 v103, v106, v107
    ds_write_b128 v8, v[100:103] offset:10240
    v_lshlrev_b32 v104, 16, v178
    v_lshlrev_b32 v105, 16, v182
    v_cvt_pk_f16_f32 v96, v104, v105
    v_lshlrev_b32 v106, 16, v186
    v_lshlrev_b32 v107, 16, v190
    v_cvt_pk_f16_f32 v97, v106, v107
    v_lshlrev_b32 v104, 16, v194
    v_lshlrev_b32 v105, 16, v198
    v_cvt_pk_f16_f32 v98, v104, v105
    v_lshlrev_b32 v106, 16, v202
    v_lshlrev_b32 v107, 16, v206
    v_cvt_pk_f16_f32 v99, v106, v107
    ds_write_b128 v7, v[96:99] offset:32
    v_and_b32 v104, 0xffff0000, v178
    v_and_b32 v105, 0xffff0000, v182
    v_cvt_pk_f16_f32 v100, v104, v105
    v_and_b32 v106, 0xffff0000, v186
    v_and_b32 v107, 0xffff0000, v190
    v_cvt_pk_f16_f32 v101, v106, v107
    v_and_b32 v104, 0xffff0000, v194
    v_and_b32 v105, 0xffff0000, v198
    v_cvt_pk_f16_f32 v102, v104, v105
    v_and_b32 v106, 0xffff0000, v202
    v_and_b32 v107, 0xffff0000, v206
    v_cvt_pk_f16_f32 v103, v106, v107
    ds_write_b128 v7, v[100:103] offset:10272
    v_lshlrev_b32 v104, 16, v179
    v_lshlrev_b32 v105, 16, v183
    v_cvt_pk_f16_f32 v96, v104, v105
    v_lshlrev_b32 v106, 16, v187
    v_lshlrev_b32 v107, 16, v191
    v_cvt_pk_f16_f32 v97, v106, v107
    v_lshlrev_b32 v104, 16, v195
    v_lshlrev_b32 v105, 16, v199
    v_cvt_pk_f16_f32 v98, v104, v105
    v_lshlrev_b32 v106, 16, v203
    v_lshlrev_b32 v107, 16, v207
    v_cvt_pk_f16_f32 v99, v106, v107
    ds_write_b128 v8, v[96:99] offset:32
    v_and_b32 v104, 0xffff0000, v179
    v_and_b32 v105, 0xffff0000, v183
    v_cvt_pk_f16_f32 v100, v104, v105
    v_and_b32 v106, 0xffff0000, v187
    v_and_b32 v107, 0xffff0000, v191
    v_cvt_pk_f16_f32 v101, v106, v107
    v_and_b32 v104, 0xffff0000, v195
    v_and_b32 v105, 0xffff0000, v199
    v_cvt_pk_f16_f32 v102, v104, v105
    v_and_b32 v106, 0xffff0000, v203
    v_and_b32 v107, 0xffff0000, v207
    v_cvt_pk_f16_f32 v103, v106, v107
    ds_write_b128 v8, v[100:103] offset:10272
    s_mov_b32 s27, 0
    buffer_load_dwordx2 v[112:113], v108, s[36:39], s27 offen
    s_mov_b32 s27, 8192
    buffer_load_dwordx2 v[114:115], v108, s[36:39], s27 offen
    s_mov_b32 s27, 65536
    buffer_load_dwordx2 v[116:117], v108, s[36:39], s27 offen
    s_mov_b32 s27, 73728
    buffer_load_dwordx2 v[118:119], v108, s[36:39], s27 offen
    s_mov_b32 s27, 16384
    buffer_load_dwordx2 v[120:121], v108, s[36:39], s27 offen
    s_mov_b32 s27, 24576
    buffer_load_dwordx2 v[122:123], v108, s[36:39], s27 offen
    s_mov_b32 s27, 81920
    buffer_load_dwordx2 v[124:125], v108, s[36:39], s27 offen
    s_mov_b32 s27, 90112
    buffer_load_dwordx2 v[126:127], v108, s[36:39], s27 offen
    s_mov_b32 s27, 262144
    buffer_load_dwordx2 v[128:129], v108, s[36:39], s27 offen
    s_mov_b32 s27, 270336
    buffer_load_dwordx2 v[130:131], v108, s[36:39], s27 offen
    s_mov_b32 s27, 327680
    buffer_load_dwordx2 v[132:133], v108, s[36:39], s27 offen
    s_mov_b32 s27, 335872
    buffer_load_dwordx2 v[134:135], v108, s[36:39], s27 offen
    s_mov_b32 s27, 278528
    buffer_load_dwordx2 v[136:137], v108, s[36:39], s27 offen
    s_mov_b32 s27, 286720
    buffer_load_dwordx2 v[138:139], v108, s[36:39], s27 offen
    s_mov_b32 s27, 344064
    buffer_load_dwordx2 v[140:141], v108, s[36:39], s27 offen
    s_mov_b32 s27, 352256
    buffer_load_dwordx2 v[142:143], v108, s[36:39], s27 offen
    s_mov_b32 s27, 524288
    buffer_load_dwordx2 v[144:145], v108, s[36:39], s27 offen
    s_mov_b32 s27, 532480
    buffer_load_dwordx2 v[146:147], v108, s[36:39], s27 offen
    s_mov_b32 s27, 589824
    buffer_load_dwordx2 v[148:149], v108, s[36:39], s27 offen
    s_mov_b32 s27, 598016
    buffer_load_dwordx2 v[150:151], v108, s[36:39], s27 offen
    s_mov_b32 s27, 540672
    buffer_load_dwordx2 v[152:153], v108, s[36:39], s27 offen
    s_mov_b32 s27, 548864
    buffer_load_dwordx2 v[154:155], v108, s[36:39], s27 offen
    s_mov_b32 s27, 606208
    buffer_load_dwordx2 v[156:157], v108, s[36:39], s27 offen
    s_mov_b32 s27, 614400
    buffer_load_dwordx2 v[158:159], v108, s[36:39], s27 offen
    s_mov_b32 s27, 786432
    buffer_load_dwordx2 v[160:161], v108, s[36:39], s27 offen
    s_mov_b32 s27, 794624
    buffer_load_dwordx2 v[162:163], v108, s[36:39], s27 offen
    s_mov_b32 s27, 851968
    buffer_load_dwordx2 v[164:165], v108, s[36:39], s27 offen
    s_mov_b32 s27, 860160
    buffer_load_dwordx2 v[166:167], v108, s[36:39], s27 offen
    s_mov_b32 s27, 802816
    buffer_load_dwordx2 v[168:169], v108, s[36:39], s27 offen
    s_mov_b32 s27, 811008
    buffer_load_dwordx2 v[170:171], v108, s[36:39], s27 offen
    s_mov_b32 s27, 868352
    buffer_load_dwordx2 v[172:173], v108, s[36:39], s27 offen
    s_mov_b32 s27, 876544
    buffer_load_dwordx2 v[174:175], v108, s[36:39], s27 offen
    s_mov_b32 s27, 1048576
    buffer_load_dwordx2 v[176:177], v108, s[36:39], s27 offen
    s_mov_b32 s27, 1056768
    buffer_load_dwordx2 v[178:179], v108, s[36:39], s27 offen
    s_mov_b32 s27, 1114112
    buffer_load_dwordx2 v[180:181], v108, s[36:39], s27 offen
    s_mov_b32 s27, 1122304
    buffer_load_dwordx2 v[182:183], v108, s[36:39], s27 offen
    s_mov_b32 s27, 1064960
    buffer_load_dwordx2 v[184:185], v108, s[36:39], s27 offen
    s_mov_b32 s27, 1073152
    buffer_load_dwordx2 v[186:187], v108, s[36:39], s27 offen
    s_mov_b32 s27, 1130496
    buffer_load_dwordx2 v[188:189], v108, s[36:39], s27 offen
    s_mov_b32 s27, 1138688
    buffer_load_dwordx2 v[190:191], v108, s[36:39], s27 offen
    s_waitcnt lgkmcnt(0)
    s_barrier
    s_mul_i32 s24, s22, 20512
    s_lshl_b32 s25, s64, 1
    s_sub_u32 s25, s25, 0
    s_cmp_lt_u32 s25, 10240
    s_cbranch_scc0 L_qskip_3
    s_add_u32 s25, s25, s24
    v_add_u32 v9, s25, v12
    ds_read_b128 a[80:83], v9 offset:0
    ds_read_b128 a[84:87], v9 offset:1024
    ds_read_b128 a[160:163], v9 offset:10240
    ds_read_b128 a[164:167], v9 offset:11264
L_qskip_3:
    s_lshl_b32 s25, s65, 1
    s_sub_u32 s25, s25, 0
    s_cmp_lt_u32 s25, 10240
    s_cbranch_scc0 L_qskip_4
    s_add_u32 s25, s25, s24
    v_add_u32 v9, s25, v12
    ds_read_b128 a[88:91], v9 offset:0
    ds_read_b128 a[92:95], v9 offset:1024
    ds_read_b128 a[168:171], v9 offset:10240
    ds_read_b128 a[172:175], v9 offset:11264
L_qskip_4:
    s_lshl_b32 s25, s66, 1
    s_sub_u32 s25, s25, 0
    s_cmp_lt_u32 s25, 10240
    s_cbranch_scc0 L_qskip_5
    s_add_u32 s25, s25, s24
    v_add_u32 v9, s25, v12
    ds_read_b128 a[96:99], v9 offset:0
    ds_read_b128 a[100:103], v9 offset:1024
    ds_read_b128 a[176:179], v9 offset:10240
    ds_read_b128 a[180:183], v9 offset:11264
L_qskip_5:
    s_lshl_b32 s25, s67, 1
    s_sub_u32 s25, s25, 0
    s_cmp_lt_u32 s25, 10240
    s_cbranch_scc0 L_qskip_6
    s_add_u32 s25, s25, s24
    v_add_u32 v9, s25, v12
    ds_read_b128 a[104:107], v9 offset:0
    ds_read_b128 a[108:111], v9 offset:1024
    ds_read_b128 a[184:187], v9 offset:10240
    ds_read_b128 a[188:191], v9 offset:11264
L_qskip_6:
    s_lshl_b32 s25, s68, 1
    s_sub_u32 s25, s25, 0
    s_cmp_lt_u32 s25, 10240
    s_cbranch_scc0 L_qskip_7
    s_add_u32 s25, s25, s24
    v_add_u32 v9, s25, v12
    ds_read_b128 a[112:115], v9 offset:0
    ds_read_b128 a[116:119], v9 offset:1024
    ds_read_b128 a[192:195], v9 offset:10240
    ds_read_b128 a[196:199], v9 offset:11264
L_qskip_7:
    s_lshl_b32 s25, s69, 1
    s_sub_u32 s25, s25, 0
    s_cmp_lt_u32 s25, 10240
    s_cbranch_scc0 L_qskip_8
    s_add_u32 s25, s25, s24
    v_add_u32 v9, s25, v12
    ds_read_b128 a[120:123], v9 offset:0
    ds_read_b128 a[124:127], v9 offset:1024
    ds_read_b128 a[200:203], v9 offset:10240
    ds_read_b128 a[204:207], v9 offset:11264
L_qskip_8:
    s_lshl_b32 s25, s70, 1
    s_sub_u32 s25, s25, 0
    s_cmp_lt_u32 s25, 10240
    s_cbranch_scc0 L_qskip_9
    s_add_u32 s25, s25, s24
    v_add_u32 v9, s25, v12
    ds_read_b128 a[128:131], v9 offset:0
    ds_read_b128 a[132:135], v9 offset:1024
    ds_read_b128 a[208:211], v9 offset:10240
    ds_read_b128 a[212:215], v9 offset:11264
L_qskip_9:
    s_lshl_b32 s25, s71, 1
    s_sub_u32 s25, s25, 0
    s_cmp_lt_u32 s25, 10240
    s_cbranch_scc0 L_qskip_10
    s_add_u32 s25, s25, s24
    v_add_u32 v9, s25, v12
    ds_read_b128 a[136:139], v9 offset:0
    ds_read_b128 a[140:143], v9 offset:1024
    ds_read_b128 a[216:219], v9 offset:10240
    ds_read_b128 a[220:223], v9 offset:11264
L_qskip_10:
    s_lshl_b32 s25, s72, 1
    s_sub_u32 s25, s25, 0
    s_cmp_lt_u32 s25, 10240
    s_cbranch_scc0 L_qskip_11
    s_add_u32 s25, s25, s24
    v_add_u32 v9, s25, v12
    ds_read_b128 a[144:147], v9 offset:0
    ds_read_b128 a[148:151], v9 offset:1024
    ds_read_b128 a[224:227], v9 offset:10240
    ds_read_b128 a[228:231], v9 offset:11264
L_qskip_11:
    s_lshl_b32 s25, s73, 1
    s_sub_u32 s25, s25, 0
    s_cmp_lt_u32 s25, 10240
    s_cbranch_scc0 L_qskip_12
    s_add_u32 s25, s25, s24
    v_add_u32 v9, s25, v12
    ds_read_b128 a[152:155], v9 offset:0
    ds_read_b128 a[156:159], v9 offset:1024
    ds_read_b128 a[232:235], v9 offset:10240
    ds_read_b128 a[236:239], v9 offset:11264
L_qskip_12:
    s_waitcnt lgkmcnt(0)
    s_barrier
    s_waitcnt vmcnt(56)
    s_lshl_b32 s24, s53, 10
    v_add_u32 v7, s24, v11
    v_xor_b32 v8, 16, v7
    v_lshlrev_b32 v104, 16, v16
    v_lshlrev_b32 v105, 16, v20
    v_cvt_pk_f16_f32 v96, v104, v105
    v_lshlrev_b32 v106, 16, v24
    v_lshlrev_b32 v107, 16, v28
    v_cvt_pk_f16_f32 v97, v106, v107
    v_lshlrev_b32 v104, 16, v32
    v_lshlrev_b32 v105, 16, v36
    v_cvt_pk_f16_f32 v98, v104, v105
    v_lshlrev_b32 v106, 16, v40
    v_lshlrev_b32 v107, 16, v44
    v_cvt_pk_f16_f32 v99, v106, v107
    ds_write_b128 v7, v[96:99] offset:0
    v_and_b32 v104, 0xffff0000, v16
    v_and_b32 v105, 0xffff0000, v20
    v_cvt_pk_f16_f32 v100, v104, v105
    v_and_b32 v106, 0xffff0000, v24
    v_and_b32 v107, 0xffff0000, v28
    v_cvt_pk_f16_f32 v101, v106, v107
    v_and_b32 v104, 0xffff0000, v32
    v_and_b32 v105, 0xffff0000, v36
    v_cvt_pk_f16_f32 v102, v104, v105
    v_and_b32 v106, 0xffff0000, v40
    v_and_b32 v107, 0xffff0000, v44
    v_cvt_pk_f16_f32 v103, v106, v107
    ds_write_b128 v7, v[100:103] offset:10240
    v_lshlrev_b32 v104, 16, v17
    v_lshlrev_b32 v105, 16, v21
    v_cvt_pk_f16_f32 v96, v104, v105
    v_lshlrev_b32 v106, 16, v25
    v_lshlrev_b32 v107, 16, v29
    v_cvt_pk_f16_f32 v97, v106, v107
    v_lshlrev_b32 v104, 16, v33
    v_lshlrev_b32 v105, 16, v37
    v_cvt_pk_f16_f32 v98, v104, v105
    v_lshlrev_b32 v106, 16, v41
    v_lshlrev_b32 v107, 16, v45
    v_cvt_pk_f16_f32 v99, v106, v107
    ds_write_b128 v8, v[96:99] offset:0
    v_and_b32 v104, 0xffff0000, v17
    v_and_b32 v105, 0xffff0000, v21
    v_cvt_pk_f16_f32 v100, v104, v105
    v_and_b32 v106, 0xffff0000, v25
    v_and_b32 v107, 0xffff0000, v29
    v_cvt_pk_f16_f32 v101, v106, v107
    v_and_b32 v104, 0xffff0000, v33
    v_and_b32 v105, 0xffff0000, v37
    v_cvt_pk_f16_f32 v102, v104, v105
    v_and_b32 v106, 0xffff0000, v41
    v_and_b32 v107, 0xffff0000, v45
    v_cvt_pk_f16_f32 v103, v106, v107
    ds_write_b128 v8, v[100:103] offset:10240
    v_lshlrev_b32 v104, 16, v18
    v_lshlrev_b32 v105, 16, v22
    v_cvt_pk_f16_f32 v96, v104, v105
    v_lshlrev_b32 v106, 16, v26
    v_lshlrev_b32 v107, 16, v30
    v_cvt_pk_f16_f32 v97, v106, v107
    v_lshlrev_b32 v104, 16, v34
    v_lshlrev_b32 v105, 16, v38
    v_cvt_pk_f16_f32 v98, v104, v105
    v_lshlrev_b32 v106, 16, v42
    v_lshlrev_b32 v107, 16, v46
    v_cvt_pk_f16_f32 v99, v106, v107
    ds_write_b128 v7, v[96:99] offset:32
    v_and_b32 v104, 0xffff0000, v18
    v_and_b32 v105, 0xffff0000, v22
    v_cvt_pk_f16_f32 v100, v104, v105
    v_and_b32 v106, 0xffff0000, v26
    v_and_b32 v107, 0xffff0000, v30
    v_cvt_pk_f16_f32 v101, v106, v107
    v_and_b32 v104, 0xffff0000, v34
    v_and_b32 v105, 0xffff0000, v38
    v_cvt_pk_f16_f32 v102, v104, v105
    v_and_b32 v106, 0xffff0000, v42
    v_and_b32 v107, 0xffff0000, v46
    v_cvt_pk_f16_f32 v103, v106, v107
    ds_write_b128 v7, v[100:103] offset:10272
    v_lshlrev_b32 v104, 16, v19
    v_lshlrev_b32 v105, 16, v23
    v_cvt_pk_f16_f32 v96, v104, v105
    v_lshlrev_b32 v106, 16, v27
    v_lshlrev_b32 v107, 16, v31
    v_cvt_pk_f16_f32 v97, v106, v107
    v_lshlrev_b32 v104, 16, v35
    v_lshlrev_b32 v105, 16, v39
    v_cvt_pk_f16_f32 v98, v104, v105
    v_lshlrev_b32 v106, 16, v43
    v_lshlrev_b32 v107, 16, v47
    v_cvt_pk_f16_f32 v99, v106, v107
    ds_write_b128 v8, v[96:99] offset:32
    v_and_b32 v104, 0xffff0000, v19
    v_and_b32 v105, 0xffff0000, v23
    v_cvt_pk_f16_f32 v100, v104, v105
    v_and_b32 v106, 0xffff0000, v27
    v_and_b32 v107, 0xffff0000, v31
    v_cvt_pk_f16_f32 v101, v106, v107
    v_and_b32 v104, 0xffff0000, v35
    v_and_b32 v105, 0xffff0000, v39
    v_cvt_pk_f16_f32 v102, v104, v105
    v_and_b32 v106, 0xffff0000, v43
    v_and_b32 v107, 0xffff0000, v47
    v_cvt_pk_f16_f32 v103, v106, v107
    ds_write_b128 v8, v[100:103] offset:10272
    s_waitcnt vmcnt(48)
    s_lshl_b32 s24, s54, 10
    v_add_u32 v7, s24, v11
    v_xor_b32 v8, 16, v7
    v_lshlrev_b32 v104, 16, v48
    v_lshlrev_b32 v105, 16, v52
    v_cvt_pk_f16_f32 v96, v104, v105
    v_lshlrev_b32 v106, 16, v56
    v_lshlrev_b32 v107, 16, v60
    v_cvt_pk_f16_f32 v97, v106, v107
    v_lshlrev_b32 v104, 16, v64
    v_lshlrev_b32 v105, 16, v68
    v_cvt_pk_f16_f32 v98, v104, v105
    v_lshlrev_b32 v106, 16, v72
    v_lshlrev_b32 v107, 16, v76
    v_cvt_pk_f16_f32 v99, v106, v107
    ds_write_b128 v7, v[96:99] offset:0
    v_and_b32 v104, 0xffff0000, v48
    v_and_b32 v105, 0xffff0000, v52
    v_cvt_pk_f16_f32 v100, v104, v105
    v_and_b32 v106, 0xffff0000, v56
    v_and_b32 v107, 0xffff0000, v60
    v_cvt_pk_f16_f32 v101, v106, v107
    v_and_b32 v104, 0xffff0000, v64
    v_and_b32 v105, 0xffff0000, v68
    v_cvt_pk_f16_f32 v102, v104, v105
    v_and_b32 v106, 0xffff0000, v72
    v_and_b32 v107, 0xffff0000, v76
    v_cvt_pk_f16_f32 v103, v106, v107
    ds_write_b128 v7, v[100:103] offset:10240
    v_lshlrev_b32 v104, 16, v49
    v_lshlrev_b32 v105, 16, v53
    v_cvt_pk_f16_f32 v96, v104, v105
    v_lshlrev_b32 v106, 16, v57
    v_lshlrev_b32 v107, 16, v61
    v_cvt_pk_f16_f32 v97, v106, v107
    v_lshlrev_b32 v104, 16, v65
    v_lshlrev_b32 v105, 16, v69
    v_cvt_pk_f16_f32 v98, v104, v105
    v_lshlrev_b32 v106, 16, v73
    v_lshlrev_b32 v107, 16, v77
    v_cvt_pk_f16_f32 v99, v106, v107
    ds_write_b128 v8, v[96:99] offset:0
    v_and_b32 v104, 0xffff0000, v49
    v_and_b32 v105, 0xffff0000, v53
    v_cvt_pk_f16_f32 v100, v104, v105
    v_and_b32 v106, 0xffff0000, v57
    v_and_b32 v107, 0xffff0000, v61
    v_cvt_pk_f16_f32 v101, v106, v107
    v_and_b32 v104, 0xffff0000, v65
    v_and_b32 v105, 0xffff0000, v69
    v_cvt_pk_f16_f32 v102, v104, v105
    v_and_b32 v106, 0xffff0000, v73
    v_and_b32 v107, 0xffff0000, v77
    v_cvt_pk_f16_f32 v103, v106, v107
    ds_write_b128 v8, v[100:103] offset:10240
    v_lshlrev_b32 v104, 16, v50
    v_lshlrev_b32 v105, 16, v54
    v_cvt_pk_f16_f32 v96, v104, v105
    v_lshlrev_b32 v106, 16, v58
    v_lshlrev_b32 v107, 16, v62
    v_cvt_pk_f16_f32 v97, v106, v107
    v_lshlrev_b32 v104, 16, v66
    v_lshlrev_b32 v105, 16, v70
    v_cvt_pk_f16_f32 v98, v104, v105
    v_lshlrev_b32 v106, 16, v74
    v_lshlrev_b32 v107, 16, v78
    v_cvt_pk_f16_f32 v99, v106, v107
    ds_write_b128 v7, v[96:99] offset:32
    v_and_b32 v104, 0xffff0000, v50
    v_and_b32 v105, 0xffff0000, v54
    v_cvt_pk_f16_f32 v100, v104, v105
    v_and_b32 v106, 0xffff0000, v58
    v_and_b32 v107, 0xffff0000, v62
    v_cvt_pk_f16_f32 v101, v106, v107
    v_and_b32 v104, 0xffff0000, v66
    v_and_b32 v105, 0xffff0000, v70
    v_cvt_pk_f16_f32 v102, v104, v105
    v_and_b32 v106, 0xffff0000, v74
    v_and_b32 v107, 0xffff0000, v78
    v_cvt_pk_f16_f32 v103, v106, v107
    ds_write_b128 v7, v[100:103] offset:10272
    v_lshlrev_b32 v104, 16, v51
    v_lshlrev_b32 v105, 16, v55
    v_cvt_pk_f16_f32 v96, v104, v105
    v_lshlrev_b32 v106, 16, v59
    v_lshlrev_b32 v107, 16, v63
    v_cvt_pk_f16_f32 v97, v106, v107
    v_lshlrev_b32 v104, 16, v67
    v_lshlrev_b32 v105, 16, v71
    v_cvt_pk_f16_f32 v98, v104, v105
    v_lshlrev_b32 v106, 16, v75
    v_lshlrev_b32 v107, 16, v79
    v_cvt_pk_f16_f32 v99, v106, v107
    ds_write_b128 v8, v[96:99] offset:32
    v_and_b32 v104, 0xffff0000, v51
    v_and_b32 v105, 0xffff0000, v55
    v_cvt_pk_f16_f32 v100, v104, v105
    v_and_b32 v106, 0xffff0000, v59
    v_and_b32 v107, 0xffff0000, v63
    v_cvt_pk_f16_f32 v101, v106, v107
    v_and_b32 v104, 0xffff0000, v67
    v_and_b32 v105, 0xffff0000, v71
    v_cvt_pk_f16_f32 v102, v104, v105
    v_and_b32 v106, 0xffff0000, v75
    v_and_b32 v107, 0xffff0000, v79
    v_cvt_pk_f16_f32 v103, v106, v107
    ds_write_b128 v8, v[100:103] offset:10272
    s_waitcnt vmcnt(40)
    s_lshl_b32 s24, s55, 10
    v_add_u32 v7, s24, v11
    v_xor_b32 v8, 16, v7
    v_lshlrev_b32 v104, 16, v208
    v_lshlrev_b32 v105, 16, v212
    v_cvt_pk_f16_f32 v96, v104, v105
    v_lshlrev_b32 v106, 16, v216
    v_lshlrev_b32 v107, 16, v220
    v_cvt_pk_f16_f32 v97, v106, v107
    v_lshlrev_b32 v104, 16, v224
    v_lshlrev_b32 v105, 16, v228
    v_cvt_pk_f16_f32 v98, v104, v105
    v_lshlrev_b32 v106, 16, v232
    v_lshlrev_b32 v107, 16, v236
    v_cvt_pk_f16_f32 v99, v106, v107
    ds_write_b128 v7, v[96:99] offset:0
    v_and_b32 v104, 0xffff0000, v208
    v_and_b32 v105, 0xffff0000, v212
    v_cvt_pk_f16_f32 v100, v104, v105
    v_and_b32 v106, 0xffff0000, v216
    v_and_b32 v107, 0xffff0000, v220
    v_cvt_pk_f16_f32 v101, v106, v107
    v_and_b32 v104, 0xffff0000, v224
    v_and_b32 v105, 0xffff0000, v228
    v_cvt_pk_f16_f32 v102, v104, v105
    v_and_b32 v106, 0xffff0000, v232
    v_and_b32 v107, 0xffff0000, v236
    v_cvt_pk_f16_f32 v103, v106, v107
    ds_write_b128 v7, v[100:103] offset:10240
    v_lshlrev_b32 v104, 16, v209
    v_lshlrev_b32 v105, 16, v213
    v_cvt_pk_f16_f32 v96, v104, v105
    v_lshlrev_b32 v106, 16, v217
    v_lshlrev_b32 v107, 16, v221
    v_cvt_pk_f16_f32 v97, v106, v107
    v_lshlrev_b32 v104, 16, v225
    v_lshlrev_b32 v105, 16, v229
    v_cvt_pk_f16_f32 v98, v104, v105
    v_lshlrev_b32 v106, 16, v233
    v_lshlrev_b32 v107, 16, v237
    v_cvt_pk_f16_f32 v99, v106, v107
    ds_write_b128 v8, v[96:99] offset:0
    v_and_b32 v104, 0xffff0000, v209
    v_and_b32 v105, 0xffff0000, v213
    v_cvt_pk_f16_f32 v100, v104, v105
    v_and_b32 v106, 0xffff0000, v217
    v_and_b32 v107, 0xffff0000, v221
    v_cvt_pk_f16_f32 v101, v106, v107
    v_and_b32 v104, 0xffff0000, v225
    v_and_b32 v105, 0xffff0000, v229
    v_cvt_pk_f16_f32 v102, v104, v105
    v_and_b32 v106, 0xffff0000, v233
    v_and_b32 v107, 0xffff0000, v237
    v_cvt_pk_f16_f32 v103, v106, v107
    ds_write_b128 v8, v[100:103] offset:10240
    v_lshlrev_b32 v104, 16, v210
    v_lshlrev_b32 v105, 16, v214
    v_cvt_pk_f16_f32 v96, v104, v105
    v_lshlrev_b32 v106, 16, v218
    v_lshlrev_b32 v107, 16, v222
    v_cvt_pk_f16_f32 v97, v106, v107
    v_lshlrev_b32 v104, 16, v226
    v_lshlrev_b32 v105, 16, v230
    v_cvt_pk_f16_f32 v98, v104, v105
    v_lshlrev_b32 v106, 16, v234
    v_lshlrev_b32 v107, 16, v238
    v_cvt_pk_f16_f32 v99, v106, v107
    ds_write_b128 v7, v[96:99] offset:32
    v_and_b32 v104, 0xffff0000, v210
    v_and_b32 v105, 0xffff0000, v214
    v_cvt_pk_f16_f32 v100, v104, v105
    v_and_b32 v106, 0xffff0000, v218
    v_and_b32 v107, 0xffff0000, v222
    v_cvt_pk_f16_f32 v101, v106, v107
    v_and_b32 v104, 0xffff0000, v226
    v_and_b32 v105, 0xffff0000, v230
    v_cvt_pk_f16_f32 v102, v104, v105
    v_and_b32 v106, 0xffff0000, v234
    v_and_b32 v107, 0xffff0000, v238
    v_cvt_pk_f16_f32 v103, v106, v107
    ds_write_b128 v7, v[100:103] offset:10272
    v_lshlrev_b32 v104, 16, v211
    v_lshlrev_b32 v105, 16, v215
    v_cvt_pk_f16_f32 v96, v104, v105
    v_lshlrev_b32 v106, 16, v219
    v_lshlrev_b32 v107, 16, v223
    v_cvt_pk_f16_f32 v97, v106, v107
    v_lshlrev_b32 v104, 16, v227
    v_lshlrev_b32 v105, 16, v231
    v_cvt_pk_f16_f32 v98, v104, v105
    v_lshlrev_b32 v106, 16, v235
    v_lshlrev_b32 v107, 16, v239
    v_cvt_pk_f16_f32 v99, v106, v107
    ds_write_b128 v8, v[96:99] offset:32
    v_and_b32 v104, 0xffff0000, v211
    v_and_b32 v105, 0xffff0000, v215
    v_cvt_pk_f16_f32 v100, v104, v105
    v_and_b32 v106, 0xffff0000, v219
    v_and_b32 v107, 0xffff0000, v223
    v_cvt_pk_f16_f32 v101, v106, v107
    v_and_b32 v104, 0xffff0000, v227
    v_and_b32 v105, 0xffff0000, v231
    v_cvt_pk_f16_f32 v102, v104, v105
    v_and_b32 v106, 0xffff0000, v235
    v_and_b32 v107, 0xffff0000, v239
    v_cvt_pk_f16_f32 v103, v106, v107
    ds_write_b128 v8, v[100:103] offset:10272
    s_mov_b32 s25, 1280
    v_and_b32 v109, 1, v3
    v_lshlrev_b32 v109, 4, v109
    v_lshrrev_b32 v6, 1, v3
    v_add_u32 v109, v109, v6
    v_mul_lo_u32 v109, v109, s25
    s_lshl_b32 s25, s51, 7
    s_lshl_b32 s26, s52, 6
    s_add_u32 s25, s25, s26
    s_mul_i32 s25, s25, 1280
    v_add_u32 v109, s25, v109
    v_lshl_add_u32 v6, v2, 4, v109
    s_lshl_b32 s26, s22, 8
    v_add_u32 v6, s26, v6
    v_lshl_add_u32 v109, v2, 2, v109
    s_lshl_b32 s26, s22, 6
    v_add_u32 v109, s26, v109
    s_mov_b32 s27, 0
    buffer_load_dwordx4 v[16:19], v6, s[40:43], s27 offen
    buffer_load_dword v80, v109, s[40:43], s27 offen offset:1024
    s_mov_b32 s27, 5120
    buffer_load_dwordx4 v[20:23], v6, s[40:43], s27 offen
    buffer_load_dword v81, v109, s[40:43], s27 offen offset:1024
    s_mov_b32 s27, 40960
    buffer_load_dwordx4 v[24:27], v6, s[40:43], s27 offen
    buffer_load_dword v82, v109, s[40:43], s27 offen offset:1024
    s_mov_b32 s27, 46080
    buffer_load_dwordx4 v[28:31], v6, s[40:43], s27 offen
    buffer_load_dword v83, v109, s[40:43], s27 offen offset:1024
    s_mov_b32 s27, 10240
    buffer_load_dwordx4 v[32:35], v6, s[40:43], s27 offen
    buffer_load_dword v84, v109, s[40:43], s27 offen offset:1024
    s_mov_b32 s27, 15360
    buffer_load_dwordx4 v[36:39], v6, s[40:43], s27 offen
    buffer_load_dword v85, v109, s[40:43], s27 offen offset:1024
    s_mov_b32 s27, 51200
    buffer_load_dwordx4 v[40:43], v6, s[40:43], s27 offen
    buffer_load_dword v86, v109, s[40:43], s27 offen offset:1024
    s_mov_b32 s27, 56320
    buffer_load_dwordx4 v[44:47], v6, s[40:43], s27 offen
    buffer_load_dword v87, v109, s[40:43], s27 offen offset:1024
    s_mov_b32 s27, 2560
    buffer_load_dwordx4 v[48:51], v6, s[40:43], s27 offen
    buffer_load_dword v88, v109, s[40:43], s27 offen offset:1024
    s_mov_b32 s27, 7680
    buffer_load_dwordx4 v[52:55], v6, s[40:43], s27 offen
    buffer_load_dword v89, v109, s[40:43], s27 offen offset:1024
    s_mov_b32 s27, 43520
    buffer_load_dwordx4 v[56:59], v6, s[40:43], s27 offen
    buffer_load_dword v90, v109, s[40:43], s27 offen offset:1024
    s_mov_b32 s27, 48640
    buffer_load_dwordx4 v[60:63], v6, s[40:43], s27 offen
    buffer_load_dword v91, v109, s[40:43], s27 offen offset:1024
    s_mov_b32 s27, 12800
    buffer_load_dwordx4 v[64:67], v6, s[40:43], s27 offen
    buffer_load_dword v92, v109, s[40:43], s27 offen offset:1024
    s_mov_b32 s27, 17920
    buffer_load_dwordx4 v[68:71], v6, s[40:43], s27 offen
    buffer_load_dword v93, v109, s[40:43], s27 offen offset:1024
    s_mov_b32 s27, 53760
    buffer_load_dwordx4 v[72:75], v6, s[40:43], s27 offen
    buffer_load_dword v94, v109, s[40:43], s27 offen offset:1024
    s_mov_b32 s27, 58880
    buffer_load_dwordx4 v[76:79], v6, s[40:43], s27 offen
    buffer_load_dword v95, v109, s[40:43], s27 offen offset:1024
    s_waitcnt lgkmcnt(0)
    s_barrier
    s_mul_i32 s24, s22, 20512
    s_lshl_b32 s25, s64, 1
    s_sub_u32 s25, s25, 10240
    s_cmp_lt_u32 s25, 10240
    s_cbranch_scc0 L_qskip_13
    s_add_u32 s25, s25, s24
    v_add_u32 v9, s25, v12
    ds_read_b128 a[80:83], v9 offset:0
    ds_read_b128 a[84:87], v9 offset:1024
    ds_read_b128 a[160:163], v9 offset:10240
    ds_read_b128 a[164:167], v9 offset:11264
L_qskip_13:
    s_lshl_b32 s25, s65, 1
    s_sub_u32 s25, s25, 10240
    s_cmp_lt_u32 s25, 10240
    s_cbranch_scc0 L_qskip_14
    s_add_u32 s25, s25, s24
    v_add_u32 v9, s25, v12
    ds_read_b128 a[88:91], v9 offset:0
    ds_read_b128 a[92:95], v9 offset:1024
    ds_read_b128 a[168:171], v9 offset:10240
    ds_read_b128 a[172:175], v9 offset:11264
L_qskip_14:
    s_lshl_b32 s25, s66, 1
    s_sub_u32 s25, s25, 10240
    s_cmp_lt_u32 s25, 10240
    s_cbranch_scc0 L_qskip_15
    s_add_u32 s25, s25, s24
    v_add_u32 v9, s25, v12
    ds_read_b128 a[96:99], v9 offset:0
    ds_read_b128 a[100:103], v9 offset:1024
    ds_read_b128 a[176:179], v9 offset:10240
    ds_read_b128 a[180:183], v9 offset:11264
L_qskip_15:
    s_lshl_b32 s25, s67, 1
    s_sub_u32 s25, s25, 10240
    s_cmp_lt_u32 s25, 10240
    s_cbranch_scc0 L_qskip_16
    s_add_u32 s25, s25, s24
    v_add_u32 v9, s25, v12
    ds_read_b128 a[104:107], v9 offset:0
    ds_read_b128 a[108:111], v9 offset:1024
    ds_read_b128 a[184:187], v9 offset:10240
    ds_read_b128 a[188:191], v9 offset:11264
L_qskip_16:
    s_lshl_b32 s25, s68, 1
    s_sub_u32 s25, s25, 10240
    s_cmp_lt_u32 s25, 10240
    s_cbranch_scc0 L_qskip_17
    s_add_u32 s25, s25, s24
    v_add_u32 v9, s25, v12
    ds_read_b128 a[112:115], v9 offset:0
    ds_read_b128 a[116:119], v9 offset:1024
    ds_read_b128 a[192:195], v9 offset:10240
    ds_read_b128 a[196:199], v9 offset:11264
L_qskip_17:
    s_lshl_b32 s25, s69, 1
    s_sub_u32 s25, s25, 10240
    s_cmp_lt_u32 s25, 10240
    s_cbranch_scc0 L_qskip_18
    s_add_u32 s25, s25, s24
    v_add_u32 v9, s25, v12
    ds_read_b128 a[120:123], v9 offset:0
    ds_read_b128 a[124:127], v9 offset:1024
    ds_read_b128 a[200:203], v9 offset:10240
    ds_read_b128 a[204:207], v9 offset:11264
L_qskip_18:
    s_lshl_b32 s25, s70, 1
    s_sub_u32 s25, s25, 10240
    s_cmp_lt_u32 s25, 10240
    s_cbranch_scc0 L_qskip_19
    s_add_u32 s25, s25, s24
    v_add_u32 v9, s25, v12
    ds_read_b128 a[128:131], v9 offset:0
    ds_read_b128 a[132:135], v9 offset:1024
    ds_read_b128 a[208:211], v9 offset:10240
    ds_read_b128 a[212:215], v9 offset:11264
L_qskip_19:
    s_lshl_b32 s25, s71, 1
    s_sub_u32 s25, s25, 10240
    s_cmp_lt_u32 s25, 10240
    s_cbranch_scc0 L_qskip_20
    s_add_u32 s25, s25, s24
    v_add_u32 v9, s25, v12
    ds_read_b128 a[136:139], v9 offset:0
    ds_read_b128 a[140:143], v9 offset:1024
    ds_read_b128 a[216:219], v9 offset:10240
    ds_read_b128 a[220:223], v9 offset:11264
L_qskip_20:
    s_lshl_b32 s25, s72, 1
    s_sub_u32 s25, s25, 10240
    s_cmp_lt_u32 s25, 10240
    s_cbranch_scc0 L_qskip_21
    s_add_u32 s25, s25, s24
    v_add_u32 v9, s25, v12
    ds_read_b128 a[144:147], v9 offset:0
    ds_read_b128 a[148:151], v9 offset:1024
    ds_read_b128 a[224:227], v9 offset:10240
    ds_read_b128 a[228:231], v9 offset:11264
L_qskip_21:
    s_lshl_b32 s25, s73, 1
    s_sub_u32 s25, s25, 10240
    s_cmp_lt_u32 s25, 10240
    s_cbranch_scc0 L_qskip_22
    s_add_u32 s25, s25, s24
    v_add_u32 v9, s25, v12
    ds_read_b128 a[152:155], v9 offset:0
    ds_read_b128 a[156:159], v9 offset:1024
    ds_read_b128 a[232:235], v9 offset:10240
    ds_read_b128 a[236:239], v9 offset:11264
L_qskip_22:
    s_waitcnt lgkmcnt(0)
    s_mul_i32 s26, s22, 5120
    v_add_u32 v7, s26, v5
    v_add_u32 v8, 0xa000, v7
    s_barrier
    s_waitcnt vmcnt(63)
    v_lshlrev_b32 v104, 16, v112
    v_lshlrev_b32 v105, 16, v114
    v_cvt_pk_f16_f32 v96, v104, v105
    v_lshlrev_b32 v106, 16, v116
    v_lshlrev_b32 v107, 16, v118
    v_cvt_pk_f16_f32 v97, v106, v107
    v_lshlrev_b32 v104, 16, v120
    v_lshlrev_b32 v105, 16, v122
    v_cvt_pk_f16_f32 v98, v104, v105
    v_lshlrev_b32 v106, 16, v124
    v_lshlrev_b32 v107, 16, v126
    v_cvt_pk_f16_f32 v99, v106, v107
    ds_write_b128 v7, v[96:99] offset:0
    v_and_b32 v104, 0xffff0000, v112
    v_and_b32 v105, 0xffff0000, v114
    v_cvt_pk_f16_f32 v100, v104, v105
    v_and_b32 v106, 0xffff0000, v116
    v_and_b32 v107, 0xffff0000, v118
    v_cvt_pk_f16_f32 v101, v106, v107
    v_and_b32 v104, 0xffff0000, v120
    v_and_b32 v105, 0xffff0000, v122
    v_cvt_pk_f16_f32 v102, v104, v105
    v_and_b32 v106, 0xffff0000, v124
    v_and_b32 v107, 0xffff0000, v126
    v_cvt_pk_f16_f32 v103, v106, v107
    ds_write_b128 v7, v[100:103] offset:20480
    v_lshlrev_b32 v104, 16, v113
    v_lshlrev_b32 v105, 16, v115
    v_cvt_pk_f16_f32 v96, v104, v105
    v_lshlrev_b32 v106, 16, v117
    v_lshlrev_b32 v107, 16, v119
    v_cvt_pk_f16_f32 v97, v106, v107
    v_lshlrev_b32 v104, 16, v121
    v_lshlrev_b32 v105, 16, v123
    v_cvt_pk_f16_f32 v98, v104, v105
    v_lshlrev_b32 v106, 16, v125
    v_lshlrev_b32 v107, 16, v127
    v_cvt_pk_f16_f32 v99, v106, v107
    ds_write_b128 v8, v[96:99] offset:0
    v_and_b32 v104, 0xffff0000, v113
    v_and_b32 v105, 0xffff0000, v115
    v_cvt_pk_f16_f32 v100, v104, v105
    v_and_b32 v106, 0xffff0000, v117
    v_and_b32 v107, 0xffff0000, v119
    v_cvt_pk_f16_f32 v101, v106, v107
    v_and_b32 v104, 0xffff0000, v121
    v_and_b32 v105, 0xffff0000, v123
    v_cvt_pk_f16_f32 v102, v104, v105
    v_and_b32 v106, 0xffff0000, v125
    v_and_b32 v107, 0xffff0000, v127
    v_cvt_pk_f16_f32 v103, v106, v107
    ds_write_b128 v8, v[100:103] offset:20480
    s_waitcnt vmcnt(56)
    v_lshlrev_b32 v104, 16, v128
    v_lshlrev_b32 v105, 16, v130
    v_cvt_pk_f16_f32 v96, v104, v105
    v_lshlrev_b32 v106, 16, v132
    v_lshlrev_b32 v107, 16, v134
    v_cvt_pk_f16_f32 v97, v106, v107
    v_lshlrev_b32 v104, 16, v136
    v_lshlrev_b32 v105, 16, v138
    v_cvt_pk_f16_f32 v98, v104, v105
    v_lshlrev_b32 v106, 16, v140
    v_lshlrev_b32 v107, 16, v142
    v_cvt_pk_f16_f32 v99, v106, v107
    ds_write_b128 v7, v[96:99] offset:1024
    v_and_b32 v104, 0xffff0000, v128
    v_and_b32 v105, 0xffff0000, v130
    v_cvt_pk_f16_f32 v100, v104, v105
    v_and_b32 v106, 0xffff0000, v132
    v_and_b32 v107, 0xffff0000, v134
    v_cvt_pk_f16_f32 v101, v106, v107
    v_and_b32 v104, 0xffff0000, v136
    v_and_b32 v105, 0xffff0000, v138
    v_cvt_pk_f16_f32 v102, v104, v105
    v_and_b32 v106, 0xffff0000, v140
    v_and_b32 v107, 0xffff0000, v142
    v_cvt_pk_f16_f32 v103, v106, v107
    ds_write_b128 v7, v[100:103] offset:21504
    v_lshlrev_b32 v104, 16, v129
    v_lshlrev_b32 v105, 16, v131
    v_cvt_pk_f16_f32 v96, v104, v105
    v_lshlrev_b32 v106, 16, v133
    v_lshlrev_b32 v107, 16, v135
    v_cvt_pk_f16_f32 v97, v106, v107
    v_lshlrev_b32 v104, 16, v137
    v_lshlrev_b32 v105, 16, v139
    v_cvt_pk_f16_f32 v98, v104, v105
    v_lshlrev_b32 v106, 16, v141
    v_lshlrev_b32 v107, 16, v143
    v_cvt_pk_f16_f32 v99, v106, v107
    ds_write_b128 v8, v[96:99] offset:1024
    v_and_b32 v104, 0xffff0000, v129
    v_and_b32 v105, 0xffff0000, v131
    v_cvt_pk_f16_f32 v100, v104, v105
    v_and_b32 v106, 0xffff0000, v133
    v_and_b32 v107, 0xffff0000, v135
    v_cvt_pk_f16_f32 v101, v106, v107
    v_and_b32 v104, 0xffff0000, v137
    v_and_b32 v105, 0xffff0000, v139
    v_cvt_pk_f16_f32 v102, v104, v105
    v_and_b32 v106, 0xffff0000, v141
    v_and_b32 v107, 0xffff0000, v143
    v_cvt_pk_f16_f32 v103, v106, v107
    ds_write_b128 v8, v[100:103] offset:21504
    s_waitcnt vmcnt(48)
    v_lshlrev_b32 v104, 16, v144
    v_lshlrev_b32 v105, 16, v146
    v_cvt_pk_f16_f32 v96, v104, v105
    v_lshlrev_b32 v106, 16, v148
    v_lshlrev_b32 v107, 16, v150
    v_cvt_pk_f16_f32 v97, v106, v107
    v_lshlrev_b32 v104, 16, v152
    v_lshlrev_b32 v105, 16, v154
    v_cvt_pk_f16_f32 v98, v104, v105
    v_lshlrev_b32 v106, 16, v156
    v_lshlrev_b32 v107, 16, v158
    v_cvt_pk_f16_f32 v99, v106, v107
    ds_write_b128 v7, v[96:99] offset:2048
    v_and_b32 v104, 0xffff0000, v144
    v_and_b32 v105, 0xffff0000, v146
    v_cvt_pk_f16_f32 v100, v104, v105
    v_and_b32 v106, 0xffff0000, v148
    v_and_b32 v107, 0xffff0000, v150
    v_cvt_pk_f16_f32 v101, v106, v107
    v_and_b32 v104, 0xffff0000, v152
    v_and_b32 v105, 0xffff0000, v154
    v_cvt_pk_f16_f32 v102, v104, v105
    v_and_b32 v106, 0xffff0000, v156
    v_and_b32 v107, 0xffff0000, v158
    v_cvt_pk_f16_f32 v103, v106, v107
    ds_write_b128 v7, v[100:103] offset:22528
    v_lshlrev_b32 v104, 16, v145
    v_lshlrev_b32 v105, 16, v147
    v_cvt_pk_f16_f32 v96, v104, v105
    v_lshlrev_b32 v106, 16, v149
    v_lshlrev_b32 v107, 16, v151
    v_cvt_pk_f16_f32 v97, v106, v107
    v_lshlrev_b32 v104, 16, v153
    v_lshlrev_b32 v105, 16, v155
    v_cvt_pk_f16_f32 v98, v104, v105
    v_lshlrev_b32 v106, 16, v157
    v_lshlrev_b32 v107, 16, v159
    v_cvt_pk_f16_f32 v99, v106, v107
    ds_write_b128 v8, v[96:99] offset:2048
    v_and_b32 v104, 0xffff0000, v145
    v_and_b32 v105, 0xffff0000, v147
    v_cvt_pk_f16_f32 v100, v104, v105
    v_and_b32 v106, 0xffff0000, v149
    v_and_b32 v107, 0xffff0000, v151
    v_cvt_pk_f16_f32 v101, v106, v107
    v_and_b32 v104, 0xffff0000, v153
    v_and_b32 v105, 0xffff0000, v155
    v_cvt_pk_f16_f32 v102, v104, v105
    v_and_b32 v106, 0xffff0000, v157
    v_and_b32 v107, 0xffff0000, v159
    v_cvt_pk_f16_f32 v103, v106, v107
    ds_write_b128 v8, v[100:103] offset:22528
    s_waitcnt vmcnt(40)
    v_lshlrev_b32 v104, 16, v160
    v_lshlrev_b32 v105, 16, v162
    v_cvt_pk_f16_f32 v96, v104, v105
    v_lshlrev_b32 v106, 16, v164
    v_lshlrev_b32 v107, 16, v166
    v_cvt_pk_f16_f32 v97, v106, v107
    v_lshlrev_b32 v104, 16, v168
    v_lshlrev_b32 v105, 16, v170
    v_cvt_pk_f16_f32 v98, v104, v105
    v_lshlrev_b32 v106, 16, v172
    v_lshlrev_b32 v107, 16, v174
    v_cvt_pk_f16_f32 v99, v106, v107
    ds_write_b128 v7, v[96:99] offset:3072
    v_and_b32 v104, 0xffff0000, v160
    v_and_b32 v105, 0xffff0000, v162
    v_cvt_pk_f16_f32 v100, v104, v105
    v_and_b32 v106, 0xffff0000, v164
    v_and_b32 v107, 0xffff0000, v166
    v_cvt_pk_f16_f32 v101, v106, v107
    v_and_b32 v104, 0xffff0000, v168
    v_and_b32 v105, 0xffff0000, v170
    v_cvt_pk_f16_f32 v102, v104, v105
    v_and_b32 v106, 0xffff0000, v172
    v_and_b32 v107, 0xffff0000, v174
    v_cvt_pk_f16_f32 v103, v106, v107
    ds_write_b128 v7, v[100:103] offset:23552
    v_lshlrev_b32 v104, 16, v161
    v_lshlrev_b32 v105, 16, v163
    v_cvt_pk_f16_f32 v96, v104, v105
    v_lshlrev_b32 v106, 16, v165
    v_lshlrev_b32 v107, 16, v167
    v_cvt_pk_f16_f32 v97, v106, v107
    v_lshlrev_b32 v104, 16, v169
    v_lshlrev_b32 v105, 16, v171
    v_cvt_pk_f16_f32 v98, v104, v105
    v_lshlrev_b32 v106, 16, v173
    v_lshlrev_b32 v107, 16, v175
    v_cvt_pk_f16_f32 v99, v106, v107
    ds_write_b128 v8, v[96:99] offset:3072
    v_and_b32 v104, 0xffff0000, v161
    v_and_b32 v105, 0xffff0000, v163
    v_cvt_pk_f16_f32 v100, v104, v105
    v_and_b32 v106, 0xffff0000, v165
    v_and_b32 v107, 0xffff0000, v167
    v_cvt_pk_f16_f32 v101, v106, v107
    v_and_b32 v104, 0xffff0000, v169
    v_and_b32 v105, 0xffff0000, v171
    v_cvt_pk_f16_f32 v102, v104, v105
    v_and_b32 v106, 0xffff0000, v173
    v_and_b32 v107, 0xffff0000, v175
    v_cvt_pk_f16_f32 v103, v106, v107
    ds_write_b128 v8, v[100:103] offset:23552
    s_waitcnt vmcnt(32)
    v_lshlrev_b32 v104, 16, v176
    v_lshlrev_b32 v105, 16, v178
    v_cvt_pk_f16_f32 v96, v104, v105
    v_lshlrev_b32 v106, 16, v180
    v_lshlrev_b32 v107, 16, v182
    v_cvt_pk_f16_f32 v97, v106, v107
    v_lshlrev_b32 v104, 16, v184
    v_lshlrev_b32 v105, 16, v186
    v_cvt_pk_f16_f32 v98, v104, v105
    v_lshlrev_b32 v106, 16, v188
    v_lshlrev_b32 v107, 16, v190
    v_cvt_pk_f16_f32 v99, v106, v107
    ds_write_b128 v7, v[96:99] offset:4096
    v_and_b32 v104, 0xffff0000, v176
    v_and_b32 v105, 0xffff0000, v178
    v_cvt_pk_f16_f32 v100, v104, v105
    v_and_b32 v106, 0xffff0000, v180
    v_and_b32 v107, 0xffff0000, v182
    v_cvt_pk_f16_f32 v101, v106, v107
    v_and_b32 v104, 0xffff0000, v184
    v_and_b32 v105, 0xffff0000, v186
    v_cvt_pk_f16_f32 v102, v104, v105
    v_and_b32 v106, 0xffff0000, v188
    v_and_b32 v107, 0xffff0000, v190
    v_cvt_pk_f16_f32 v103, v106, v107
    ds_write_b128 v7, v[100:103] offset:24576
    v_lshlrev_b32 v104, 16, v177
    v_lshlrev_b32 v105, 16, v179
    v_cvt_pk_f16_f32 v96, v104, v105
    v_lshlrev_b32 v106, 16, v181
    v_lshlrev_b32 v107, 16, v183
    v_cvt_pk_f16_f32 v97, v106, v107
    v_lshlrev_b32 v104, 16, v185
    v_lshlrev_b32 v105, 16, v187
    v_cvt_pk_f16_f32 v98, v104, v105
    v_lshlrev_b32 v106, 16, v189
    v_lshlrev_b32 v107, 16, v191
    v_cvt_pk_f16_f32 v99, v106, v107
    ds_write_b128 v8, v[96:99] offset:4096
    v_and_b32 v104, 0xffff0000, v177
    v_and_b32 v105, 0xffff0000, v179
    v_cvt_pk_f16_f32 v100, v104, v105
    v_and_b32 v106, 0xffff0000, v181
    v_and_b32 v107, 0xffff0000, v183
    v_cvt_pk_f16_f32 v101, v106, v107
    v_and_b32 v104, 0xffff0000, v185
    v_and_b32 v105, 0xffff0000, v187
    v_cvt_pk_f16_f32 v102, v104, v105
    v_and_b32 v106, 0xffff0000, v189
    v_and_b32 v107, 0xffff0000, v191
    v_cvt_pk_f16_f32 v103, v106, v107
    ds_write_b128 v8, v[100:103] offset:24576
    s_waitcnt lgkmcnt(0)
    s_barrier
    s_mul_i32 s24, s22, 20480
    s_lshl_b32 s25, s64, 1
    s_add_u32 s25, s25, s24
    v_add_u32 v9, s25, v5
    ds_read_b128 a[240:243], v9 offset:0
    ds_read_b128 a[244:247], v9 offset:1024
    s_lshl_b32 s25, s65, 1
    s_add_u32 s25, s25, s24
    v_add_u32 v9, s25, v5
    ds_read_b128 a[248:251], v9 offset:0
    ds_read_b128 a[252:255], v9 offset:1024
    s_lshl_b32 s25, s66, 1
    s_add_u32 s25, s25, s24
    v_add_u32 v9, s25, v5
    ds_read_b128 v[112:115], v9 offset:0
    ds_read_b128 v[116:119], v9 offset:1024
    s_lshl_b32 s25, s67, 1
    s_add_u32 s25, s25, s24
    v_add_u32 v9, s25, v5
    ds_read_b128 v[120:123], v9 offset:0
    ds_read_b128 v[124:127], v9 offset:1024
    s_lshl_b32 s25, s68, 1
    s_add_u32 s25, s25, s24
    v_add_u32 v9, s25, v5
    ds_read_b128 v[128:131], v9 offset:0
    ds_read_b128 v[132:135], v9 offset:1024
    s_lshl_b32 s25, s69, 1
    s_add_u32 s25, s25, s24
    v_add_u32 v9, s25, v5
    ds_read_b128 v[136:139], v9 offset:0
    ds_read_b128 v[140:143], v9 offset:1024
    s_lshl_b32 s25, s70, 1
    s_add_u32 s25, s25, s24
    v_add_u32 v9, s25, v5
    ds_read_b128 v[144:147], v9 offset:0
    ds_read_b128 v[148:151], v9 offset:1024
    s_lshl_b32 s25, s71, 1
    s_add_u32 s25, s25, s24
    v_add_u32 v9, s25, v5
    ds_read_b128 v[152:155], v9 offset:0
    ds_read_b128 v[156:159], v9 offset:1024
    s_lshl_b32 s25, s72, 1
    s_add_u32 s25, s25, s24
    v_add_u32 v9, s25, v5
    ds_read_b128 v[160:163], v9 offset:0
    ds_read_b128 v[164:167], v9 offset:1024
    s_lshl_b32 s25, s73, 1
    s_add_u32 s25, s25, s24
    v_add_u32 v9, s25, v5
    ds_read_b128 v[168:171], v9 offset:0
    ds_read_b128 v[172:175], v9 offset:1024
    s_waitcnt lgkmcnt(0)
    s_lshr_b32 s78, s51, 1
    s_lshl_b32 s78, s78, 6
    s_add_u32 s78, s78, 116556800
    v_lshlrev_b32 v110, 2, v1
    v_and_b32 v111, 3, v1
    v_and_b32 v6, 4, v1
    v_lshlrev_b32 v111, 2, v111
    v_lshl_add_u32 v111, v6, 8, v111
    v_lshrrev_b32 v7, 2, v2
    v_and_b32 v6, 1, v2
    v_lshl_add_u32 v7, v7, 1, v6
    s_mov_b32 s24, 1280
    v_mul_lo_u32 v7, v7, s24
    v_lshl_add_u32 v7, v3, 5, v7
    v_bfe_u32 v6, v2, 1, 1
    v_lshl_add_u32 v7, v6, 4, v7
    s_lshr_b32 s24, s64, 3
    s_waitcnt vmcnt(0)
    s_cmp_eq_u32 s22, 0
    s_cbranch_scc0 L_rec_e0
    buffer_load_dword v108, v110, s[84:87], 0 offen sc1
    buffer_load_dword v109, v111, s[12:15], s78 offen sc1
L_rec_e0:
    buffer_load_dwordx4 v[96:99], v7, s[8:11], s24 offen offset:0
    buffer_load_dwordx4 v[100:103], v7, s[8:11], s24 offen offset:128
    s_mov_b32 s24, 1280
    v_mul_lo_u32 v7, v3, s24
    v_lshl_add_u32 v7, v2, 3, v7
    s_lshr_b32 s24, s22, 1
    s_mul_i32 s24, s24, 640
    s_and_b32 s25, s22, 1
    s_mul_i32 s25, s25, 5120
    s_add_u32 s24, s24, s25
    buffer_load_dwordx2 v[104:105], v7, s[8:11], s24 offen offset:256
    v_perm_b32 v176, v20, v16, s34
    v_perm_b32 v184, v20, v16, s35
    v_perm_b32 v192, v21, v17, s34
    v_perm_b32 v200, v21, v17, s35
    v_perm_b32 v208, v22, v18, s34
    v_perm_b32 v216, v22, v18, s35
    v_perm_b32 v224, v23, v19, s34
    v_perm_b32 v232, v23, v19, s35
    v_perm_b32 v240, v81, v80, s34
    v_perm_b32 v248, v81, v80, s35
    v_perm_b32 v177, v28, v24, s34
    v_perm_b32 v185, v28, v24, s35
    v_perm_b32 v193, v29, v25, s34
    v_perm_b32 v201, v29, v25, s35
    v_perm_b32 v209, v30, v26, s34
    v_perm_b32 v217, v30, v26, s35
    v_perm_b32 v225, v31, v27, s34
    v_perm_b32 v233, v31, v27, s35
    v_perm_b32 v241, v83, v82, s34
    v_perm_b32 v249, v83, v82, s35
    v_perm_b32 v178, v36, v32, s34
    v_perm_b32 v186, v36, v32, s35
    v_perm_b32 v194, v37, v33, s34
    v_perm_b32 v202, v37, v33, s35
    v_perm_b32 v210, v38, v34, s34
    v_perm_b32 v218, v38, v34, s35
    v_perm_b32 v226, v39, v35, s34
    v_perm_b32 v234, v39, v35, s35
    v_perm_b32 v242, v85, v84, s34
    v_perm_b32 v250, v85, v84, s35
    v_perm_b32 v179, v44, v40, s34
    v_perm_b32 v187, v44, v40, s35
    v_perm_b32 v195, v45, v41, s34
    v_perm_b32 v203, v45, v41, s35
    v_perm_b32 v211, v46, v42, s34
    v_perm_b32 v219, v46, v42, s35
    v_perm_b32 v227, v47, v43, s34
    v_perm_b32 v235, v47, v43, s35
    v_perm_b32 v243, v87, v86, s34
    v_perm_b32 v251, v87, v86, s35
    v_perm_b32 v180, v52, v48, s34
    v_perm_b32 v188, v52, v48, s35
    v_perm_b32 v196, v53, v49, s34
    v_perm_b32 v204, v53, v49, s35
    v_perm_b32 v212, v54, v50, s34
    v_perm_b32 v220, v54, v50, s35
    v_perm_b32 v228, v55, v51, s34
    v_perm_b32 v236, v55, v51, s35
    v_perm_b32 v244, v89, v88, s34
    v_perm_b32 v252, v89, v88, s35
    v_perm_b32 v181, v60, v56, s34
    v_perm_b32 v189, v60, v56, s35
    v_perm_b32 v197, v61, v57, s34
    v_perm_b32 v205, v61, v57, s35
    v_perm_b32 v213, v62, v58, s34
    v_perm_b32 v221, v62, v58, s35
    v_perm_b32 v229, v63, v59, s34
    v_perm_b32 v237, v63, v59, s35
    v_perm_b32 v245, v91, v90, s34
    v_perm_b32 v253, v91, v90, s35
    v_perm_b32 v182, v68, v64, s34
    v_perm_b32 v190, v68, v64, s35
    v_perm_b32 v198, v69, v65, s34
    v_perm_b32 v206, v69, v65, s35
    v_perm_b32 v214, v70, v66, s34
    v_perm_b32 v222, v70, v66, s35
    v_perm_b32 v230, v71, v67, s34
    v_perm_b32 v238, v71, v67, s35
    v_perm_b32 v246, v93, v92, s34
    v_perm_b32 v254, v93, v92, s35
    v_perm_b32 v183, v76, v72, s34
    v_perm_b32 v191, v76, v72, s35
    v_perm_b32 v199, v77, v73, s34
    v_perm_b32 v207, v77, v73, s35
    v_perm_b32 v215, v78, v74, s34
    v_perm_b32 v223, v78, v74, s35
    v_perm_b32 v231, v79, v75, s34
    v_perm_b32 v239, v79, v75, s35
    v_perm_b32 v247, v95, v94, s34
    v_perm_b32 v255, v95, v94, s35
    s_barrier
    s_cmp_eq_u32 s22, 1
    s_cbranch_scc0 L_rec_nosig2
    v_mov_b32 v24, 0
    v_mov_b32 v25, 1
    s_mov_b64 exec, 1
    buffer_atomic_add v25, v24, s[84:87], 0 offen offset:160 sc1
    s_mov_b64 exec, -1
L_rec_nosig2:
    v_and_b32 v24, 1, v3
    v_lshrrev_b32 v25, 1, v3
    v_lshlrev_b32 v26, 1, v3
    v_and_b32 v27, 1, v2
    v_and_b32 v28, 3, v2
    v_and_b32 v29, 7, v2
    v_mov_b32 v4, 0x4444
    v_mov_b32 v30, 0xeeee
    v_and_b32 v22, 2, v2
    v_cmp_eq_u32 vcc, 0, v22
    s_nop 1
    v_cndmask_b32 v4, v30, v4, vcc
    v_add_u32 v6, s64, v5
    v_lshrrev_b32 v30, 2, v2
    v_lshl_add_u32 v30, v30, 1, v27
    v_lshlrev_b32 v14, 7, v3
    v_lshl_add_u32 v14, v30, 4, v14
    v_lshrrev_b32 v7, 2, v2
    v_lshlrev_b32 v7, 7, v7
    v_lshl_add_u32 v7, v26, 4, v7
    v_lshl_add_u32 v7, v28, 2, v7
    s_lshl_b32 s24, s22, 9
    s_lshl_b32 s25, s52, 10
    s_xor_b32 s24, s24, s25
    s_add_u32 s24, s24, 20480
    v_add_u32 v7, s24, v7
    v_lshrrev_b32 v19, 3, v2
    v_lshlrev_b32 v19, 7, v19
    v_lshl_add_u32 v19, v26, 4, v19
    v_lshl_add_u32 v19, v29, 1, v19
    s_lshl_b32 s24, s22, 8
    v_add_u32 v19, s24, v19
    v_lshlrev_b32 v8, 7, v3
    v_lshl_add_u32 v8, v29, 4, v8
    s_lshl_b32 s24, s22, 10
    s_add_u32 s24, s24, 49152
    v_add_u32 v9, s24, v5
    v_lshrrev_b32 v10, 1, v29
    v_lshlrev_b32 v10, 6, v10
    v_lshl_add_u32 v10, v25, 5, v10
    v_lshl_add_u32 v10, v27, 4, v10
    v_lshl_add_u32 v10, v24, 3, v10
    s_lshl_b32 s24, s22, 8
    s_add_u32 s24, s24, 26624
    v_add_u32 v10, s24, v10
    s_mul_i32 s36, s20, 80*4096
    s_add_u32 s36, s36, 100663296
    s_xor_b32 s24, s20, 1
    s_mul_i32 s24, s24, 20480
    s_add_u32 s40, s24, 101328896
    v_lshrrev_b32 v30, 3, v2
    s_lshl_b32 s24, s22, 1
    v_add_u32 v30, s24, v30
    v_lshl_add_u32 v30, v30, 3, v26
    v_add_u32 v30, 0, v30
    v_add_u32 v11, s21, v30
    v_and_b32 v11, 31, v11
    v_lshlrev_b32 v11, 7, v11
    v_lshl_add_u32 v11, v30, 12, v11
    v_lshl_add_u32 v11, v29, 4, v11
    v_lshrrev_b32 v30, 3, v2
    s_lshl_b32 s24, s22, 1
    v_add_u32 v30, s24, v30
    v_lshl_add_u32 v30, v30, 3, v26
    v_add_u32 v30, 1, v30
    v_add_u32 v12, s21, v30
    v_and_b32 v12, 31, v12
    v_lshlrev_b32 v12, 7, v12
    v_lshl_add_u32 v12, v30, 12, v12
    v_lshl_add_u32 v12, v29, 4, v12
    s_lshl_b32 s24, s22, 2
    s_add_u32 s24, s24, 64
    v_add_u32 v30, s24, v3
    v_add_u32 v13, s21, v30
    v_and_b32 v13, 31, v13
    v_lshlrev_b32 v13, 7, v13
    v_lshl_add_u32 v13, v30, 12, v13
    v_lshl_add_u32 v13, v2, 3, v13
    v_cmp_eq_u32 s[58:59], 0, v28
    s_lshl_b32 s37, s22, 5
    s_add_u32 s37, s37, s21
    s_lshl_b32 s24, s37, 12
    s_add_u32 s38, s24, s36
    v_lshrrev_b32 v18, 2, v2
    v_lshlrev_b32 v18, 8, v18
    v_lshl_add_u32 v18, v25, 6, v18
    v_bfe_u32 v22, v2, 1, 1
    v_lshl_add_u32 v18, v22, 5, v18
    v_lshl_add_u32 v18, v24, 4, v18
    v_lshl_add_u32 v18, v27, 3, v18
    s_lshr_b32 s24, s22, 1
    s_mul_i32 s24, s24, 5120
    s_and_b32 s25, s22, 1
    s_lshl_b32 s25, s25, 7
    s_add_u32 s24, s24, s25
    s_add_u32 s24, s24, 2048
    v_add_u32 v18, s24, v18
    s_lshr_b32 s24, s37, 3
    s_lshl_b32 s24, s24, 10
    s_and_b32 s25, s37, 6
    s_lshl_b32 s25, s25, 5
    s_add_u32 s24, s24, s25
    s_and_b32 s25, s37, 1
    s_lshl_b32 s25, s25, 4
    s_add_u32 s24, s24, s25
    v_lshrrev_b32 v21, 1, v29
    v_lshlrev_b32 v21, 8, v21
    v_lshl_add_u32 v21, v27, 5, v21
    v_lshl_add_u32 v21, v24, 3, v21
    v_add_u32 v21, s24, v21
    s_cmp_ge_u32 s37, 64
    s_cbranch_scc0 L_rec_mainu
    v_lshrrev_b32 v21, 2, v29
    v_lshlrev_b32 v21, 8, v21
    v_bfe_u32 v22, v2, 1, 1
    v_lshl_add_u32 v21, v22, 5, v21
    v_lshl_add_u32 v21, v24, 4, v21
    v_lshl_add_u32 v21, v27, 3, v21
    s_lshr_b32 s24, s37, 2
    s_lshl_b32 s24, s24, 9
    s_and_b32 s25, s37, 3
    s_lshl_b32 s25, s25, 6
    s_add_u32 s24, s24, s25
    v_add_u32 v21, s24, v21
L_rec_mainu:
    v_and_b32 v22, 40, v1
    v_cmp_eq_u32 s[74:75], 0, v22
    v_lshrrev_b32 v22, 1, v2
    v_mov_b32 v23, 0x3c00
    v_lshlrev_b32 v30, 4, v27
    v_lshlrev_b32 v23, v30, v23
    v_cmp_eq_u32 vcc, 0, v22
    s_nop 1
    v_cndmask_b32 v32, 0, v23, vcc
    v_cmp_eq_u32 vcc, 1, v22
    s_nop 1
    v_cndmask_b32 v33, 0, v23, vcc
    v_cmp_eq_u32 vcc, 2, v22
    s_nop 1
    v_cndmask_b32 v34, 0, v23, vcc
    v_cmp_eq_u32 vcc, 3, v22
    s_nop 1
    v_cndmask_b32 v35, 0, v23, vcc
    ds_write_b128 v5, v[32:35] offset:57344
    v_lshlrev_b32 v15, 3, v2
    v_lshl_add_u32 v15, v25, 7, v15
    v_lshl_add_u32 v15, v24, 2, v15
    s_lshl_b32 s24, s52, 10
    s_lshl_b32 s25, s22, 8
    s_add_u32 s24, s24, s25
    v_add_u32 v15, s24, v15
    v_mov_b32 v16, 0
    v_mov_b32 v17, 0
    ds_write_b32 v5, v16 offset:1024
    s_mul_i32 s24, s20, 20480
    s_add_u32 s39, s24, 101318656
    s_lshl_b32 s24, s51, 13
    s_lshl_b32 s25, s22, 11
    s_add_u32 s41, s24, s25
    s_add_u32 s41, s41, 20971520
    s_lshl_b32 s25, s52, 12
    s_add_u32 s24, s24, s25
    s_lshl_b32 s25, s22, 10
    s_add_u32 s24, s24, s25
    s_add_u32 s42, s24, 37748736
    s_lshl_b32 s24, s51, 11
    s_add_u32 s43, s24, 103940096
    s_add_u32 s44, s24, 108134400
    s_mov_b32 s23, 0
    s_mov_b32 s45, 0
    s_mov_b32 s46, 0
    s_mov_b32 s47, 0x3e0293ee
    s_lshl_b32 s48, s22, 11
    s_add_u32 s48, s48, 32768
    s_lshl_b32 s49, s22, 10
    s_add_u32 s49, s49, 49152
    s_lshl_b32 s53, s52, 10
    s_add_u32 s43, s43, s53
    s_xor_b32 s54, s43, 1024
    s_lshl_b32 s55, s52, 11
    s_xor_b32 s56, s55, 2048
    s_mov_b32 s81, 0x70
    s_mov_b32 s100, 0x3f803f80
    s_mov_b32 s101, 0x3f803f80
    s_add_u32 s30, s39, 10240
    s_mov_b32 s76, 0
    s_mov_b32 s77, 0
    s_lshr_b32 s78, s51, 1
    s_lshl_b32 s78, s78, 6
    s_add_u32 s78, s78, 116556800
    s_lshl_b32 s24, s51, 11
    s_lshl_b32 s25, s52, 10
    s_add_u32 s24, s24, s25
    s_add_u32 s79, s24, 112328704
    s_add_u32 s44, s24, 108134400
    s_and_b32 s25, s22, 1
    s_lshl_b32 s25, s25, 9
    s_add_u32 s79, s79, s25
    s_add_u32 s44, s44, s25
    s_add_u32 s24, s24, s25
    s_add_u32 s24, s24, 83886080
    s_add_u32 s25, s79, 65536
    s_cmp_ge_u32 s22, 2
    s_cselect_b32 s24, s24, s79
    s_cselect_b32 s79, s44, s25
    s_mov_b32 s44, s24
    s_cselect_b32 s80, 1024, 0
    s_lshl_b32 s24, s52, 10
    v_subrev_u32 v15, s24, v15
    v_add_u32 v15, 24576, v15
    s_add_u32 s82, s39, 40960
    s_add_u32 s83, s39, 163840
    v_mov_b32 v25, 0
    s_mov_b32 s24, 48
    v_writelane_b32 v25, s24, 56
    s_mov_b32 s24, 48
    v_writelane_b32 v25, s24, 57
    s_mov_b32 s24, 64
    v_writelane_b32 v25, s24, 24
    s_mov_b32 s24, 1
    v_writelane_b32 v25, s24, 60
    s_mov_b32 s24, 1
    v_writelane_b32 v25, s24, 61
    s_mov_b32 s24, 1
    v_writelane_b32 v25, s24, 62
    s_mov_b32 s24, 1
    v_writelane_b32 v25, s24, 63
    s_mov_b32 s28, 0
    s_cmp_eq_u32 s22, 0
    s_cbranch_scc0 L_rec_w2
    s_waitcnt vmcnt(3)
    s_branch L_rec_w1
L_rec_w0:
    s_sleep 6
    buffer_load_dword v108, v110, s[84:87], 0 offen sc1
    buffer_load_dword v109, v111, s[12:15], s78 offen sc1
    s_add_u32 s28, s28, 1
    s_cmp_ge_u32 s28, 1048576
    s_cbranch_scc1 L_mega_done
    s_waitcnt vmcnt(0)
L_rec_w1:
    v_cmp_lt_u32 vcc, v108, v25
    s_cbranch_vccnz L_rec_w0
    s_branch L_rec_w4
L_rec_w3:
    s_sleep 3
    buffer_load_dword v109, v111, s[12:15], s78 offen sc1
    s_add_u32 s28, s28, 1
    s_cmp_ge_u32 s28, 1048576
    s_cbranch_scc1 L_mega_done
    s_waitcnt vmcnt(0)
L_rec_w4:
    v_cmp_eq_u32 vcc, 0, v109
    s_and_b32 vcc_lo, vcc_lo, 0x33
    s_cbranch_scc1 L_rec_w3
    ds_write_b32 v110, v108
    ds_write_b32 v110, v109 offset:256
    s_waitcnt lgkmcnt(0)
L_rec_w2:
    s_barrier
    ds_read_b32 v108, v110
    ds_read_b32 v109, v110 offset:256
    s_waitcnt lgkmcnt(0)
    v_and_b32 v22, 3, v1
    v_lshl_add_u32 v23, v109, 2, v22
    s_nop 0
    v_readlane_b32 s76, v23, 0
    v_readlane_b32 s24, v23, 1
    s_min_u32 s76, s76, s24
    v_readlane_b32 s24, v23, 2
    s_min_u32 s76, s76, s24
    v_readlane_b32 s24, v23, 3
    s_min_u32 s76, s76, s24
    v_readlane_b32 s24, v23, 4
    s_min_u32 s76, s76, s24
    v_readlane_b32 s24, v23, 5
    s_min_u32 s76, s76, s24
    v_readlane_b32 s24, v23, 6
    s_min_u32 s76, s76, s24
    v_readlane_b32 s24, v23, 7
    s_min_u32 s76, s76, s24
    s_mov_b32 s88, s48
    s_mov_b32 s89, s49
    s_cmp_lt_u32 s77, s76
    s_cbranch_scc1 L_hok_23
    s_mov_b32 s28, 0
L_hpoll_24:
    v_bfe_u32 v22, v5, 4, 2
    v_bfe_u32 v23, v5, 4, 3
    v_and_b32 v23, 4, v23
    v_lshlrev_b32 v52, 2, v22
    v_lshl_add_u32 v52, v23, 8, v52
    s_sleep 4
    buffer_load_dword v23, v52, s[12:15], s78 offen sc1
    s_add_u32 s28, s28, 1
    s_cmp_ge_u32 s28, 1048576
    s_cbranch_scc1 L_mega_done
    s_waitcnt vmcnt(0)
    v_lshl_add_u32 v23, v23, 2, v22
    s_nop 0
    v_readlane_b32 s76, v23, 0
    v_readlane_b32 s24, v23, 1
    s_min_u32 s76, s76, s24
    v_readlane_b32 s24, v23, 2
    s_min_u32 s76, s76, s24
    v_readlane_b32 s24, v23, 3
    s_min_u32 s76, s76, s24
    v_readlane_b32 s24, v23, 4
    s_min_u32 s76, s76, s24
    v_readlane_b32 s24, v23, 5
    s_min_u32 s76, s76, s24
    v_readlane_b32 s24, v23, 6
    s_min_u32 s76, s76, s24
    v_readlane_b32 s24, v23, 7
    s_min_u32 s76, s76, s24
    s_cmp_lt_u32 s77, s76
    s_cbranch_scc0 L_hpoll_24
L_hok_23:
    s_add_u32 s77, s77, 1
    s_mov_b32 m0, s89
    s_nop 0
    buffer_load_dwordx4 v5, s[12:15], s42 offen sc1 lds
    s_mov_b32 m0, s88
    s_nop 0
    buffer_load_dwordx4 v5, s[12:15], s41 offen offset:0 sc1 lds
    buffer_load_dwordx4 v5, s[12:15], s41 offen offset:1024 sc1 lds
    v_readlane_b32 s24, v108, 56
    v_readlane_b32 s25, v108, 57
    s_cmp_eq_u32 s20, 0
    s_cselect_b32 s62, s24, s25
    s_cselect_b32 s63, s25, s24
    s_and_b32 s62, s62, 2
    s_and_b32 s63, s63, 2
    s_lshl_b32 s62, s62, 12
    s_lshl_b32 s63, s63, 12
    s_add_u32 s60, s60, s62
    s_add_u32 s61, s61, s63
    s_lshr_b32 s32, s64, 10
    s_lshr_b32 s57, s37, 3
    s_lshr_b32 s59, s22, 1
    s_mul_i32 s59, s59, 5
    s_add_u32 s59, s59, 2
    v_mov_b32 v27, v9
    s_lshl_b32 s24, s37, 7
    s_and_b32 s50, s24, 1023
    s_and_b32 s24, s37, 3
    s_lshl_b32 s24, s24, 8
    s_and_b32 s25, s37, 4
    s_lshl_b32 s25, s25, 4
    s_add_u32 s24, s24, s25
    s_cmp_ge_u32 s37, 64
    s_cselect_b32 s50, s24, s50
    s_mov_b32 s24, 22528
    s_cmp_ge_u32 s22, 2
    s_cselect_b32 s24, 25600, s24
    s_and_b32 s25, s22, 1
    s_lshl_b32 s25, s25, 9
    s_add_u32 s24, s24, s25
    v_and_b32 v9, 0x1ff, v5
    v_add_u32 v9, s24, v9
    v_lshrrev_b32 v22, 2, v2
    v_lshlrev_b32 v26, 8, v22
    v_and_b32 v22, 1, v2
    v_lshl_add_u32 v26, v22, 7, v26
    v_lshl_add_u32 v26, v3, 5, v26
    v_bfe_u32 v22, v2, 1, 1
    v_lshl_add_u32 v26, v22, 4, v26
    v_mov_b32 v3, v21
    v_mov_b32 v21, 0x3f003f00
    v_mov_b32 v20, 0x3f003f00
    v_mov_b32 v1, v26
    v_mov_b32 v2, v27
    s_cmp_lt_u32 s77, s76
    s_cbranch_scc1 L_hok_25
    s_mov_b32 s28, 0
L_hpoll_26:
    v_bfe_u32 v22, v5, 4, 2
    v_bfe_u32 v23, v5, 4, 3
    v_and_b32 v23, 4, v23
    v_lshlrev_b32 v52, 2, v22
    v_lshl_add_u32 v52, v23, 8, v52
    s_sleep 4
    buffer_load_dword v23, v52, s[12:15], s78 offen sc1
    s_add_u32 s28, s28, 1
    s_cmp_ge_u32 s28, 1048576
    s_cbranch_scc1 L_mega_done
    s_waitcnt vmcnt(0)
    v_lshl_add_u32 v23, v23, 2, v22
    s_nop 0
    v_readlane_b32 s76, v23, 0
    v_readlane_b32 s24, v23, 1
    s_min_u32 s76, s76, s24
    v_readlane_b32 s24, v23, 2
    s_min_u32 s76, s76, s24
    v_readlane_b32 s24, v23, 3
    s_min_u32 s76, s76, s24
    v_readlane_b32 s24, v23, 4
    s_min_u32 s76, s76, s24
    v_readlane_b32 s24, v23, 5
    s_min_u32 s76, s76, s24
    v_readlane_b32 s24, v23, 6
    s_min_u32 s76, s76, s24
    v_readlane_b32 s24, v23, 7
    s_min_u32 s76, s76, s24
    s_cmp_lt_u32 s77, s76
    s_cbranch_scc0 L_hpoll_26
L_hok_25:
    s_add_u32 s77, s77, 1
    s_add_u32 s41, s41, 262144
    s_add_u32 s42, s42, 262144
    s_xor_b32 s88, s88, 8192
    s_xor_b32 s89, s89, 4096
    s_waitcnt vmcnt(3)
    v_lshlrev_b32 v22, 16, v96
    v_and_b32 v23, 0xffff0000, v96
    v_cvt_pk_f16_f32 v40, v22, v23
    v_lshlrev_b32 v22, 16, v97
    v_and_b32 v23, 0xffff0000, v97
    v_cvt_pk_f16_f32 v41, v22, v23
    v_lshlrev_b32 v22, 16, v98
    v_and_b32 v23, 0xffff0000, v98
    v_cvt_pk_f16_f32 v42, v22, v23
    v_lshlrev_b32 v22, 16, v99
    v_and_b32 v23, 0xffff0000, v99
    v_cvt_pk_f16_f32 v43, v22, v23
    v_lshlrev_b32 v22, 16, v100
    v_and_b32 v23, 0xffff0000, v100
    v_cvt_pk_f16_f32 v44, v22, v23
    v_lshlrev_b32 v22, 16, v101
    v_and_b32 v23, 0xffff0000, v101
    v_cvt_pk_f16_f32 v45, v22, v23
    v_lshlrev_b32 v22, 16, v102
    v_and_b32 v23, 0xffff0000, v102
    v_cvt_pk_f16_f32 v46, v22, v23
    v_lshlrev_b32 v22, 16, v103
    v_and_b32 v23, 0xffff0000, v103
    v_cvt_pk_f16_f32 v47, v22, v23
    v_lshlrev_b32 v22, 16, v104
    v_and_b32 v23, 0xffff0000, v104
    v_cvt_pk_f16_f32 v48, v22, v23
    v_lshlrev_b32 v22, 16, v105
    v_and_b32 v23, 0xffff0000, v105
    v_cvt_pk_f16_f32 v49, v22, v23
    v_mov_b64 v[24:25], 0
    v_mov_b64 v[26:27], 0
    v_mov_b64 v[28:29], 0
    v_mov_b64 v[30:31], 0
    v_mov_b64 v[32:33], 0
    v_mov_b64 v[34:35], 0
    v_mov_b64 v[36:37], 0
    v_mov_b64 v[38:39], 0
    v_mov_b64 v[50:51], 0
    v_mov_b64 v[52:53], 0
    v_mov_b64 v[54:55], 0
    v_mov_b64 v[56:57], 0
    v_mov_b64 v[58:59], 0
    v_add_u32 v60, s66, v5
    v_add_u32 v61, s67, v5
    v_add_u32 v62, s68, v5
    v_add_u32 v63, s69, v5
    v_add_u32 v64, s70, v5
    v_add_u32 v68, s71, v5
    v_add_u32 v72, s72, v5
    v_add_u32 v76, s73, v5
    s_waitcnt vmcnt(0)
    s_barrier
    s_lshl_b32 s24, s46, 13
    s_add_u32 s24, s24, 32768
    s_add_u32 s25, s24, s55
    v_add_u32 v22, s25, v5
    s_add_u32 s25, s24, s56
    v_add_u32 v23, s25, v5
    ds_read_b128 v[80:83], v22 offset:0
    ds_read_b128 v[84:87], v22 offset:4096
    ds_read_b128 v[88:91], v22 offset:1024
    ds_read_b128 v[92:95], v22 offset:5120
    ds_read_b128 v[96:99], v23 offset:0
    ds_read_b128 v[100:103], v23 offset:4096
    ds_read_b128 v[104:107], v23 offset:1024
    ds_read_b128 v[108:111], v23 offset:5120
    s_waitcnt lgkmcnt(0)
    s_mov_b32 s28, 0
    s_mov_b32 m0, s89
    s_branch L_rec_tail
L_rec_failR:
    s_nop 7
    s_nop 3
    buffer_load_dwordx4 v[40:43], v1, s[12:15], s30 offen sc1
    buffer_load_dwordx4 v[44:47], v1, s[12:15], s31 offen sc1
    buffer_load_dwordx2 v[48:49], v69, s[12:15], s33 offen sc1
    v_mov_b64 v[24:25], 0
    v_mov_b64 v[26:27], 0
    v_mov_b64 v[28:29], 0
    v_mov_b64 v[30:31], 0
    s_add_u32 s28, s28, 1
    s_cmp_ge_u32 s28, 2097152
    s_cbranch_scc1 L_mega_done
    s_branch L_rec_chkR
L_rec_slowK:
    s_nop 7
    v_cmp_u_f32 vcc, v64, v65
    s_cbranch_vccz L_rec_slowM
    buffer_load_dwordx4 v[40:43], v14, s[12:15], s54 offen sc1
    buffer_load_dwordx4 v[44:47], v14, s[12:15], s54 offen offset:512 sc1
    s_add_u32 s28, s28, 1
    s_cmp_ge_u32 s28, 2097152
    s_cbranch_scc1 L_mega_done
    s_waitcnt vmcnt(0)
    v_mfma_f32_16x16x32_bf16 v[64:67], v[40:43], v[56:59], v[24:27]
    v_mfma_f32_16x16x32_bf16 v[64:67], v[44:47], v[60:63], v[64:67]
    s_nop 7
    s_nop 3
    s_branch L_rec_chkK
L_rec_slowM:
    v_max_f32 v22, v64, v65
    v_mov_b32 v23, v22
    s_nop 1
    v_permlane32_swap_b32 v22, v23
    v_max_f32 v22, v22, v23
    v_mov_b32 v23, v22
    s_nop 1
    v_permlane16_swap_b32 v22, v23
    v_max_f32 v22, v22, v23
    v_mul_f32 v22, s47, v22
    v_max_f32 v22, v22, v79
    v_sub_f32 v23, v79, v22
    v_exp_f32 v23, v23
    v_mov_b32 v79, v22
    v_mul_f32 v28, v28, v23
    v_mul_f32 v29, v29, v23
    v_mul_f32 v30, v30, v23
    v_mul_f32 v31, v31, v23
    v_mul_f32 v32, v32, v23
    v_fma_f32 v22, v64, s47, -v79
    v_fma_f32 v23, v65, s47, -v79
    v_exp_f32 v22, v22
    v_exp_f32 v23, v23
    s_nop 1
    s_branch L_rec_fastK
L_rec_step:
    s_add_u32 s24, s57, 0
    s_lshr_b32 s25, s24, 3
    s_and_b32 s24, s24, 7
    s_lshl_b32 s24, s24, 10
    s_add_u32 s40, s61, s24
    s_lshl_b32 s24, s25, 14
    s_add_u32 s40, s40, s24
    s_add_u32 s57, s57, 10
    s_mov_b32 s39, s82
    s_add_u32 s82, s82, 40960
    s_sub_u32 s24, s82, 122880
    s_cmp_ge_u32 s82, s83
    s_cselect_b32 s82, s24, s82
    s_add_u32 s41, s41, 262144
    s_add_u32 s42, s42, 262144
    s_xor_b32 s88, s88, 8192
    s_xor_b32 s89, s89, 4096
    s_cmp_ge_u32 s23, 61
    s_cbranch_scc0 L_rec_noearly
    s_cmp_ge_u32 s22, 2
    s_cbranch_scc0 L_rec_noearly
    v_xor_b32 v9, s80, v9
    s_mov_b32 s44, s79
    ds_read_b128 v[24:27], v9
    v_xor_b32 v9, s80, v9
    s_waitcnt lgkmcnt(0)
    s_mov_b32 exec_hi, 0
    buffer_store_dwordx4 v[24:27], v5, s[12:15], s44 offen sc1
    s_mov_b32 exec_hi, -1
L_rec_noearly:
    s_cmp_ge_u32 s37, 80
    s_cbranch_scc1 L_rec_nored
    ds_read_b128 v[80:83], v5 offset:57344
    v_mov_b32 v84, -1
    v_mov_b32 v85, -1
    v_lshrrev_b32 v86, 5, v5
    v_and_b32 v86, 8, v86
    v_and_or_b32 v86, v5, s81, v86
    s_add_u32 s40, s40, s50
    s_waitcnt lgkmcnt(0)
    s_cmp_ge_u32 s37, 64
    s_cbranch_scc0 L_rec_mainu2
    v_swap_b32 v81, v82
    v_lshrrev_b32 v86, 1, v5
L_rec_mainu2:
    s_sleep 4
    s_mov_b32 s28, 0
L_recP_loop:
    buffer_load_dwordx4 v[64:67], v5, s[12:15], s38 offen offset:0 sc1
    buffer_load_dwordx4 v[68:71], v5, s[12:15], s38 offen offset:1024 sc1
    buffer_load_dwordx4 v[72:75], v5, s[12:15], s38 offen offset:2048 sc1
    buffer_load_dwordx4 v[76:79], v5, s[12:15], s38 offen offset:3072 sc1
    s_add_u32 s28, s28, 1
    s_cmp_ge_u32 s28, 2097152
    s_cbranch_scc1 L_mega_done
    s_waitcnt vmcnt(3)
    v_mfma_f32_16x16x32_f16 v[88:91], v[80:83], v[64:67], 0
    v_xor_b32 v92, s45, v64
    s_waitcnt vmcnt(2)
    v_mfma_f32_16x16x32_f16 v[88:91], v[80:83], v[68:71], v[88:91]
    v_xor_b32 v93, s45, v68
    s_waitcnt vmcnt(1)
    v_mfma_f32_16x16x32_f16 v[88:91], v[80:83], v[72:75], v[88:91]
    v_xor_b32 v94, s45, v72
    s_waitcnt vmcnt(0)
    v_mfma_f32_16x16x32_f16 v[88:91], v[80:83], v[76:79], v[88:91]
    v_xor_b32 v95, s45, v76
    v_or3_b32 v92, v92, v93, v94
    v_or_b32 v92, v92, v95
    v_and_b32 v92, 1, v92
    v_cmp_ne_u32 vcc, 0, v92
    s_cbranch_vccnz L_recP_loop
L_recP_ok:
    s_nop 1
L_recP_ok2:
    v_add_f32_dpp v88, v88, v88 row_ror:8 row_mask:0xf bank_mask:0xf
    v_add_f32_dpp v89, v89, v89 row_ror:8 row_mask:0xf bank_mask:0xf
    v_add_f32_dpp v90, v90, v90 row_ror:8 row_mask:0xf bank_mask:0xf
    v_add_f32_dpp v91, v91, v91 row_ror:8 row_mask:0xf bank_mask:0xf
    v_cvt_pk_f16_f32 v22, v88, v89
    v_cvt_pk_f16_f32 v23, v90, v91
    s_mov_b64 exec, s[74:75]
    buffer_store_dwordx2 v[22:23], v86, s[12:15], s40 offen sc1
    buffer_store_dwordx2 v[22:23], v3, s[12:15], s39 offen
    buffer_store_dwordx2 v[84:85], v3, s[12:15], s82 offen
    s_mov_b64 exec, -1
    s_branch L_rec_red_done
L_rec_nored:
    s_waitcnt vmcnt(0)
L_rec_red_done:
    s_add_u32 s23, s23, 1
    s_xor_b32 s46, s46, 1
    s_xor_b32 s45, s45, 1
    s_add_u32 s43, s43, 65536
    s_add_u32 s54, s54, 65536
    s_mov_b32 s44, s79
    s_add_u32 s79, s79, 65536
    s_barrier
    s_lshl_b32 s24, s46, 13
    s_add_u32 s24, s24, 32768
    s_add_u32 s25, s24, s55
    v_add_u32 v22, s25, v5
    s_add_u32 s25, s24, s56
    v_add_u32 v23, s25, v5
    ds_read_b128 v[80:83], v22 offset:0
    ds_read_b128 v[84:87], v22 offset:4096
    ds_read_b128 v[88:91], v22 offset:1024
    ds_read_b128 v[92:95], v22 offset:5120
    ds_read_b128 v[96:99], v23 offset:0
    ds_read_b128 v[100:103], v23 offset:4096
    ds_read_b128 v[104:107], v23 offset:1024
    ds_read_b128 v[108:111], v23 offset:5120
    s_add_u32 s24, s32, 0
    s_lshr_b32 s25, s24, 3
    s_and_b32 s24, s24, 7
    s_lshl_b32 s24, s24, 10
    s_add_u32 s30, s60, s24
    s_lshl_b32 s24, s25, 14
    s_add_u32 s30, s30, s24
    s_add_u32 s24, s32, 1
    s_lshr_b32 s25, s24, 3
    s_and_b32 s24, s24, 7
    s_lshl_b32 s24, s24, 10
    s_add_u32 s31, s60, s24
    s_lshl_b32 s24, s25, 14
    s_add_u32 s31, s31, s24
    s_add_u32 s24, s59, 0
    s_lshr_b32 s25, s24, 3
    s_and_b32 s24, s24, 7
    s_lshl_b32 s24, s24, 10
    s_add_u32 s33, s60, s24
    s_lshl_b32 s24, s25, 14
    s_add_u32 s33, s33, s24
    s_and_b32 s24, s22, 1
    s_lshl_b32 s24, s24, 9
    s_add_u32 s33, s33, s24
    s_add_u32 s32, s32, 10
    s_add_u32 s59, s59, 10
    v_lshrrev_b32 v69, 1, v5
    s_cmp_ge_u32 s23, 63
    s_cbranch_scc1 L_rec_nohor
    s_cmp_lt_u32 s77, s76
    s_cbranch_scc1 L_hok_27
    s_mov_b32 s28, 0
L_hpoll_28:
    v_bfe_u32 v22, v5, 4, 2
    v_bfe_u32 v23, v5, 4, 3
    v_and_b32 v23, 4, v23
    v_lshlrev_b32 v52, 2, v22
    v_lshl_add_u32 v52, v23, 8, v52
    s_sleep 4
    buffer_load_dword v23, v52, s[12:15], s78 offen sc1
    s_add_u32 s28, s28, 1
    s_cmp_ge_u32 s28, 1048576
    s_cbranch_scc1 L_mega_done
    s_waitcnt vmcnt(0)
    v_lshl_add_u32 v23, v23, 2, v22
    s_nop 0
    v_readlane_b32 s76, v23, 0
    v_readlane_b32 s24, v23, 1
    s_min_u32 s76, s76, s24
    v_readlane_b32 s24, v23, 2
    s_min_u32 s76, s76, s24
    v_readlane_b32 s24, v23, 3
    s_min_u32 s76, s76, s24
    v_readlane_b32 s24, v23, 4
    s_min_u32 s76, s76, s24
    v_readlane_b32 s24, v23, 5
    s_min_u32 s76, s76, s24
    v_readlane_b32 s24, v23, 6
    s_min_u32 s76, s76, s24
    v_readlane_b32 s24, v23, 7
    s_min_u32 s76, s76, s24
    s_cmp_lt_u32 s77, s76
    s_cbranch_scc0 L_hpoll_28
L_hok_27:
    s_add_u32 s77, s77, 1
L_rec_nohor:
    s_mov_b32 s28, 0
    s_sleep 2
L_rec_pollL:
    buffer_load_dwordx4 v[52:55], v6, s[12:15], s39 offen offset:0 sc1
    buffer_load_dwordx4 v[56:59], v6, s[12:15], s39 offen offset:1024 sc1
    buffer_load_dwordx2 v[50:51], v18, s[12:15], s39 offen sc1
    s_add_u32 s28, s28, 1
    s_cmp_ge_u32 s28, 2097152
    s_cbranch_scc1 L_mega_done
    s_waitcnt vmcnt(0)
    v_max3_u32 v22, v52, v54, v56
    v_max3_u32 v22, v22, v58, v50
    v_cmp_eq_u32 vcc, -1, v22
    s_cbranch_vccnz L_rec_pollL
    buffer_load_dwordx4 v[40:43], v1, s[12:15], s30 offen sc1
    buffer_load_dwordx4 v[44:47], v1, s[12:15], s31 offen sc1
    buffer_load_dwordx2 v[48:49], v69, s[12:15], s33 offen sc1
    v_xor_b32 v2, 0x1000, v2
    v_xor_b32 v9, s80, v9
    v_xor_b32 v15, 0x400, v15
    v_mov_b64 v[24:25], 0
    v_mov_b64 v[26:27], 0
    v_mov_b64 v[28:29], 0
    v_mov_b64 v[30:31], 0
    v_mov_b64 v[32:33], 0
    v_mov_b64 v[34:35], 0
    v_mov_b64 v[36:37], 0
    v_mov_b64 v[38:39], 0
    v_add_u32 v60, s66, v5
    v_add_u32 v61, s67, v5
    v_add_u32 v62, s68, v5
    v_add_u32 v63, s69, v5
    v_add_u32 v64, s70, v5
    v_add_u32 v68, s71, v5
    v_add_u32 v72, s72, v5
    v_add_u32 v76, s73, v5
    s_mov_b32 m0, s89
L_rec_chkR:
    s_waitcnt vmcnt(2)
L_rec_tail:
    v_pk_add_f16 v40, v40, v52
    v_pk_add_f16 v41, v41, v53
    v_pk_add_f16 v42, v42, v54
    v_pk_add_f16 v43, v43, v55
    ds_write_b128 v6, v[40:43] offset:10240
    s_waitcnt vmcnt(1)
    v_pk_add_f16 v44, v44, v56
    v_pk_add_f16 v45, v45, v57
    v_pk_add_f16 v46, v46, v58
    v_pk_add_f16 v47, v47, v59
    ds_write_b128 v6, v[44:47] offset:11264
    s_waitcnt vmcnt(0)
    v_pk_add_f16 v48, v48, v50
    v_pk_add_f16 v49, v49, v51
    ds_write_b64 v18, v[48:49] offset:10240
    v_smfmac_f32_16x16x64_f16 v[24:27], v[40:43], a[0:7], v4
    v_max3_u32 v22, v40, v42, v44
    v_smfmac_f32_16x16x64_f16 v[28:31], v[40:43], a[80:87], v4
    v_max3_u32 v22, v22, v46, v48
    v_smfmac_f32_16x16x64_f16 v[24:27], v[44:47], a[8:15], v4
    v_cmp_eq_u32 vcc, -1, v22
    s_cbranch_vccnz L_rec_failR
    s_waitcnt lgkmcnt(0)
    s_barrier
    ds_read_b128 v[48:51], v60 offset:10240
    ds_read_b128 v[52:55], v61 offset:10240
    ds_read_b128 v[56:59], v62 offset:10240
    v_smfmac_f32_16x16x64_f16 v[28:31], v[44:47], a[88:95], v4
    ds_read_b128 v[60:63], v63 offset:10240
    v_smfmac_f32_16x16x64_f16 v[32:35], v[40:43], a[160:167], v4
    ds_read_b128 v[64:67], v64 offset:10240
    v_smfmac_f32_16x16x64_f16 v[32:35], v[44:47], a[168:175], v4
    ds_read_b128 v[68:71], v68 offset:10240
    v_smfmac_f32_16x16x64_f16 v[36:39], v[40:43], a[240:247], v4
    ds_read_b128 v[72:75], v72 offset:10240
    v_smfmac_f32_16x16x64_f16 v[36:39], v[44:47], a[248:255], v4
    ds_read_b128 v[76:79], v76 offset:10240
    s_waitcnt lgkmcnt(7)
    v_smfmac_f32_16x16x64_f16 v[24:27], v[48:51], a[16:23], v4
    v_smfmac_f32_16x16x64_f16 v[28:31], v[48:51], a[96:103], v4
    s_waitcnt lgkmcnt(6)
    v_smfmac_f32_16x16x64_f16 v[24:27], v[52:55], a[24:31], v4
    v_smfmac_f32_16x16x64_f16 v[28:31], v[52:55], a[104:111], v4
    s_waitcnt lgkmcnt(5)
    v_smfmac_f32_16x16x64_f16 v[24:27], v[56:59], a[32:39], v4
    v_smfmac_f32_16x16x64_f16 v[28:31], v[56:59], a[112:119], v4
    s_waitcnt lgkmcnt(4)
    v_smfmac_f32_16x16x64_f16 v[24:27], v[60:63], a[40:47], v4
    v_smfmac_f32_16x16x64_f16 v[28:31], v[60:63], a[120:127], v4
    s_waitcnt lgkmcnt(3)
    v_smfmac_f32_16x16x64_f16 v[24:27], v[64:67], a[48:55], v4
    v_smfmac_f32_16x16x64_f16 v[28:31], v[64:67], a[128:135], v4
    s_waitcnt lgkmcnt(2)
    v_smfmac_f32_16x16x64_f16 v[24:27], v[68:71], a[56:63], v4
    v_smfmac_f32_16x16x64_f16 v[28:31], v[68:71], a[136:143], v4
    s_waitcnt lgkmcnt(1)
    v_smfmac_f32_16x16x64_f16 v[24:27], v[72:75], a[64:71], v4
    v_smfmac_f32_16x16x64_f16 v[28:31], v[72:75], a[144:151], v4
    s_waitcnt lgkmcnt(0)
    v_smfmac_f32_16x16x64_f16 v[24:27], v[76:79], a[72:79], v4
    v_smfmac_f32_16x16x64_f16 v[28:31], v[76:79], a[152:159], v4
    v_smfmac_f32_16x16x64_f16 v[32:35], v[48:51], a[176:183], v4
    v_smfmac_f32_16x16x64_f16 v[32:35], v[52:55], a[184:191], v4
    v_add_f32 v24, v24, v26
    v_add_f32 v25, v25, v27
    v_cvt_pk_bf16_f32 v24, v24, v25
    buffer_store_short v24, v19, s[12:15], s43 offen
    v_smfmac_f32_16x16x64_f16 v[32:35], v[56:59], a[192:199], v4
    buffer_store_short_d16_hi v24, v19, s[12:15], s43 offen offset:16
    v_smfmac_f32_16x16x64_f16 v[32:35], v[60:63], a[200:207], v4
    ds_write_b16 v19, v24 offset:22528
    v_smfmac_f32_16x16x64_f16 v[32:35], v[64:67], a[208:215], v4
    ds_write_b16_d16_hi v19, v24 offset:22544
    v_smfmac_f32_16x16x64_f16 v[32:35], v[68:71], a[216:223], v4
    v_add_f32 v28, v28, v30
    v_smfmac_f32_16x16x64_f16 v[32:35], v[72:75], a[224:231], v4
    v_add_f32 v29, v29, v31
    v_smfmac_f32_16x16x64_f16 v[32:35], v[76:79], a[232:239], v4
    v_smfmac_f32_16x16x64_f16 v[36:39], v[48:51], v[112:119], v4
    v_smfmac_f32_16x16x64_f16 v[36:39], v[52:55], v[120:127], v4
    v_add_f32 v32, v32, v34
    v_add_f32 v33, v33, v35
    v_cvt_pk_bf16_f32 v22, v28, v32
    ds_write_b32 v7, v22
    v_cvt_pk_bf16_f32 v23, v29, v33
    ds_write_b32 v7, v23 offset:16
    v_smfmac_f32_16x16x64_f16 v[36:39], v[56:59], v[128:135], v4
    buffer_load_dwordx4 v[40:43], v14, s[12:15], s54 offen sc1
    buffer_load_dwordx4 v[44:47], v14, s[12:15], s54 offen offset:512 sc1
    v_smfmac_f32_16x16x64_f16 v[36:39], v[60:63], v[136:143], v4
    s_waitcnt lgkmcnt(0)
    s_barrier
    ds_read_b128 v[48:51], v8 offset:20480
    ds_read_b128 v[52:55], v8 offset:20992
    ds_read_b128 v[56:59], v8 offset:21504
    ds_read_b128 v[60:63], v8 offset:22016
    ds_read_b128 v[24:27], v9
    v_smfmac_f32_16x16x64_f16 v[36:39], v[64:67], v[144:151], v4
    v_smfmac_f32_16x16x64_f16 v[36:39], v[68:71], v[152:159], v4
    ds_read_b128 v[64:67], v14 offset:22528
    ds_read_b128 v[68:71], v14 offset:23040
    v_smfmac_f32_16x16x64_f16 v[36:39], v[72:75], v[160:167], v4
    v_smfmac_f32_16x16x64_f16 v[36:39], v[76:79], v[168:175], v4
    ds_read_b128 v[72:75], v2
    buffer_load_dwordx4 v5, s[12:15], s42 offen sc1 lds
    s_waitcnt lgkmcnt(7)
    v_mfma_f32_16x16x32_bf16 v[28:31], v[80:83], v[48:51], 0
    s_mov_b32 m0, s88
    v_mfma_f32_16x16x32_bf16 v[32:35], v[84:87], v[48:51], 0
    s_waitcnt lgkmcnt(6)
    v_mfma_f32_16x16x32_bf16 v[28:31], v[88:91], v[52:55], v[28:31]
    v_mfma_f32_16x16x32_bf16 v[32:35], v[92:95], v[52:55], v[32:35]
    v_cvt_pk_bf16_f32 v76, v36, v37
    s_waitcnt lgkmcnt(5)
    v_mfma_f32_16x16x32_bf16 v[28:31], v[96:99], v[56:59], v[28:31]
    v_cvt_pk_bf16_f32 v77, v38, v39
    v_add_f32 v36, v36, v38
    v_mfma_f32_16x16x32_bf16 v[32:35], v[100:103], v[56:59], v[32:35]
    v_add_f32 v37, v37, v39
    s_waitcnt lgkmcnt(4)
    v_mfma_f32_16x16x32_bf16 v[28:31], v[104:107], v[60:63], v[28:31]
    v_cvt_pk_bf16_f32 v78, v36, v37
    v_mov_b64 v[38:39], s[100:101]
    s_waitcnt lgkmcnt(3)
    s_mov_b32 exec_hi, 0
    buffer_store_dwordx4 v[24:27], v5, s[12:15], s44 offen sc1
    s_mov_b32 exec_hi, -1
    v_mfma_f32_16x16x32_bf16 v[32:35], v[108:111], v[60:63], v[32:35]
    ds_write_b32 v15, v78
    s_waitcnt lgkmcnt(3)
    v_mfma_f32_16x16x32_bf16 v[24:27], v[64:67], v[48:51], 0
    v_mov_b64 v[36:37], s[100:101]
    s_waitcnt lgkmcnt(2)
    v_mfma_f32_16x16x32_bf16 v[24:27], v[68:71], v[52:55], v[24:27]
    s_cmp_eq_u32 s23, 63
    s_cbranch_scc1 L_rec_final
    v_max3_f32 v22, v28, v29, v30
    v_max3_f32 v23, v31, v32, v33
    v_max3_f32 v22, v22, v34, v35
    v_max_f32 v22, v22, v23
    v_mov_b32 v23, v22
    v_mfma_f32_4x4x4_16b_bf16 v[80:83], v[16:17], v[16:17], 0
    v_mfma_f32_4x4x4_16b_bf16 v[84:87], v[16:17], v[16:17], 0
    v_permlane32_swap_b32 v22, v23
    v_max_f32 v22, v22, v23
    v_mov_b32 v23, v22
    v_mfma_f32_4x4x4_16b_bf16 v[88:91], v[16:17], v[16:17], 0
    v_mfma_f32_4x4x4_16b_bf16 v[92:95], v[16:17], v[16:17], 0
    v_permlane16_swap_b32 v22, v23
    v_max_f32 v22, v22, v23
    v_mul_f32 v79, s47, v22
    v_fma_f32 v28, v28, s47, -v79
    v_exp_f32 v28, v28
    v_fma_f32 v29, v29, s47, -v79
    v_exp_f32 v29, v29
    v_fma_f32 v30, v30, s47, -v79
    v_exp_f32 v30, v30
    v_fma_f32 v31, v31, s47, -v79
    v_exp_f32 v31, v31
    v_fma_f32 v32, v32, s47, -v79
    v_exp_f32 v32, v32
    v_fma_f32 v33, v33, s47, -v79
    v_exp_f32 v33, v33
    v_fma_f32 v34, v34, s47, -v79
    v_exp_f32 v34, v34
    v_fma_f32 v35, v35, s47, -v79
    v_exp_f32 v35, v35
    s_waitcnt vmcnt(2)
    v_mfma_f32_16x16x32_bf16 v[64:67], v[40:43], v[56:59], v[24:27]
    v_cvt_pk_bf16_f32 v48, v28, v29
    v_cvt_pk_bf16_f32 v49, v30, v31
    v_mfma_f32_16x16x32_bf16 v[64:67], v[44:47], v[60:63], v[64:67]
    v_cvt_pk_bf16_f32 v50, v32, v33
    v_cvt_pk_bf16_f32 v51, v34, v35
    s_waitcnt lgkmcnt(1)
    v_mfma_f32_4x4x4_16b_bf16 v[96:99], v[16:17], v[16:17], 0
    v_mfma_f32_16x16x32_bf16 v[32:35], v[36:39], v[48:51], 0
    v_mfma_f32_16x16x32_bf16 v[28:31], v[72:75], v[48:51], 0
L_rec_chkK:
    v_fma_f32 v22, v64, s47, -v79
    v_fma_f32 v23, v65, s47, -v79
    v_cmp_nge_f32 vcc, 0, v22
    v_cmp_nge_f32 s[24:25], 0, v23
    v_exp_f32 v22, v22
    v_exp_f32 v23, v23
    s_or_b64 vcc, vcc, s[24:25]
    s_cbranch_scc1 L_rec_slowK
L_rec_fastK:
    v_cvt_pk_bf16_f32 v68, v22, v23
    v_cvt_pk_bf16_f32 v69, v22, v23
    v_mfma_f32_4x4x4_16b_bf16 v[100:103], v[16:17], v[16:17], 0
    v_mfma_f32_4x4x4_16b_bf16 v[104:107], v[16:17], v[16:17], 0
    v_mfma_f32_16x16x16_bf16 v[56:59], v[20:21], v[68:69], v[32:35]
    v_mov_b64 v[108:109], 0
    v_mov_b64 v[110:111], 0
    v_mfma_f32_16x16x16_bf16 v[44:47], v[76:77], v[68:69], v[28:31]
    v_mov_b64 v[52:53], 0
    v_mov_b64 v[54:55], 0
    v_mov_b64 v[48:49], 0
    v_mov_b64 v[50:51], 0
    v_rcp_f32 v22, v56
    s_nop 2
    v_pk_mul_f32 v[44:45], v[44:45], v[22:23] op_sel_hi:[1,0]
    v_pk_mul_f32 v[46:47], v[46:47], v[22:23] op_sel_hi:[1,0]
    v_cvt_pk_bf16_f32 v22, v44, v45
    v_cvt_pk_bf16_f32 v23, v46, v47
    ds_write_b64 v10, v[22:23]
    buffer_load_dwordx4 v5, s[12:15], s41 offen offset:0 sc1 lds
    buffer_load_dwordx4 v5, s[12:15], s41 offen offset:1024 sc1 lds
    s_waitcnt lgkmcnt(0)
    s_barrier
    ds_read_b128 v[40:43], v5 offset:26624
    s_waitcnt lgkmcnt(0)
    v_smfmac_f32_16x16x64_bf16 v[52:55], v[40:43], v[240:247], v4
    v_smfmac_f32_16x16x64_bf16 v[48:51], v[40:43], v[248:255], v4
    v_smfmac_f32_16x16x64_bf16 v[80:83], v[40:43], v[176:183], v4
    v_smfmac_f32_16x16x64_bf16 v[84:87], v[40:43], v[184:191], v4
    v_add_f32 v52, v52, v54
    v_smfmac_f32_16x16x64_bf16 v[88:91], v[40:43], v[192:199], v4
    v_add_f32 v48, v48, v50
    v_smfmac_f32_16x16x64_bf16 v[92:95], v[40:43], v[200:207], v4
    v_add_f32 v53, v53, v55
    v_smfmac_f32_16x16x64_bf16 v[96:99], v[40:43], v[208:215], v4
    v_add_f32 v49, v49, v51
    v_smfmac_f32_16x16x64_bf16 v[100:103], v[40:43], v[216:223], v4
    v_cvt_pk_f16_f32 v22, v52, v48
    v_smfmac_f32_16x16x64_bf16 v[104:107], v[40:43], v[224:231], v4
    v_cvt_pk_f16_f32 v23, v53, v49
    v_smfmac_f32_16x16x64_bf16 v[108:111], v[40:43], v[232:239], v4
    v_and_or_b32 v22, v22, -2, s45
    buffer_store_dwordx2 v[22:23], v13, s[12:15], s36 offen
    v_pk_add_f32 v[80:81], v[80:81], v[82:83]
    v_pk_add_f32 v[84:85], v[84:85], v[86:87]
    v_cvt_pk_f16_f32 v56, v80, v84
    v_and_or_b32 v56, v56, -2, s45
    v_cvt_pk_f16_f32 v60, v81, v85
    v_and_or_b32 v60, v60, -2, s45
    v_pk_add_f32 v[88:89], v[88:89], v[90:91]
    v_pk_add_f32 v[92:93], v[92:93], v[94:95]
    v_cvt_pk_f16_f32 v57, v88, v92
    v_cvt_pk_f16_f32 v61, v89, v93
    v_pk_add_f32 v[96:97], v[96:97], v[98:99]
    v_pk_add_f32 v[100:101], v[100:101], v[102:103]
    v_cvt_pk_f16_f32 v58, v96, v100
    v_cvt_pk_f16_f32 v62, v97, v101
    v_pk_add_f32 v[104:105], v[104:105], v[106:107]
    v_pk_add_f32 v[108:109], v[108:109], v[110:111]
    v_cvt_pk_f16_f32 v59, v104, v108
    buffer_store_dwordx4 v[56:59], v11, s[12:15], s36 offen
    v_cvt_pk_f16_f32 v63, v105, v109
    buffer_store_dwordx4 v[60:63], v12, s[12:15], s36 offen
    s_branch L_rec_step
L_rec_final:
    s_waitcnt lgkmcnt(0)
    s_barrier
    s_cmp_ge_u32 s22, 2
    s_cbranch_scc0 L_rec_final2
    v_xor_b32 v9, s80, v9
    s_mov_b32 s44, s79
    ds_read_b128 v[24:27], v9
    s_waitcnt lgkmcnt(0)
    s_mov_b32 exec_hi, 0
    buffer_store_dwordx4 v[24:27], v5, s[12:15], s44 offen sc1
    s_mov_b32 exec_hi, -1
L_rec_final2:
    s_waitcnt vmcnt(0)
    s_add_u32 s24, s21, s22
    s_cmp_eq_u32 s24, 0
    s_cbranch_scc0 L_mega_done
    s_sleep 40
    buffer_wbl2 sc1
    s_waitcnt vmcnt(0)
    s_branch L_mega_done
L_mega_bulk:
    s_sub_u32 s2, s20, 2
    s_lshl_b32 s2, s2, 5
    s_add_u32 s2, s2, s21
    s_mov_b32 s25, s22
    s_cmp_ge_u32 s2, 64
    s_cbranch_scc1 L_mega_pre_done
L_mega_qpre:
    s_load_dwordx2 s[16:17], s[0:1], 0
    v_and_b32 v1, 63, v0
    s_add_u32 s29, s2, 4
    s_and_b32 s29, s29, 63
    s_lshl_b32 s29, s29, 5
    s_lshl_b32 s30, s25, 2
    s_add_u32 s29, s29, s30
    s_add_u32 s30, s29, 16
    s_waitcnt lgkmcnt(0)
    s_mov_b32 s18, 2621440
    s_mov_b32 s19, 0x00020000
    v_lshrrev_b32 v2, 4, v1
    v_and_b32 v3, 15, v1
    v_add_u32 v4, s29, v2
    s_mov_b32 s40, 1280
    v_mul_lo_u32 v5, v4, s40
    v_lshl_add_u32 v5, v3, 4, v5
    s_mov_b32 s41, 0
    buffer_load_dwordx4 v[220:223], v5, s[16:19], s41 offen offset:0
    buffer_load_dwordx4 v[224:227], v5, s[16:19], s41 offen offset:256
    buffer_load_dwordx4 v[228:231], v5, s[16:19], s41 offen offset:512
    buffer_load_dwordx4 v[232:235], v5, s[16:19], s41 offen offset:768
    buffer_load_dwordx4 v[236:239], v5, s[16:19], s41 offen offset:1024
    v_lshrrev_b32 v2, 4, v1
    v_and_b32 v3, 15, v1
    v_add_u32 v4, s30, v2
    s_mov_b32 s40, 1280
    v_mul_lo_u32 v5, v4, s40
    v_lshl_add_u32 v5, v3, 4, v5
    s_mov_b32 s41, 0
    buffer_load_dwordx4 v[200:203], v5, s[16:19], s41 offen offset:0
    buffer_load_dwordx4 v[204:207], v5, s[16:19], s41 offen offset:256
    buffer_load_dwordx4 v[208:211], v5, s[16:19], s41 offen offset:512
    buffer_load_dwordx4 v[212:215], v5, s[16:19], s41 offen offset:768
    buffer_load_dwordx4 v[216:219], v5, s[16:19], s41 offen offset:1024
    s_cmp_ge_u32 s2, 60
    s_cbranch_scc0 L_mega_nozero
    v_lshlrev_b32 v8, 6, v0
    v_mov_b32 v4, 0
    s_sub_u32 s28, s2, 60
    s_lshl_b32 s28, s28, 2
    s_add_u32 s28, s28, 116555776
    v_cmp_gt_u32 vcc, 48, v0
    s_and_saveexec_b64 s[26:27], vcc
    s_cbranch_execz L_mega_nz2
    buffer_store_dword v4, v8, s[12:15], s28 offen sc1
L_mega_nz2:
    s_mov_b64 exec, -1
    s_branch L_mega_nomod
L_mega_nozero:
    s_load_dwordx2 s[4:5], s[0:1], 96
    s_load_dwordx2 s[8:9], s[0:1], 88
    s_waitcnt lgkmcnt(0)
    s_mov_b32 s6, 4915200
    s_mov_b32 s7, 0x00020000
    s_mov_b32 s10, 1280
    s_mov_b32 s11, 0x00020000
    v_and_b32 v1, 7, v0
    v_lshrrev_b32 v2, 3, v0
    s_mov_b32 s16, 7680
    v_mul_lo_u32 v3, v2, s16
    s_lshl_b32 s17, s2, 7
    v_lshl_add_u32 v3, v1, 4, v3
    v_add_u32 v3, s17, v3
    v_lshlrev_b32 v4, 1, v2
    buffer_load_ushort v10, v4, s[8:11], 0 offen offset:0
    buffer_load_ushort v11, v4, s[8:11], 0 offen offset:64
    buffer_load_ushort v12, v4, s[8:11], 0 offen offset:128
    buffer_load_ushort v13, v4, s[8:11], 0 offen offset:192
    buffer_load_ushort v14, v4, s[8:11], 0 offen offset:256
    buffer_load_ushort v15, v4, s[8:11], 0 offen offset:320
    buffer_load_ushort v16, v4, s[8:11], 0 offen offset:384
    buffer_load_ushort v17, v4, s[8:11], 0 offen offset:448
    buffer_load_ushort v18, v4, s[8:11], 0 offen offset:512
    buffer_load_ushort v19, v4, s[8:11], 0 offen offset:576
    buffer_load_ushort v20, v4, s[8:11], 0 offen offset:640
    buffer_load_ushort v21, v4, s[8:11], 0 offen offset:704
    buffer_load_ushort v22, v4, s[8:11], 0 offen offset:768
    buffer_load_ushort v23, v4, s[8:11], 0 offen offset:832
    buffer_load_ushort v24, v4, s[8:11], 0 offen offset:896
    buffer_load_ushort v25, v4, s[8:11], 0 offen offset:960
    buffer_load_ushort v26, v4, s[8:11], 0 offen offset:1024
    buffer_load_ushort v27, v4, s[8:11], 0 offen offset:1088
    buffer_load_ushort v28, v4, s[8:11], 0 offen offset:1152
    buffer_load_ushort v29, v4, s[8:11], 0 offen offset:1216
    s_mov_b32 s18, 0
    buffer_load_dwordx4 v[32:35], v3, s[4:7], s18 offen
    s_add_u32 s18, s18, 245760
    buffer_load_dwordx4 v[36:39], v3, s[4:7], s18 offen
    s_add_u32 s18, s18, 245760
    buffer_load_dwordx4 v[40:43], v3, s[4:7], s18 offen
    s_add_u32 s18, s18, 245760
    buffer_load_dwordx4 v[44:47], v3, s[4:7], s18 offen
    s_add_u32 s18, s18, 245760
    buffer_load_dwordx4 v[48:51], v3, s[4:7], s18 offen
    s_add_u32 s18, s18, 245760
    buffer_load_dwordx4 v[52:55], v3, s[4:7], s18 offen
    s_add_u32 s18, s18, 245760
    buffer_load_dwordx4 v[56:59], v3, s[4:7], s18 offen
    s_add_u32 s18, s18, 245760
    buffer_load_dwordx4 v[60:63], v3, s[4:7], s18 offen
    s_add_u32 s18, s18, 245760
    buffer_load_dwordx4 v[64:67], v3, s[4:7], s18 offen
    s_add_u32 s18, s18, 245760
    buffer_load_dwordx4 v[68:71], v3, s[4:7], s18 offen
    s_add_u32 s18, s18, 245760
    buffer_load_dwordx4 v[72:75], v3, s[4:7], s18 offen
    s_add_u32 s18, s18, 245760
    buffer_load_dwordx4 v[76:79], v3, s[4:7], s18 offen
    s_add_u32 s18, s18, 245760
    buffer_load_dwordx4 v[80:83], v3, s[4:7], s18 offen
    s_add_u32 s18, s18, 245760
    buffer_load_dwordx4 v[84:87], v3, s[4:7], s18 offen
    s_add_u32 s18, s18, 245760
    buffer_load_dwordx4 v[88:91], v3, s[4:7], s18 offen
    s_add_u32 s18, s18, 245760
    buffer_load_dwordx4 v[92:95], v3, s[4:7], s18 offen
    s_add_u32 s18, s18, 245760
    buffer_load_dwordx4 v[96:99], v3, s[4:7], s18 offen
    s_add_u32 s18, s18, 245760
    buffer_load_dwordx4 v[100:103], v3, s[4:7], s18 offen
    s_add_u32 s18, s18, 245760
    buffer_load_dwordx4 v[104:107], v3, s[4:7], s18 offen
    s_add_u32 s18, s18, 245760
    buffer_load_dwordx4 v[108:111], v3, s[4:7], s18 offen
    s_add_u32 s18, s18, 245760
    v_mov_b32 v120, 0
    v_mov_b32 v121, 0
    v_mov_b32 v122, 0
    v_mov_b32 v123, 0
    v_mov_b32 v124, 0
    v_mov_b32 v125, 0
    v_mov_b32 v126, 0
    v_mov_b32 v127, 0
    s_waitcnt vmcnt(20)
    s_mov_b32 s19, 0xbfb8aa3b
    v_lshlrev_b32 v10, 16, v10
    v_mul_f32 v5, s19, v10
    v_exp_f32 v5, v5
    s_nop 0
    v_add_f32 v5, 1.0, v5
    v_rcp_f32 v5, v5
    s_nop 0
    v_mul_f32 v10, v10, v5
    v_cvt_pk_bf16_f32 v10, v10, v10
    v_lshlrev_b32 v10, 16, v10
    v_lshlrev_b32 v11, 16, v11
    v_mul_f32 v5, s19, v11
    v_exp_f32 v5, v5
    s_nop 0
    v_add_f32 v5, 1.0, v5
    v_rcp_f32 v5, v5
    s_nop 0
    v_mul_f32 v11, v11, v5
    v_cvt_pk_bf16_f32 v11, v11, v11
    v_lshlrev_b32 v11, 16, v11
    v_lshlrev_b32 v12, 16, v12
    v_mul_f32 v5, s19, v12
    v_exp_f32 v5, v5
    s_nop 0
    v_add_f32 v5, 1.0, v5
    v_rcp_f32 v5, v5
    s_nop 0
    v_mul_f32 v12, v12, v5
    v_cvt_pk_bf16_f32 v12, v12, v12
    v_lshlrev_b32 v12, 16, v12
    v_lshlrev_b32 v13, 16, v13
    v_mul_f32 v5, s19, v13
    v_exp_f32 v5, v5
    s_nop 0
    v_add_f32 v5, 1.0, v5
    v_rcp_f32 v5, v5
    s_nop 0
    v_mul_f32 v13, v13, v5
    v_cvt_pk_bf16_f32 v13, v13, v13
    v_lshlrev_b32 v13, 16, v13
    v_lshlrev_b32 v14, 16, v14
    v_mul_f32 v5, s19, v14
    v_exp_f32 v5, v5
    s_nop 0
    v_add_f32 v5, 1.0, v5
    v_rcp_f32 v5, v5
    s_nop 0
    v_mul_f32 v14, v14, v5
    v_cvt_pk_bf16_f32 v14, v14, v14
    v_lshlrev_b32 v14, 16, v14
    v_lshlrev_b32 v15, 16, v15
    v_mul_f32 v5, s19, v15
    v_exp_f32 v5, v5
    s_nop 0
    v_add_f32 v5, 1.0, v5
    v_rcp_f32 v5, v5
    s_nop 0
    v_mul_f32 v15, v15, v5
    v_cvt_pk_bf16_f32 v15, v15, v15
    v_lshlrev_b32 v15, 16, v15
    v_lshlrev_b32 v16, 16, v16
    v_mul_f32 v5, s19, v16
    v_exp_f32 v5, v5
    s_nop 0
    v_add_f32 v5, 1.0, v5
    v_rcp_f32 v5, v5
    s_nop 0
    v_mul_f32 v16, v16, v5
    v_cvt_pk_bf16_f32 v16, v16, v16
    v_lshlrev_b32 v16, 16, v16
    v_lshlrev_b32 v17, 16, v17
    v_mul_f32 v5, s19, v17
    v_exp_f32 v5, v5
    s_nop 0
    v_add_f32 v5, 1.0, v5
    v_rcp_f32 v5, v5
    s_nop 0
    v_mul_f32 v17, v17, v5
    v_cvt_pk_bf16_f32 v17, v17, v17
    v_lshlrev_b32 v17, 16, v17
    v_lshlrev_b32 v18, 16, v18
    v_mul_f32 v5, s19, v18
    v_exp_f32 v5, v5
    s_nop 0
    v_add_f32 v5, 1.0, v5
    v_rcp_f32 v5, v5
    s_nop 0
    v_mul_f32 v18, v18, v5
    v_cvt_pk_bf16_f32 v18, v18, v18
    v_lshlrev_b32 v18, 16, v18
    v_lshlrev_b32 v19, 16, v19
    v_mul_f32 v5, s19, v19
    v_exp_f32 v5, v5
    s_nop 0
    v_add_f32 v5, 1.0, v5
    v_rcp_f32 v5, v5
    s_nop 0
    v_mul_f32 v19, v19, v5
    v_cvt_pk_bf16_f32 v19, v19, v19
    v_lshlrev_b32 v19, 16, v19
    v_lshlrev_b32 v20, 16, v20
    v_mul_f32 v5, s19, v20
    v_exp_f32 v5, v5
    s_nop 0
    v_add_f32 v5, 1.0, v5
    v_rcp_f32 v5, v5
    s_nop 0
    v_mul_f32 v20, v20, v5
    v_cvt_pk_bf16_f32 v20, v20, v20
    v_lshlrev_b32 v20, 16, v20
    v_lshlrev_b32 v21, 16, v21
    v_mul_f32 v5, s19, v21
    v_exp_f32 v5, v5
    s_nop 0
    v_add_f32 v5, 1.0, v5
    v_rcp_f32 v5, v5
    s_nop 0
    v_mul_f32 v21, v21, v5
    v_cvt_pk_bf16_f32 v21, v21, v21
    v_lshlrev_b32 v21, 16, v21
    v_lshlrev_b32 v22, 16, v22
    v_mul_f32 v5, s19, v22
    v_exp_f32 v5, v5
    s_nop 0
    v_add_f32 v5, 1.0, v5
    v_rcp_f32 v5, v5
    s_nop 0
    v_mul_f32 v22, v22, v5
    v_cvt_pk_bf16_f32 v22, v22, v22
    v_lshlrev_b32 v22, 16, v22
    v_lshlrev_b32 v23, 16, v23
    v_mul_f32 v5, s19, v23
    v_exp_f32 v5, v5
    s_nop 0
    v_add_f32 v5, 1.0, v5
    v_rcp_f32 v5, v5
    s_nop 0
    v_mul_f32 v23, v23, v5
    v_cvt_pk_bf16_f32 v23, v23, v23
    v_lshlrev_b32 v23, 16, v23
    v_lshlrev_b32 v24, 16, v24
    v_mul_f32 v5, s19, v24
    v_exp_f32 v5, v5
    s_nop 0
    v_add_f32 v5, 1.0, v5
    v_rcp_f32 v5, v5
    s_nop 0
    v_mul_f32 v24, v24, v5
    v_cvt_pk_bf16_f32 v24, v24, v24
    v_lshlrev_b32 v24, 16, v24
    v_lshlrev_b32 v25, 16, v25
    v_mul_f32 v5, s19, v25
    v_exp_f32 v5, v5
    s_nop 0
    v_add_f32 v5, 1.0, v5
    v_rcp_f32 v5, v5
    s_nop 0
    v_mul_f32 v25, v25, v5
    v_cvt_pk_bf16_f32 v25, v25, v25
    v_lshlrev_b32 v25, 16, v25
    v_lshlrev_b32 v26, 16, v26
    v_mul_f32 v5, s19, v26
    v_exp_f32 v5, v5
    s_nop 0
    v_add_f32 v5, 1.0, v5
    v_rcp_f32 v5, v5
    s_nop 0
    v_mul_f32 v26, v26, v5
    v_cvt_pk_bf16_f32 v26, v26, v26
    v_lshlrev_b32 v26, 16, v26
    v_lshlrev_b32 v27, 16, v27
    v_mul_f32 v5, s19, v27
    v_exp_f32 v5, v5
    s_nop 0
    v_add_f32 v5, 1.0, v5
    v_rcp_f32 v5, v5
    s_nop 0
    v_mul_f32 v27, v27, v5
    v_cvt_pk_bf16_f32 v27, v27, v27
    v_lshlrev_b32 v27, 16, v27
    v_lshlrev_b32 v28, 16, v28
    v_mul_f32 v5, s19, v28
    v_exp_f32 v5, v5
    s_nop 0
    v_add_f32 v5, 1.0, v5
    v_rcp_f32 v5, v5
    s_nop 0
    v_mul_f32 v28, v28, v5
    v_cvt_pk_bf16_f32 v28, v28, v28
    v_lshlrev_b32 v28, 16, v28
    v_lshlrev_b32 v29, 16, v29
    v_mul_f32 v5, s19, v29
    v_exp_f32 v5, v5
    s_nop 0
    v_add_f32 v5, 1.0, v5
    v_rcp_f32 v5, v5
    s_nop 0
    v_mul_f32 v29, v29, v5
    v_cvt_pk_bf16_f32 v29, v29, v29
    v_lshlrev_b32 v29, 16, v29
    s_waitcnt vmcnt(19)
    v_lshlrev_b32 v5, 16, v32
    v_and_b32 v6, 0xffff0000, v32
    v_fmac_f32 v120, v10, v5
    v_fmac_f32 v121, v10, v6
    v_lshlrev_b32 v5, 16, v33
    v_and_b32 v6, 0xffff0000, v33
    v_fmac_f32 v122, v10, v5
    v_fmac_f32 v123, v10, v6
    v_lshlrev_b32 v5, 16, v34
    v_and_b32 v6, 0xffff0000, v34
    v_fmac_f32 v124, v10, v5
    v_fmac_f32 v125, v10, v6
    v_lshlrev_b32 v5, 16, v35
    v_and_b32 v6, 0xffff0000, v35
    v_fmac_f32 v126, v10, v5
    v_fmac_f32 v127, v10, v6
    s_waitcnt vmcnt(18)
    v_lshlrev_b32 v5, 16, v36
    v_and_b32 v6, 0xffff0000, v36
    v_fmac_f32 v120, v11, v5
    v_fmac_f32 v121, v11, v6
    v_lshlrev_b32 v5, 16, v37
    v_and_b32 v6, 0xffff0000, v37
    v_fmac_f32 v122, v11, v5
    v_fmac_f32 v123, v11, v6
    v_lshlrev_b32 v5, 16, v38
    v_and_b32 v6, 0xffff0000, v38
    v_fmac_f32 v124, v11, v5
    v_fmac_f32 v125, v11, v6
    v_lshlrev_b32 v5, 16, v39
    v_and_b32 v6, 0xffff0000, v39
    v_fmac_f32 v126, v11, v5
    v_fmac_f32 v127, v11, v6
    s_waitcnt vmcnt(17)
    v_lshlrev_b32 v5, 16, v40
    v_and_b32 v6, 0xffff0000, v40
    v_fmac_f32 v120, v12, v5
    v_fmac_f32 v121, v12, v6
    v_lshlrev_b32 v5, 16, v41
    v_and_b32 v6, 0xffff0000, v41
    v_fmac_f32 v122, v12, v5
    v_fmac_f32 v123, v12, v6
    v_lshlrev_b32 v5, 16, v42
    v_and_b32 v6, 0xffff0000, v42
    v_fmac_f32 v124, v12, v5
    v_fmac_f32 v125, v12, v6
    v_lshlrev_b32 v5, 16, v43
    v_and_b32 v6, 0xffff0000, v43
    v_fmac_f32 v126, v12, v5
    v_fmac_f32 v127, v12, v6
    s_waitcnt vmcnt(16)
    v_lshlrev_b32 v5, 16, v44
    v_and_b32 v6, 0xffff0000, v44
    v_fmac_f32 v120, v13, v5
    v_fmac_f32 v121, v13, v6
    v_lshlrev_b32 v5, 16, v45
    v_and_b32 v6, 0xffff0000, v45
    v_fmac_f32 v122, v13, v5
    v_fmac_f32 v123, v13, v6
    v_lshlrev_b32 v5, 16, v46
    v_and_b32 v6, 0xffff0000, v46
    v_fmac_f32 v124, v13, v5
    v_fmac_f32 v125, v13, v6
    v_lshlrev_b32 v5, 16, v47
    v_and_b32 v6, 0xffff0000, v47
    v_fmac_f32 v126, v13, v5
    v_fmac_f32 v127, v13, v6
    s_waitcnt vmcnt(15)
    v_lshlrev_b32 v5, 16, v48
    v_and_b32 v6, 0xffff0000, v48
    v_fmac_f32 v120, v14, v5
    v_fmac_f32 v121, v14, v6
    v_lshlrev_b32 v5, 16, v49
    v_and_b32 v6, 0xffff0000, v49
    v_fmac_f32 v122, v14, v5
    v_fmac_f32 v123, v14, v6
    v_lshlrev_b32 v5, 16, v50
    v_and_b32 v6, 0xffff0000, v50
    v_fmac_f32 v124, v14, v5
    v_fmac_f32 v125, v14, v6
    v_lshlrev_b32 v5, 16, v51
    v_and_b32 v6, 0xffff0000, v51
    v_fmac_f32 v126, v14, v5
    v_fmac_f32 v127, v14, v6
    s_waitcnt vmcnt(14)
    v_lshlrev_b32 v5, 16, v52
    v_and_b32 v6, 0xffff0000, v52
    v_fmac_f32 v120, v15, v5
    v_fmac_f32 v121, v15, v6
    v_lshlrev_b32 v5, 16, v53
    v_and_b32 v6, 0xffff0000, v53
    v_fmac_f32 v122, v15, v5
    v_fmac_f32 v123, v15, v6
    v_lshlrev_b32 v5, 16, v54
    v_and_b32 v6, 0xffff0000, v54
    v_fmac_f32 v124, v15, v5
    v_fmac_f32 v125, v15, v6
    v_lshlrev_b32 v5, 16, v55
    v_and_b32 v6, 0xffff0000, v55
    v_fmac_f32 v126, v15, v5
    v_fmac_f32 v127, v15, v6
    s_waitcnt vmcnt(13)
    v_lshlrev_b32 v5, 16, v56
    v_and_b32 v6, 0xffff0000, v56
    v_fmac_f32 v120, v16, v5
    v_fmac_f32 v121, v16, v6
    v_lshlrev_b32 v5, 16, v57
    v_and_b32 v6, 0xffff0000, v57
    v_fmac_f32 v122, v16, v5
    v_fmac_f32 v123, v16, v6
    v_lshlrev_b32 v5, 16, v58
    v_and_b32 v6, 0xffff0000, v58
    v_fmac_f32 v124, v16, v5
    v_fmac_f32 v125, v16, v6
    v_lshlrev_b32 v5, 16, v59
    v_and_b32 v6, 0xffff0000, v59
    v_fmac_f32 v126, v16, v5
    v_fmac_f32 v127, v16, v6
    s_waitcnt vmcnt(12)
    v_lshlrev_b32 v5, 16, v60
    v_and_b32 v6, 0xffff0000, v60
    v_fmac_f32 v120, v17, v5
    v_fmac_f32 v121, v17, v6
    v_lshlrev_b32 v5, 16, v61
    v_and_b32 v6, 0xffff0000, v61
    v_fmac_f32 v122, v17, v5
    v_fmac_f32 v123, v17, v6
    v_lshlrev_b32 v5, 16, v62
    v_and_b32 v6, 0xffff0000, v62
    v_fmac_f32 v124, v17, v5
    v_fmac_f32 v125, v17, v6
    v_lshlrev_b32 v5, 16, v63
    v_and_b32 v6, 0xffff0000, v63
    v_fmac_f32 v126, v17, v5
    v_fmac_f32 v127, v17, v6
    s_waitcnt vmcnt(11)
    v_lshlrev_b32 v5, 16, v64
    v_and_b32 v6, 0xffff0000, v64
    v_fmac_f32 v120, v18, v5
    v_fmac_f32 v121, v18, v6
    v_lshlrev_b32 v5, 16, v65
    v_and_b32 v6, 0xffff0000, v65
    v_fmac_f32 v122, v18, v5
    v_fmac_f32 v123, v18, v6
    v_lshlrev_b32 v5, 16, v66
    v_and_b32 v6, 0xffff0000, v66
    v_fmac_f32 v124, v18, v5
    v_fmac_f32 v125, v18, v6
    v_lshlrev_b32 v5, 16, v67
    v_and_b32 v6, 0xffff0000, v67
    v_fmac_f32 v126, v18, v5
    v_fmac_f32 v127, v18, v6
    s_waitcnt vmcnt(10)
    v_lshlrev_b32 v5, 16, v68
    v_and_b32 v6, 0xffff0000, v68
    v_fmac_f32 v120, v19, v5
    v_fmac_f32 v121, v19, v6
    v_lshlrev_b32 v5, 16, v69
    v_and_b32 v6, 0xffff0000, v69
    v_fmac_f32 v122, v19, v5
    v_fmac_f32 v123, v19, v6
    v_lshlrev_b32 v5, 16, v70
    v_and_b32 v6, 0xffff0000, v70
    v_fmac_f32 v124, v19, v5
    v_fmac_f32 v125, v19, v6
    v_lshlrev_b32 v5, 16, v71
    v_and_b32 v6, 0xffff0000, v71
    v_fmac_f32 v126, v19, v5
    v_fmac_f32 v127, v19, v6
    s_waitcnt vmcnt(9)
    v_lshlrev_b32 v5, 16, v72
    v_and_b32 v6, 0xffff0000, v72
    v_fmac_f32 v120, v20, v5
    v_fmac_f32 v121, v20, v6
    v_lshlrev_b32 v5, 16, v73
    v_and_b32 v6, 0xffff0000, v73
    v_fmac_f32 v122, v20, v5
    v_fmac_f32 v123, v20, v6
    v_lshlrev_b32 v5, 16, v74
    v_and_b32 v6, 0xffff0000, v74
    v_fmac_f32 v124, v20, v5
    v_fmac_f32 v125, v20, v6
    v_lshlrev_b32 v5, 16, v75
    v_and_b32 v6, 0xffff0000, v75
    v_fmac_f32 v126, v20, v5
    v_fmac_f32 v127, v20, v6
    s_waitcnt vmcnt(8)
    v_lshlrev_b32 v5, 16, v76
    v_and_b32 v6, 0xffff0000, v76
    v_fmac_f32 v120, v21, v5
    v_fmac_f32 v121, v21, v6
    v_lshlrev_b32 v5, 16, v77
    v_and_b32 v6, 0xffff0000, v77
    v_fmac_f32 v122, v21, v5
    v_fmac_f32 v123, v21, v6
    v_lshlrev_b32 v5, 16, v78
    v_and_b32 v6, 0xffff0000, v78
    v_fmac_f32 v124, v21, v5
    v_fmac_f32 v125, v21, v6
    v_lshlrev_b32 v5, 16, v79
    v_and_b32 v6, 0xffff0000, v79
    v_fmac_f32 v126, v21, v5
    v_fmac_f32 v127, v21, v6
    s_waitcnt vmcnt(7)
    v_lshlrev_b32 v5, 16, v80
    v_and_b32 v6, 0xffff0000, v80
    v_fmac_f32 v120, v22, v5
    v_fmac_f32 v121, v22, v6
    v_lshlrev_b32 v5, 16, v81
    v_and_b32 v6, 0xffff0000, v81
    v_fmac_f32 v122, v22, v5
    v_fmac_f32 v123, v22, v6
    v_lshlrev_b32 v5, 16, v82
    v_and_b32 v6, 0xffff0000, v82
    v_fmac_f32 v124, v22, v5
    v_fmac_f32 v125, v22, v6
    v_lshlrev_b32 v5, 16, v83
    v_and_b32 v6, 0xffff0000, v83
    v_fmac_f32 v126, v22, v5
    v_fmac_f32 v127, v22, v6
    s_waitcnt vmcnt(6)
    v_lshlrev_b32 v5, 16, v84
    v_and_b32 v6, 0xffff0000, v84
    v_fmac_f32 v120, v23, v5
    v_fmac_f32 v121, v23, v6
    v_lshlrev_b32 v5, 16, v85
    v_and_b32 v6, 0xffff0000, v85
    v_fmac_f32 v122, v23, v5
    v_fmac_f32 v123, v23, v6
    v_lshlrev_b32 v5, 16, v86
    v_and_b32 v6, 0xffff0000, v86
    v_fmac_f32 v124, v23, v5
    v_fmac_f32 v125, v23, v6
    v_lshlrev_b32 v5, 16, v87
    v_and_b32 v6, 0xffff0000, v87
    v_fmac_f32 v126, v23, v5
    v_fmac_f32 v127, v23, v6
    s_waitcnt vmcnt(5)
    v_lshlrev_b32 v5, 16, v88
    v_and_b32 v6, 0xffff0000, v88
    v_fmac_f32 v120, v24, v5
    v_fmac_f32 v121, v24, v6
    v_lshlrev_b32 v5, 16, v89
    v_and_b32 v6, 0xffff0000, v89
    v_fmac_f32 v122, v24, v5
    v_fmac_f32 v123, v24, v6
    v_lshlrev_b32 v5, 16, v90
    v_and_b32 v6, 0xffff0000, v90
    v_fmac_f32 v124, v24, v5
    v_fmac_f32 v125, v24, v6
    v_lshlrev_b32 v5, 16, v91
    v_and_b32 v6, 0xffff0000, v91
    v_fmac_f32 v126, v24, v5
    v_fmac_f32 v127, v24, v6
    s_waitcnt vmcnt(4)
    v_lshlrev_b32 v5, 16, v92
    v_and_b32 v6, 0xffff0000, v92
    v_fmac_f32 v120, v25, v5
    v_fmac_f32 v121, v25, v6
    v_lshlrev_b32 v5, 16, v93
    v_and_b32 v6, 0xffff0000, v93
    v_fmac_f32 v122, v25, v5
    v_fmac_f32 v123, v25, v6
    v_lshlrev_b32 v5, 16, v94
    v_and_b32 v6, 0xffff0000, v94
    v_fmac_f32 v124, v25, v5
    v_fmac_f32 v125, v25, v6
    v_lshlrev_b32 v5, 16, v95
    v_and_b32 v6, 0xffff0000, v95
    v_fmac_f32 v126, v25, v5
    v_fmac_f32 v127, v25, v6
    s_waitcnt vmcnt(3)
    v_lshlrev_b32 v5, 16, v96
    v_and_b32 v6, 0xffff0000, v96
    v_fmac_f32 v120, v26, v5
    v_fmac_f32 v121, v26, v6
    v_lshlrev_b32 v5, 16, v97
    v_and_b32 v6, 0xffff0000, v97
    v_fmac_f32 v122, v26, v5
    v_fmac_f32 v123, v26, v6
    v_lshlrev_b32 v5, 16, v98
    v_and_b32 v6, 0xffff0000, v98
    v_fmac_f32 v124, v26, v5
    v_fmac_f32 v125, v26, v6
    v_lshlrev_b32 v5, 16, v99
    v_and_b32 v6, 0xffff0000, v99
    v_fmac_f32 v126, v26, v5
    v_fmac_f32 v127, v26, v6
    s_waitcnt vmcnt(2)
    v_lshlrev_b32 v5, 16, v100
    v_and_b32 v6, 0xffff0000, v100
    v_fmac_f32 v120, v27, v5
    v_fmac_f32 v121, v27, v6
    v_lshlrev_b32 v5, 16, v101
    v_and_b32 v6, 0xffff0000, v101
    v_fmac_f32 v122, v27, v5
    v_fmac_f32 v123, v27, v6
    v_lshlrev_b32 v5, 16, v102
    v_and_b32 v6, 0xffff0000, v102
    v_fmac_f32 v124, v27, v5
    v_fmac_f32 v125, v27, v6
    v_lshlrev_b32 v5, 16, v103
    v_and_b32 v6, 0xffff0000, v103
    v_fmac_f32 v126, v27, v5
    v_fmac_f32 v127, v27, v6
    s_waitcnt vmcnt(1)
    v_lshlrev_b32 v5, 16, v104
    v_and_b32 v6, 0xffff0000, v104
    v_fmac_f32 v120, v28, v5
    v_fmac_f32 v121, v28, v6
    v_lshlrev_b32 v5, 16, v105
    v_and_b32 v6, 0xffff0000, v105
    v_fmac_f32 v122, v28, v5
    v_fmac_f32 v123, v28, v6
    v_lshlrev_b32 v5, 16, v106
    v_and_b32 v6, 0xffff0000, v106
    v_fmac_f32 v124, v28, v5
    v_fmac_f32 v125, v28, v6
    v_lshlrev_b32 v5, 16, v107
    v_and_b32 v6, 0xffff0000, v107
    v_fmac_f32 v126, v28, v5
    v_fmac_f32 v127, v28, v6
    s_waitcnt vmcnt(0)
    v_lshlrev_b32 v5, 16, v108
    v_and_b32 v6, 0xffff0000, v108
    v_fmac_f32 v120, v29, v5
    v_fmac_f32 v121, v29, v6
    v_lshlrev_b32 v5, 16, v109
    v_and_b32 v6, 0xffff0000, v109
    v_fmac_f32 v122, v29, v5
    v_fmac_f32 v123, v29, v6
    v_lshlrev_b32 v5, 16, v110
    v_and_b32 v6, 0xffff0000, v110
    v_fmac_f32 v124, v29, v5
    v_fmac_f32 v125, v29, v6
    v_lshlrev_b32 v5, 16, v111
    v_and_b32 v6, 0xffff0000, v111
    v_fmac_f32 v126, v29, v5
    v_fmac_f32 v127, v29, v6
    v_lshlrev_b32 v7, 5, v0
    ds_write_b128 v7, v[120:123]
    ds_write_b128 v7, v[124:127] offset:16
    s_waitcnt lgkmcnt(0)
    s_barrier
    v_cmp_gt_u32 vcc, 64, v0
    s_and_saveexec_b64 s[20:21], vcc
    s_cbranch_execz L_mega_modend
    v_lshlrev_b32 v7, 2, v0
    ds_read_b32 v32, v7 offset:0
    ds_read_b32 v33, v7 offset:256
    ds_read_b32 v34, v7 offset:512
    ds_read_b32 v35, v7 offset:768
    ds_read_b32 v36, v7 offset:1024
    ds_read_b32 v37, v7 offset:1280
    ds_read_b32 v38, v7 offset:1536
    ds_read_b32 v39, v7 offset:1792
    ds_read_b32 v40, v7 offset:2048
    ds_read_b32 v41, v7 offset:2304
    ds_read_b32 v42, v7 offset:2560
    ds_read_b32 v43, v7 offset:2816
    ds_read_b32 v44, v7 offset:3072
    ds_read_b32 v45, v7 offset:3328
    ds_read_b32 v46, v7 offset:3584
    ds_read_b32 v47, v7 offset:3840
    ds_read_b32 v48, v7 offset:4096
    ds_read_b32 v49, v7 offset:4352
    ds_read_b32 v50, v7 offset:4608
    ds_read_b32 v51, v7 offset:4864
    ds_read_b32 v52, v7 offset:5120
    ds_read_b32 v53, v7 offset:5376
    ds_read_b32 v54, v7 offset:5632
    ds_read_b32 v55, v7 offset:5888
    ds_read_b32 v56, v7 offset:6144
    ds_read_b32 v57, v7 offset:6400
    ds_read_b32 v58, v7 offset:6656
    ds_read_b32 v59, v7 offset:6912
    ds_read_b32 v60, v7 offset:7168
    ds_read_b32 v61, v7 offset:7424
    ds_read_b32 v62, v7 offset:7680
    ds_read_b32 v63, v7 offset:7936
    s_waitcnt lgkmcnt(0)
    v_add_f32 v32, v32, v33
    v_add_f32 v32, v32, v34
    v_add_f32 v32, v32, v35
    v_add_f32 v32, v32, v36
    v_add_f32 v32, v32, v37
    v_add_f32 v32, v32, v38
    v_add_f32 v32, v32, v39
    v_add_f32 v32, v32, v40
    v_add_f32 v32, v32, v41
    v_add_f32 v32, v32, v42
    v_add_f32 v32, v32, v43
    v_add_f32 v32, v32, v44
    v_add_f32 v32, v32, v45
    v_add_f32 v32, v32, v46
    v_add_f32 v32, v32, v47
    v_add_f32 v32, v32, v48
    v_add_f32 v32, v32, v49
    v_add_f32 v32, v32, v50
    v_add_f32 v32, v32, v51
    v_add_f32 v32, v32, v52
    v_add_f32 v32, v32, v53
    v_add_f32 v32, v32, v54
    v_add_f32 v32, v32, v55
    v_add_f32 v32, v32, v56
    v_add_f32 v32, v32, v57
    v_add_f32 v32, v32, v58
    v_add_f32 v32, v32, v59
    v_add_f32 v32, v32, v60
    v_add_f32 v32, v32, v61
    v_add_f32 v32, v32, v62
    v_add_f32 v32, v32, v63
    v_cvt_pk_bf16_f32 v32, v32, v32
    v_lshlrev_b32 v32, 16, v32
    s_lshl_b32 s17, s2, 8
    v_add_u32 v7, s17, v7
    buffer_store_dword v32, v7, s[12:15], 0 offen offset:0 sc1
    s_mov_b32 s40, 128
    s_cmp_lt_u32 s2, 20
    s_cselect_b32 s40, 232, s40
    s_waitcnt vmcnt(0)
    v_mov_b32 v250, 0
    v_mov_b32 v251, 1
    s_mov_b64 exec, 1
    buffer_atomic_add v251, v250, s[84:87], s40 offen sc1
    s_mov_b64 exec, -1
L_mega_modend:
    s_mov_b64 exec, -1
L_mega_nomod:
    v_and_b32 v1, 63, v0
    s_waitcnt vmcnt(0)
    v_lshlrev_b32 v28, 16, v220
    v_and_b32 v29, 0xffff0000, v220
    v_lshlrev_b32 v30, 16, v221
    v_and_b32 v31, 0xffff0000, v221
    v_lshlrev_b32 v32, 16, v222
    v_and_b32 v33, 0xffff0000, v222
    v_lshlrev_b32 v34, 16, v223
    v_and_b32 v35, 0xffff0000, v223
    v_lshlrev_b32 v36, 16, v224
    v_and_b32 v37, 0xffff0000, v224
    v_lshlrev_b32 v38, 16, v225
    v_and_b32 v39, 0xffff0000, v225
    v_lshlrev_b32 v40, 16, v226
    v_and_b32 v41, 0xffff0000, v226
    v_lshlrev_b32 v42, 16, v227
    v_and_b32 v43, 0xffff0000, v227
    v_lshlrev_b32 v44, 16, v228
    v_and_b32 v45, 0xffff0000, v228
    v_lshlrev_b32 v46, 16, v229
    v_and_b32 v47, 0xffff0000, v229
    v_lshlrev_b32 v48, 16, v230
    v_and_b32 v49, 0xffff0000, v230
    v_lshlrev_b32 v50, 16, v231
    v_and_b32 v51, 0xffff0000, v231
    v_lshlrev_b32 v52, 16, v232
    v_and_b32 v53, 0xffff0000, v232
    v_lshlrev_b32 v54, 16, v233
    v_and_b32 v55, 0xffff0000, v233
    v_lshlrev_b32 v56, 16, v234
    v_and_b32 v57, 0xffff0000, v234
    v_lshlrev_b32 v58, 16, v235
    v_and_b32 v59, 0xffff0000, v235
    v_lshlrev_b32 v60, 16, v236
    v_and_b32 v61, 0xffff0000, v236
    v_lshlrev_b32 v62, 16, v237
    v_and_b32 v63, 0xffff0000, v237
    v_lshlrev_b32 v64, 16, v238
    v_and_b32 v65, 0xffff0000, v238
    v_lshlrev_b32 v66, 16, v239
    v_and_b32 v67, 0xffff0000, v239
    v_pk_add_f32 v[8:9], v[28:29], v[30:31]
    v_pk_add_f32 v[10:11], v[32:33], v[34:35]
    v_pk_add_f32 v[8:9], v[8:9], v[36:37]
    v_pk_add_f32 v[10:11], v[10:11], v[38:39]
    v_pk_add_f32 v[8:9], v[8:9], v[40:41]
    v_pk_add_f32 v[10:11], v[10:11], v[42:43]
    v_pk_add_f32 v[8:9], v[8:9], v[44:45]
    v_pk_add_f32 v[10:11], v[10:11], v[46:47]
    v_pk_add_f32 v[8:9], v[8:9], v[48:49]
    v_pk_add_f32 v[10:11], v[10:11], v[50:51]
    v_pk_add_f32 v[8:9], v[8:9], v[52:53]
    v_pk_add_f32 v[10:11], v[10:11], v[54:55]
    v_pk_add_f32 v[8:9], v[8:9], v[56:57]
    v_pk_add_f32 v[10:11], v[10:11], v[58:59]
    v_pk_add_f32 v[8:9], v[8:9], v[60:61]
    v_pk_add_f32 v[10:11], v[10:11], v[62:63]
    v_pk_add_f32 v[8:9], v[8:9], v[64:65]
    v_pk_add_f32 v[10:11], v[10:11], v[66:67]
    v_pk_add_f32 v[8:9], v[8:9], v[10:11]
    v_add_f32 v8, v8, v9
    s_nop 1
    v_add_f32_dpp v8, v8, v8 row_ror:8 row_mask:0xf bank_mask:0xf
    s_nop 1
    v_add_f32_dpp v8, v8, v8 row_ror:4 row_mask:0xf bank_mask:0xf
    s_nop 1
    v_add_f32_dpp v8, v8, v8 row_ror:2 row_mask:0xf bank_mask:0xf
    s_nop 1
    v_add_f32_dpp v8, v8, v8 row_ror:1 row_mask:0xf bank_mask:0xf
    s_mov_b32 s42, 0x3acccccd
    v_mul_f32 v8, s42, v8
    v_pk_add_f32 v[12:13], v[28:29], v[8:9] op_sel_hi:[1,0] neg_lo:[0,1] neg_hi:[0,1]
    v_pk_mul_f32 v[10:11], v[12:13], v[12:13]
    v_pk_add_f32 v[12:13], v[30:31], v[8:9] op_sel_hi:[1,0] neg_lo:[0,1] neg_hi:[0,1]
    v_pk_fma_f32 v[10:11], v[12:13], v[12:13], v[10:11]
    v_pk_add_f32 v[12:13], v[32:33], v[8:9] op_sel_hi:[1,0] neg_lo:[0,1] neg_hi:[0,1]
    v_pk_fma_f32 v[10:11], v[12:13], v[12:13], v[10:11]
    v_pk_add_f32 v[12:13], v[34:35], v[8:9] op_sel_hi:[1,0] neg_lo:[0,1] neg_hi:[0,1]
    v_pk_fma_f32 v[10:11], v[12:13], v[12:13], v[10:11]
    v_pk_add_f32 v[12:13], v[36:37], v[8:9] op_sel_hi:[1,0] neg_lo:[0,1] neg_hi:[0,1]
    v_pk_fma_f32 v[10:11], v[12:13], v[12:13], v[10:11]
    v_pk_add_f32 v[12:13], v[38:39], v[8:9] op_sel_hi:[1,0] neg_lo:[0,1] neg_hi:[0,1]
    v_pk_fma_f32 v[10:11], v[12:13], v[12:13], v[10:11]
    v_pk_add_f32 v[12:13], v[40:41], v[8:9] op_sel_hi:[1,0] neg_lo:[0,1] neg_hi:[0,1]
    v_pk_fma_f32 v[10:11], v[12:13], v[12:13], v[10:11]
    v_pk_add_f32 v[12:13], v[42:43], v[8:9] op_sel_hi:[1,0] neg_lo:[0,1] neg_hi:[0,1]
    v_pk_fma_f32 v[10:11], v[12:13], v[12:13], v[10:11]
    v_pk_add_f32 v[12:13], v[44:45], v[8:9] op_sel_hi:[1,0] neg_lo:[0,1] neg_hi:[0,1]
    v_pk_fma_f32 v[10:11], v[12:13], v[12:13], v[10:11]
    v_pk_add_f32 v[12:13], v[46:47], v[8:9] op_sel_hi:[1,0] neg_lo:[0,1] neg_hi:[0,1]
    v_pk_fma_f32 v[10:11], v[12:13], v[12:13], v[10:11]
    v_pk_add_f32 v[12:13], v[48:49], v[8:9] op_sel_hi:[1,0] neg_lo:[0,1] neg_hi:[0,1]
    v_pk_fma_f32 v[10:11], v[12:13], v[12:13], v[10:11]
    v_pk_add_f32 v[12:13], v[50:51], v[8:9] op_sel_hi:[1,0] neg_lo:[0,1] neg_hi:[0,1]
    v_pk_fma_f32 v[10:11], v[12:13], v[12:13], v[10:11]
    v_pk_add_f32 v[12:13], v[52:53], v[8:9] op_sel_hi:[1,0] neg_lo:[0,1] neg_hi:[0,1]
    v_pk_fma_f32 v[10:11], v[12:13], v[12:13], v[10:11]
    v_pk_add_f32 v[12:13], v[54:55], v[8:9] op_sel_hi:[1,0] neg_lo:[0,1] neg_hi:[0,1]
    v_pk_fma_f32 v[10:11], v[12:13], v[12:13], v[10:11]
    v_pk_add_f32 v[12:13], v[56:57], v[8:9] op_sel_hi:[1,0] neg_lo:[0,1] neg_hi:[0,1]
    v_pk_fma_f32 v[10:11], v[12:13], v[12:13], v[10:11]
    v_pk_add_f32 v[12:13], v[58:59], v[8:9] op_sel_hi:[1,0] neg_lo:[0,1] neg_hi:[0,1]
    v_pk_fma_f32 v[10:11], v[12:13], v[12:13], v[10:11]
    v_pk_add_f32 v[12:13], v[60:61], v[8:9] op_sel_hi:[1,0] neg_lo:[0,1] neg_hi:[0,1]
    v_pk_fma_f32 v[10:11], v[12:13], v[12:13], v[10:11]
    v_pk_add_f32 v[12:13], v[62:63], v[8:9] op_sel_hi:[1,0] neg_lo:[0,1] neg_hi:[0,1]
    v_pk_fma_f32 v[10:11], v[12:13], v[12:13], v[10:11]
    v_pk_add_f32 v[12:13], v[64:65], v[8:9] op_sel_hi:[1,0] neg_lo:[0,1] neg_hi:[0,1]
    v_pk_fma_f32 v[10:11], v[12:13], v[12:13], v[10:11]
    v_pk_add_f32 v[12:13], v[66:67], v[8:9] op_sel_hi:[1,0] neg_lo:[0,1] neg_hi:[0,1]
    v_pk_fma_f32 v[10:11], v[12:13], v[12:13], v[10:11]
    v_add_f32 v9, v10, v11
    s_nop 1
    v_add_f32_dpp v9, v9, v9 row_ror:8 row_mask:0xf bank_mask:0xf
    s_nop 1
    v_add_f32_dpp v9, v9, v9 row_ror:4 row_mask:0xf bank_mask:0xf
    s_nop 1
    v_add_f32_dpp v9, v9, v9 row_ror:2 row_mask:0xf bank_mask:0xf
    s_nop 1
    v_add_f32_dpp v9, v9, v9 row_ror:1 row_mask:0xf bank_mask:0xf
    v_mul_f32 v9, s42, v9
    v_cvt_pk_bf16_f32 v10, v8, v9
    v_lshlrev_b32 v8, 16, v10
    v_and_b32 v9, 0xffff0000, v10
    v_add_f32 v9, 0x3727c5ac, v9
    v_cvt_pk_bf16_f32 v9, v9, v9
    v_lshlrev_b32 v9, 16, v9
    v_sqrt_f32 v9, v9
    s_nop 0
    v_cvt_pk_bf16_f32 v9, v9, v9
    v_lshlrev_b32 v9, 16, v9
    v_rcp_f32 v9, v9
    s_nop 0
    v_pk_add_f32 v[28:29], v[28:29], v[8:9] op_sel_hi:[1,0] neg_lo:[0,1] neg_hi:[0,1]
    v_cvt_pk_bf16_f32 v10, v28, v29
    v_lshlrev_b32 v28, 16, v10
    v_and_b32 v29, 0xffff0000, v10
    v_pk_mul_f32 v[28:29], v[28:29], v[8:9] op_sel:[0,1] op_sel_hi:[1,1]
    v_cvt_pk_bf16_f32 v12, v28, v29
    v_lshlrev_b32 v28, 16, v12
    v_and_b32 v29, 0xffff0000, v12
    v_pk_add_f32 v[30:31], v[30:31], v[8:9] op_sel_hi:[1,0] neg_lo:[0,1] neg_hi:[0,1]
    v_cvt_pk_bf16_f32 v11, v30, v31
    v_lshlrev_b32 v30, 16, v11
    v_and_b32 v31, 0xffff0000, v11
    v_pk_mul_f32 v[30:31], v[30:31], v[8:9] op_sel:[0,1] op_sel_hi:[1,1]
    v_cvt_pk_bf16_f32 v13, v30, v31
    v_lshlrev_b32 v30, 16, v13
    v_and_b32 v31, 0xffff0000, v13
    v_pk_add_f32 v[32:33], v[32:33], v[8:9] op_sel_hi:[1,0] neg_lo:[0,1] neg_hi:[0,1]
    v_cvt_pk_bf16_f32 v10, v32, v33
    v_lshlrev_b32 v32, 16, v10
    v_and_b32 v33, 0xffff0000, v10
    v_pk_mul_f32 v[32:33], v[32:33], v[8:9] op_sel:[0,1] op_sel_hi:[1,1]
    v_cvt_pk_bf16_f32 v12, v32, v33
    v_lshlrev_b32 v32, 16, v12
    v_and_b32 v33, 0xffff0000, v12
    v_pk_add_f32 v[34:35], v[34:35], v[8:9] op_sel_hi:[1,0] neg_lo:[0,1] neg_hi:[0,1]
    v_cvt_pk_bf16_f32 v11, v34, v35
    v_lshlrev_b32 v34, 16, v11
    v_and_b32 v35, 0xffff0000, v11
    v_pk_mul_f32 v[34:35], v[34:35], v[8:9] op_sel:[0,1] op_sel_hi:[1,1]
    v_cvt_pk_bf16_f32 v13, v34, v35
    v_lshlrev_b32 v34, 16, v13
    v_and_b32 v35, 0xffff0000, v13
    v_pk_add_f32 v[36:37], v[36:37], v[8:9] op_sel_hi:[1,0] neg_lo:[0,1] neg_hi:[0,1]
    v_cvt_pk_bf16_f32 v10, v36, v37
    v_lshlrev_b32 v36, 16, v10
    v_and_b32 v37, 0xffff0000, v10
    v_pk_mul_f32 v[36:37], v[36:37], v[8:9] op_sel:[0,1] op_sel_hi:[1,1]
    v_cvt_pk_bf16_f32 v12, v36, v37
    v_lshlrev_b32 v36, 16, v12
    v_and_b32 v37, 0xffff0000, v12
    v_pk_add_f32 v[38:39], v[38:39], v[8:9] op_sel_hi:[1,0] neg_lo:[0,1] neg_hi:[0,1]
    v_cvt_pk_bf16_f32 v11, v38, v39
    v_lshlrev_b32 v38, 16, v11
    v_and_b32 v39, 0xffff0000, v11
    v_pk_mul_f32 v[38:39], v[38:39], v[8:9] op_sel:[0,1] op_sel_hi:[1,1]
    v_cvt_pk_bf16_f32 v13, v38, v39
    v_lshlrev_b32 v38, 16, v13
    v_and_b32 v39, 0xffff0000, v13
    v_pk_add_f32 v[40:41], v[40:41], v[8:9] op_sel_hi:[1,0] neg_lo:[0,1] neg_hi:[0,1]
    v_cvt_pk_bf16_f32 v10, v40, v41
    v_lshlrev_b32 v40, 16, v10
    v_and_b32 v41, 0xffff0000, v10
    v_pk_mul_f32 v[40:41], v[40:41], v[8:9] op_sel:[0,1] op_sel_hi:[1,1]
    v_cvt_pk_bf16_f32 v12, v40, v41
    v_lshlrev_b32 v40, 16, v12
    v_and_b32 v41, 0xffff0000, v12
    v_pk_add_f32 v[42:43], v[42:43], v[8:9] op_sel_hi:[1,0] neg_lo:[0,1] neg_hi:[0,1]
    v_cvt_pk_bf16_f32 v11, v42, v43
    v_lshlrev_b32 v42, 16, v11
    v_and_b32 v43, 0xffff0000, v11
    v_pk_mul_f32 v[42:43], v[42:43], v[8:9] op_sel:[0,1] op_sel_hi:[1,1]
    v_cvt_pk_bf16_f32 v13, v42, v43
    v_lshlrev_b32 v42, 16, v13
    v_and_b32 v43, 0xffff0000, v13
    v_pk_add_f32 v[44:45], v[44:45], v[8:9] op_sel_hi:[1,0] neg_lo:[0,1] neg_hi:[0,1]
    v_cvt_pk_bf16_f32 v10, v44, v45
    v_lshlrev_b32 v44, 16, v10
    v_and_b32 v45, 0xffff0000, v10
    v_pk_mul_f32 v[44:45], v[44:45], v[8:9] op_sel:[0,1] op_sel_hi:[1,1]
    v_cvt_pk_bf16_f32 v12, v44, v45
    v_lshlrev_b32 v44, 16, v12
    v_and_b32 v45, 0xffff0000, v12
    v_pk_add_f32 v[46:47], v[46:47], v[8:9] op_sel_hi:[1,0] neg_lo:[0,1] neg_hi:[0,1]
    v_cvt_pk_bf16_f32 v11, v46, v47
    v_lshlrev_b32 v46, 16, v11
    v_and_b32 v47, 0xffff0000, v11
    v_pk_mul_f32 v[46:47], v[46:47], v[8:9] op_sel:[0,1] op_sel_hi:[1,1]
    v_cvt_pk_bf16_f32 v13, v46, v47
    v_lshlrev_b32 v46, 16, v13
    v_and_b32 v47, 0xffff0000, v13
    v_pk_add_f32 v[48:49], v[48:49], v[8:9] op_sel_hi:[1,0] neg_lo:[0,1] neg_hi:[0,1]
    v_cvt_pk_bf16_f32 v10, v48, v49
    v_lshlrev_b32 v48, 16, v10
    v_and_b32 v49, 0xffff0000, v10
    v_pk_mul_f32 v[48:49], v[48:49], v[8:9] op_sel:[0,1] op_sel_hi:[1,1]
    v_cvt_pk_bf16_f32 v12, v48, v49
    v_lshlrev_b32 v48, 16, v12
    v_and_b32 v49, 0xffff0000, v12
    v_pk_add_f32 v[50:51], v[50:51], v[8:9] op_sel_hi:[1,0] neg_lo:[0,1] neg_hi:[0,1]
    v_cvt_pk_bf16_f32 v11, v50, v51
    v_lshlrev_b32 v50, 16, v11
    v_and_b32 v51, 0xffff0000, v11
    v_pk_mul_f32 v[50:51], v[50:51], v[8:9] op_sel:[0,1] op_sel_hi:[1,1]
    v_cvt_pk_bf16_f32 v13, v50, v51
    v_lshlrev_b32 v50, 16, v13
    v_and_b32 v51, 0xffff0000, v13
    v_pk_add_f32 v[52:53], v[52:53], v[8:9] op_sel_hi:[1,0] neg_lo:[0,1] neg_hi:[0,1]
    v_cvt_pk_bf16_f32 v10, v52, v53
    v_lshlrev_b32 v52, 16, v10
    v_and_b32 v53, 0xffff0000, v10
    v_pk_mul_f32 v[52:53], v[52:53], v[8:9] op_sel:[0,1] op_sel_hi:[1,1]
    v_cvt_pk_bf16_f32 v12, v52, v53
    v_lshlrev_b32 v52, 16, v12
    v_and_b32 v53, 0xffff0000, v12
    v_pk_add_f32 v[54:55], v[54:55], v[8:9] op_sel_hi:[1,0] neg_lo:[0,1] neg_hi:[0,1]
    v_cvt_pk_bf16_f32 v11, v54, v55
    v_lshlrev_b32 v54, 16, v11
    v_and_b32 v55, 0xffff0000, v11
    v_pk_mul_f32 v[54:55], v[54:55], v[8:9] op_sel:[0,1] op_sel_hi:[1,1]
    v_cvt_pk_bf16_f32 v13, v54, v55
    v_lshlrev_b32 v54, 16, v13
    v_and_b32 v55, 0xffff0000, v13
    v_pk_add_f32 v[56:57], v[56:57], v[8:9] op_sel_hi:[1,0] neg_lo:[0,1] neg_hi:[0,1]
    v_cvt_pk_bf16_f32 v10, v56, v57
    v_lshlrev_b32 v56, 16, v10
    v_and_b32 v57, 0xffff0000, v10
    v_pk_mul_f32 v[56:57], v[56:57], v[8:9] op_sel:[0,1] op_sel_hi:[1,1]
    v_cvt_pk_bf16_f32 v12, v56, v57
    v_lshlrev_b32 v56, 16, v12
    v_and_b32 v57, 0xffff0000, v12
    v_pk_add_f32 v[58:59], v[58:59], v[8:9] op_sel_hi:[1,0] neg_lo:[0,1] neg_hi:[0,1]
    v_cvt_pk_bf16_f32 v11, v58, v59
    v_lshlrev_b32 v58, 16, v11
    v_and_b32 v59, 0xffff0000, v11
    v_pk_mul_f32 v[58:59], v[58:59], v[8:9] op_sel:[0,1] op_sel_hi:[1,1]
    v_cvt_pk_bf16_f32 v13, v58, v59
    v_lshlrev_b32 v58, 16, v13
    v_and_b32 v59, 0xffff0000, v13
    v_pk_add_f32 v[60:61], v[60:61], v[8:9] op_sel_hi:[1,0] neg_lo:[0,1] neg_hi:[0,1]
    v_cvt_pk_bf16_f32 v10, v60, v61
    v_lshlrev_b32 v60, 16, v10
    v_and_b32 v61, 0xffff0000, v10
    v_pk_mul_f32 v[60:61], v[60:61], v[8:9] op_sel:[0,1] op_sel_hi:[1,1]
    v_cvt_pk_bf16_f32 v12, v60, v61
    v_lshlrev_b32 v60, 16, v12
    v_and_b32 v61, 0xffff0000, v12
    v_pk_add_f32 v[62:63], v[62:63], v[8:9] op_sel_hi:[1,0] neg_lo:[0,1] neg_hi:[0,1]
    v_cvt_pk_bf16_f32 v11, v62, v63
    v_lshlrev_b32 v62, 16, v11
    v_and_b32 v63, 0xffff0000, v11
    v_pk_mul_f32 v[62:63], v[62:63], v[8:9] op_sel:[0,1] op_sel_hi:[1,1]
    v_cvt_pk_bf16_f32 v13, v62, v63
    v_lshlrev_b32 v62, 16, v13
    v_and_b32 v63, 0xffff0000, v13
    v_pk_add_f32 v[64:65], v[64:65], v[8:9] op_sel_hi:[1,0] neg_lo:[0,1] neg_hi:[0,1]
    v_cvt_pk_bf16_f32 v10, v64, v65
    v_lshlrev_b32 v64, 16, v10
    v_and_b32 v65, 0xffff0000, v10
    v_pk_mul_f32 v[64:65], v[64:65], v[8:9] op_sel:[0,1] op_sel_hi:[1,1]
    v_cvt_pk_bf16_f32 v12, v64, v65
    v_lshlrev_b32 v64, 16, v12
    v_and_b32 v65, 0xffff0000, v12
    v_pk_add_f32 v[66:67], v[66:67], v[8:9] op_sel_hi:[1,0] neg_lo:[0,1] neg_hi:[0,1]
    v_cvt_pk_bf16_f32 v11, v66, v67
    v_lshlrev_b32 v66, 16, v11
    v_and_b32 v67, 0xffff0000, v11
    v_pk_mul_f32 v[66:67], v[66:67], v[8:9] op_sel:[0,1] op_sel_hi:[1,1]
    v_cvt_pk_bf16_f32 v13, v66, v67
    v_lshlrev_b32 v66, 16, v13
    v_and_b32 v67, 0xffff0000, v13
    v_lshlrev_b32 v68, 16, v200
    v_and_b32 v69, 0xffff0000, v200
    v_lshlrev_b32 v70, 16, v201
    v_and_b32 v71, 0xffff0000, v201
    v_lshlrev_b32 v72, 16, v202
    v_and_b32 v73, 0xffff0000, v202
    v_lshlrev_b32 v74, 16, v203
    v_and_b32 v75, 0xffff0000, v203
    v_lshlrev_b32 v76, 16, v204
    v_and_b32 v77, 0xffff0000, v204
    v_lshlrev_b32 v78, 16, v205
    v_and_b32 v79, 0xffff0000, v205
    v_lshlrev_b32 v80, 16, v206
    v_and_b32 v81, 0xffff0000, v206
    v_lshlrev_b32 v82, 16, v207
    v_and_b32 v83, 0xffff0000, v207
    v_lshlrev_b32 v84, 16, v208
    v_and_b32 v85, 0xffff0000, v208
    v_lshlrev_b32 v86, 16, v209
    v_and_b32 v87, 0xffff0000, v209
    v_lshlrev_b32 v88, 16, v210
    v_and_b32 v89, 0xffff0000, v210
    v_lshlrev_b32 v90, 16, v211
    v_and_b32 v91, 0xffff0000, v211
    v_lshlrev_b32 v92, 16, v212
    v_and_b32 v93, 0xffff0000, v212
    v_lshlrev_b32 v94, 16, v213
    v_and_b32 v95, 0xffff0000, v213
    v_lshlrev_b32 v96, 16, v214
    v_and_b32 v97, 0xffff0000, v214
    v_lshlrev_b32 v98, 16, v215
    v_and_b32 v99, 0xffff0000, v215
    v_lshlrev_b32 v100, 16, v216
    v_and_b32 v101, 0xffff0000, v216
    v_lshlrev_b32 v102, 16, v217
    v_and_b32 v103, 0xffff0000, v217
    v_lshlrev_b32 v104, 16, v218
    v_and_b32 v105, 0xffff0000, v218
    v_lshlrev_b32 v106, 16, v219
    v_and_b32 v107, 0xffff0000, v219
    v_pk_add_f32 v[8:9], v[68:69], v[70:71]
    v_pk_add_f32 v[10:11], v[72:73], v[74:75]
    v_pk_add_f32 v[8:9], v[8:9], v[76:77]
    v_pk_add_f32 v[10:11], v[10:11], v[78:79]
    v_pk_add_f32 v[8:9], v[8:9], v[80:81]
    v_pk_add_f32 v[10:11], v[10:11], v[82:83]
    v_pk_add_f32 v[8:9], v[8:9], v[84:85]
    v_pk_add_f32 v[10:11], v[10:11], v[86:87]
    v_pk_add_f32 v[8:9], v[8:9], v[88:89]
    v_pk_add_f32 v[10:11], v[10:11], v[90:91]
    v_pk_add_f32 v[8:9], v[8:9], v[92:93]
    v_pk_add_f32 v[10:11], v[10:11], v[94:95]
    v_pk_add_f32 v[8:9], v[8:9], v[96:97]
    v_pk_add_f32 v[10:11], v[10:11], v[98:99]
    v_pk_add_f32 v[8:9], v[8:9], v[100:101]
    v_pk_add_f32 v[10:11], v[10:11], v[102:103]
    v_pk_add_f32 v[8:9], v[8:9], v[104:105]
    v_pk_add_f32 v[10:11], v[10:11], v[106:107]
    v_pk_add_f32 v[8:9], v[8:9], v[10:11]
    v_add_f32 v8, v8, v9
    s_nop 1
    v_add_f32_dpp v8, v8, v8 row_ror:8 row_mask:0xf bank_mask:0xf
    s_nop 1
    v_add_f32_dpp v8, v8, v8 row_ror:4 row_mask:0xf bank_mask:0xf
    s_nop 1
    v_add_f32_dpp v8, v8, v8 row_ror:2 row_mask:0xf bank_mask:0xf
    s_nop 1
    v_add_f32_dpp v8, v8, v8 row_ror:1 row_mask:0xf bank_mask:0xf
    s_mov_b32 s42, 0x3acccccd
    v_mul_f32 v8, s42, v8
    v_pk_add_f32 v[12:13], v[68:69], v[8:9] op_sel_hi:[1,0] neg_lo:[0,1] neg_hi:[0,1]
    v_pk_mul_f32 v[10:11], v[12:13], v[12:13]
    v_pk_add_f32 v[12:13], v[70:71], v[8:9] op_sel_hi:[1,0] neg_lo:[0,1] neg_hi:[0,1]
    v_pk_fma_f32 v[10:11], v[12:13], v[12:13], v[10:11]
    v_pk_add_f32 v[12:13], v[72:73], v[8:9] op_sel_hi:[1,0] neg_lo:[0,1] neg_hi:[0,1]
    v_pk_fma_f32 v[10:11], v[12:13], v[12:13], v[10:11]
    v_pk_add_f32 v[12:13], v[74:75], v[8:9] op_sel_hi:[1,0] neg_lo:[0,1] neg_hi:[0,1]
    v_pk_fma_f32 v[10:11], v[12:13], v[12:13], v[10:11]
    v_pk_add_f32 v[12:13], v[76:77], v[8:9] op_sel_hi:[1,0] neg_lo:[0,1] neg_hi:[0,1]
    v_pk_fma_f32 v[10:11], v[12:13], v[12:13], v[10:11]
    v_pk_add_f32 v[12:13], v[78:79], v[8:9] op_sel_hi:[1,0] neg_lo:[0,1] neg_hi:[0,1]
    v_pk_fma_f32 v[10:11], v[12:13], v[12:13], v[10:11]
    v_pk_add_f32 v[12:13], v[80:81], v[8:9] op_sel_hi:[1,0] neg_lo:[0,1] neg_hi:[0,1]
    v_pk_fma_f32 v[10:11], v[12:13], v[12:13], v[10:11]
    v_pk_add_f32 v[12:13], v[82:83], v[8:9] op_sel_hi:[1,0] neg_lo:[0,1] neg_hi:[0,1]
    v_pk_fma_f32 v[10:11], v[12:13], v[12:13], v[10:11]
    v_pk_add_f32 v[12:13], v[84:85], v[8:9] op_sel_hi:[1,0] neg_lo:[0,1] neg_hi:[0,1]
    v_pk_fma_f32 v[10:11], v[12:13], v[12:13], v[10:11]
    v_pk_add_f32 v[12:13], v[86:87], v[8:9] op_sel_hi:[1,0] neg_lo:[0,1] neg_hi:[0,1]
    v_pk_fma_f32 v[10:11], v[12:13], v[12:13], v[10:11]
    v_pk_add_f32 v[12:13], v[88:89], v[8:9] op_sel_hi:[1,0] neg_lo:[0,1] neg_hi:[0,1]
    v_pk_fma_f32 v[10:11], v[12:13], v[12:13], v[10:11]
    v_pk_add_f32 v[12:13], v[90:91], v[8:9] op_sel_hi:[1,0] neg_lo:[0,1] neg_hi:[0,1]
    v_pk_fma_f32 v[10:11], v[12:13], v[12:13], v[10:11]
    v_pk_add_f32 v[12:13], v[92:93], v[8:9] op_sel_hi:[1,0] neg_lo:[0,1] neg_hi:[0,1]
    v_pk_fma_f32 v[10:11], v[12:13], v[12:13], v[10:11]
    v_pk_add_f32 v[12:13], v[94:95], v[8:9] op_sel_hi:[1,0] neg_lo:[0,1] neg_hi:[0,1]
    v_pk_fma_f32 v[10:11], v[12:13], v[12:13], v[10:11]
    v_pk_add_f32 v[12:13], v[96:97], v[8:9] op_sel_hi:[1,0] neg_lo:[0,1] neg_hi:[0,1]
    v_pk_fma_f32 v[10:11], v[12:13], v[12:13], v[10:11]
    v_pk_add_f32 v[12:13], v[98:99], v[8:9] op_sel_hi:[1,0] neg_lo:[0,1] neg_hi:[0,1]
    v_pk_fma_f32 v[10:11], v[12:13], v[12:13], v[10:11]
    v_pk_add_f32 v[12:13], v[100:101], v[8:9] op_sel_hi:[1,0] neg_lo:[0,1] neg_hi:[0,1]
    v_pk_fma_f32 v[10:11], v[12:13], v[12:13], v[10:11]
    v_pk_add_f32 v[12:13], v[102:103], v[8:9] op_sel_hi:[1,0] neg_lo:[0,1] neg_hi:[0,1]
    v_pk_fma_f32 v[10:11], v[12:13], v[12:13], v[10:11]
    v_pk_add_f32 v[12:13], v[104:105], v[8:9] op_sel_hi:[1,0] neg_lo:[0,1] neg_hi:[0,1]
    v_pk_fma_f32 v[10:11], v[12:13], v[12:13], v[10:11]
    v_pk_add_f32 v[12:13], v[106:107], v[8:9] op_sel_hi:[1,0] neg_lo:[0,1] neg_hi:[0,1]
    v_pk_fma_f32 v[10:11], v[12:13], v[12:13], v[10:11]
    v_add_f32 v9, v10, v11
    s_nop 1
    v_add_f32_dpp v9, v9, v9 row_ror:8 row_mask:0xf bank_mask:0xf
    s_nop 1
    v_add_f32_dpp v9, v9, v9 row_ror:4 row_mask:0xf bank_mask:0xf
    s_nop 1
    v_add_f32_dpp v9, v9, v9 row_ror:2 row_mask:0xf bank_mask:0xf
    s_nop 1
    v_add_f32_dpp v9, v9, v9 row_ror:1 row_mask:0xf bank_mask:0xf
    v_mul_f32 v9, s42, v9
    v_cvt_pk_bf16_f32 v10, v8, v9
    v_lshlrev_b32 v8, 16, v10
    v_and_b32 v9, 0xffff0000, v10
    v_add_f32 v9, 0x3727c5ac, v9
    v_cvt_pk_bf16_f32 v9, v9, v9
    v_lshlrev_b32 v9, 16, v9
    v_sqrt_f32 v9, v9
    s_nop 0
    v_cvt_pk_bf16_f32 v9, v9, v9
    v_lshlrev_b32 v9, 16, v9
    v_rcp_f32 v9, v9
    s_nop 0
    v_pk_add_f32 v[68:69], v[68:69], v[8:9] op_sel_hi:[1,0] neg_lo:[0,1] neg_hi:[0,1]
    v_cvt_pk_bf16_f32 v10, v68, v69
    v_lshlrev_b32 v68, 16, v10
    v_and_b32 v69, 0xffff0000, v10
    v_pk_mul_f32 v[68:69], v[68:69], v[8:9] op_sel:[0,1] op_sel_hi:[1,1]
    v_cvt_pk_bf16_f32 v12, v68, v69
    v_lshlrev_b32 v68, 16, v12
    v_and_b32 v69, 0xffff0000, v12
    v_pk_add_f32 v[70:71], v[70:71], v[8:9] op_sel_hi:[1,0] neg_lo:[0,1] neg_hi:[0,1]
    v_cvt_pk_bf16_f32 v11, v70, v71
    v_lshlrev_b32 v70, 16, v11
    v_and_b32 v71, 0xffff0000, v11
    v_pk_mul_f32 v[70:71], v[70:71], v[8:9] op_sel:[0,1] op_sel_hi:[1,1]
    v_cvt_pk_bf16_f32 v13, v70, v71
    v_lshlrev_b32 v70, 16, v13
    v_and_b32 v71, 0xffff0000, v13
    v_pk_add_f32 v[72:73], v[72:73], v[8:9] op_sel_hi:[1,0] neg_lo:[0,1] neg_hi:[0,1]
    v_cvt_pk_bf16_f32 v10, v72, v73
    v_lshlrev_b32 v72, 16, v10
    v_and_b32 v73, 0xffff0000, v10
    v_pk_mul_f32 v[72:73], v[72:73], v[8:9] op_sel:[0,1] op_sel_hi:[1,1]
    v_cvt_pk_bf16_f32 v12, v72, v73
    v_lshlrev_b32 v72, 16, v12
    v_and_b32 v73, 0xffff0000, v12
    v_pk_add_f32 v[74:75], v[74:75], v[8:9] op_sel_hi:[1,0] neg_lo:[0,1] neg_hi:[0,1]
    v_cvt_pk_bf16_f32 v11, v74, v75
    v_lshlrev_b32 v74, 16, v11
    v_and_b32 v75, 0xffff0000, v11
    v_pk_mul_f32 v[74:75], v[74:75], v[8:9] op_sel:[0,1] op_sel_hi:[1,1]
    v_cvt_pk_bf16_f32 v13, v74, v75
    v_lshlrev_b32 v74, 16, v13
    v_and_b32 v75, 0xffff0000, v13
    v_pk_add_f32 v[76:77], v[76:77], v[8:9] op_sel_hi:[1,0] neg_lo:[0,1] neg_hi:[0,1]
    v_cvt_pk_bf16_f32 v10, v76, v77
    v_lshlrev_b32 v76, 16, v10
    v_and_b32 v77, 0xffff0000, v10
    v_pk_mul_f32 v[76:77], v[76:77], v[8:9] op_sel:[0,1] op_sel_hi:[1,1]
    v_cvt_pk_bf16_f32 v12, v76, v77
    v_lshlrev_b32 v76, 16, v12
    v_and_b32 v77, 0xffff0000, v12
    v_pk_add_f32 v[78:79], v[78:79], v[8:9] op_sel_hi:[1,0] neg_lo:[0,1] neg_hi:[0,1]
    v_cvt_pk_bf16_f32 v11, v78, v79
    v_lshlrev_b32 v78, 16, v11
    v_and_b32 v79, 0xffff0000, v11
    v_pk_mul_f32 v[78:79], v[78:79], v[8:9] op_sel:[0,1] op_sel_hi:[1,1]
    v_cvt_pk_bf16_f32 v13, v78, v79
    v_lshlrev_b32 v78, 16, v13
    v_and_b32 v79, 0xffff0000, v13
    v_pk_add_f32 v[80:81], v[80:81], v[8:9] op_sel_hi:[1,0] neg_lo:[0,1] neg_hi:[0,1]
    v_cvt_pk_bf16_f32 v10, v80, v81
    v_lshlrev_b32 v80, 16, v10
    v_and_b32 v81, 0xffff0000, v10
    v_pk_mul_f32 v[80:81], v[80:81], v[8:9] op_sel:[0,1] op_sel_hi:[1,1]
    v_cvt_pk_bf16_f32 v12, v80, v81
    v_lshlrev_b32 v80, 16, v12
    v_and_b32 v81, 0xffff0000, v12
    v_pk_add_f32 v[82:83], v[82:83], v[8:9] op_sel_hi:[1,0] neg_lo:[0,1] neg_hi:[0,1]
    v_cvt_pk_bf16_f32 v11, v82, v83
    v_lshlrev_b32 v82, 16, v11
    v_and_b32 v83, 0xffff0000, v11
    v_pk_mul_f32 v[82:83], v[82:83], v[8:9] op_sel:[0,1] op_sel_hi:[1,1]
    v_cvt_pk_bf16_f32 v13, v82, v83
    v_lshlrev_b32 v82, 16, v13
    v_and_b32 v83, 0xffff0000, v13
    v_pk_add_f32 v[84:85], v[84:85], v[8:9] op_sel_hi:[1,0] neg_lo:[0,1] neg_hi:[0,1]
    v_cvt_pk_bf16_f32 v10, v84, v85
    v_lshlrev_b32 v84, 16, v10
    v_and_b32 v85, 0xffff0000, v10
    v_pk_mul_f32 v[84:85], v[84:85], v[8:9] op_sel:[0,1] op_sel_hi:[1,1]
    v_cvt_pk_bf16_f32 v12, v84, v85
    v_lshlrev_b32 v84, 16, v12
    v_and_b32 v85, 0xffff0000, v12
    v_pk_add_f32 v[86:87], v[86:87], v[8:9] op_sel_hi:[1,0] neg_lo:[0,1] neg_hi:[0,1]
    v_cvt_pk_bf16_f32 v11, v86, v87
    v_lshlrev_b32 v86, 16, v11
    v_and_b32 v87, 0xffff0000, v11
    v_pk_mul_f32 v[86:87], v[86:87], v[8:9] op_sel:[0,1] op_sel_hi:[1,1]
    v_cvt_pk_bf16_f32 v13, v86, v87
    v_lshlrev_b32 v86, 16, v13
    v_and_b32 v87, 0xffff0000, v13
    v_pk_add_f32 v[88:89], v[88:89], v[8:9] op_sel_hi:[1,0] neg_lo:[0,1] neg_hi:[0,1]
    v_cvt_pk_bf16_f32 v10, v88, v89
    v_lshlrev_b32 v88, 16, v10
    v_and_b32 v89, 0xffff0000, v10
    v_pk_mul_f32 v[88:89], v[88:89], v[8:9] op_sel:[0,1] op_sel_hi:[1,1]
    v_cvt_pk_bf16_f32 v12, v88, v89
    v_lshlrev_b32 v88, 16, v12
    v_and_b32 v89, 0xffff0000, v12
    v_pk_add_f32 v[90:91], v[90:91], v[8:9] op_sel_hi:[1,0] neg_lo:[0,1] neg_hi:[0,1]
    v_cvt_pk_bf16_f32 v11, v90, v91
    v_lshlrev_b32 v90, 16, v11
    v_and_b32 v91, 0xffff0000, v11
    v_pk_mul_f32 v[90:91], v[90:91], v[8:9] op_sel:[0,1] op_sel_hi:[1,1]
    v_cvt_pk_bf16_f32 v13, v90, v91
    v_lshlrev_b32 v90, 16, v13
    v_and_b32 v91, 0xffff0000, v13
    v_pk_add_f32 v[92:93], v[92:93], v[8:9] op_sel_hi:[1,0] neg_lo:[0,1] neg_hi:[0,1]
    v_cvt_pk_bf16_f32 v10, v92, v93
    v_lshlrev_b32 v92, 16, v10
    v_and_b32 v93, 0xffff0000, v10
    v_pk_mul_f32 v[92:93], v[92:93], v[8:9] op_sel:[0,1] op_sel_hi:[1,1]
    v_cvt_pk_bf16_f32 v12, v92, v93
    v_lshlrev_b32 v92, 16, v12
    v_and_b32 v93, 0xffff0000, v12
    v_pk_add_f32 v[94:95], v[94:95], v[8:9] op_sel_hi:[1,0] neg_lo:[0,1] neg_hi:[0,1]
    v_cvt_pk_bf16_f32 v11, v94, v95
    v_lshlrev_b32 v94, 16, v11
    v_and_b32 v95, 0xffff0000, v11
    v_pk_mul_f32 v[94:95], v[94:95], v[8:9] op_sel:[0,1] op_sel_hi:[1,1]
    v_cvt_pk_bf16_f32 v13, v94, v95
    v_lshlrev_b32 v94, 16, v13
    v_and_b32 v95, 0xffff0000, v13
    v_pk_add_f32 v[96:97], v[96:97], v[8:9] op_sel_hi:[1,0] neg_lo:[0,1] neg_hi:[0,1]
    v_cvt_pk_bf16_f32 v10, v96, v97
    v_lshlrev_b32 v96, 16, v10
    v_and_b32 v97, 0xffff0000, v10
    v_pk_mul_f32 v[96:97], v[96:97], v[8:9] op_sel:[0,1] op_sel_hi:[1,1]
    v_cvt_pk_bf16_f32 v12, v96, v97
    v_lshlrev_b32 v96, 16, v12
    v_and_b32 v97, 0xffff0000, v12
    v_pk_add_f32 v[98:99], v[98:99], v[8:9] op_sel_hi:[1,0] neg_lo:[0,1] neg_hi:[0,1]
    v_cvt_pk_bf16_f32 v11, v98, v99
    v_lshlrev_b32 v98, 16, v11
    v_and_b32 v99, 0xffff0000, v11
    v_pk_mul_f32 v[98:99], v[98:99], v[8:9] op_sel:[0,1] op_sel_hi:[1,1]
    v_cvt_pk_bf16_f32 v13, v98, v99
    v_lshlrev_b32 v98, 16, v13
    v_and_b32 v99, 0xffff0000, v13
    v_pk_add_f32 v[100:101], v[100:101], v[8:9] op_sel_hi:[1,0] neg_lo:[0,1] neg_hi:[0,1]
    v_cvt_pk_bf16_f32 v10, v100, v101
    v_lshlrev_b32 v100, 16, v10
    v_and_b32 v101, 0xffff0000, v10
    v_pk_mul_f32 v[100:101], v[100:101], v[8:9] op_sel:[0,1] op_sel_hi:[1,1]
    v_cvt_pk_bf16_f32 v12, v100, v101
    v_lshlrev_b32 v100, 16, v12
    v_and_b32 v101, 0xffff0000, v12
    v_pk_add_f32 v[102:103], v[102:103], v[8:9] op_sel_hi:[1,0] neg_lo:[0,1] neg_hi:[0,1]
    v_cvt_pk_bf16_f32 v11, v102, v103
    v_lshlrev_b32 v102, 16, v11
    v_and_b32 v103, 0xffff0000, v11
    v_pk_mul_f32 v[102:103], v[102:103], v[8:9] op_sel:[0,1] op_sel_hi:[1,1]
    v_cvt_pk_bf16_f32 v13, v102, v103
    v_lshlrev_b32 v102, 16, v13
    v_and_b32 v103, 0xffff0000, v13
    v_pk_add_f32 v[104:105], v[104:105], v[8:9] op_sel_hi:[1,0] neg_lo:[0,1] neg_hi:[0,1]
    v_cvt_pk_bf16_f32 v10, v104, v105
    v_lshlrev_b32 v104, 16, v10
    v_and_b32 v105, 0xffff0000, v10
    v_pk_mul_f32 v[104:105], v[104:105], v[8:9] op_sel:[0,1] op_sel_hi:[1,1]
    v_cvt_pk_bf16_f32 v12, v104, v105
    v_lshlrev_b32 v104, 16, v12
    v_and_b32 v105, 0xffff0000, v12
    v_pk_add_f32 v[106:107], v[106:107], v[8:9] op_sel_hi:[1,0] neg_lo:[0,1] neg_hi:[0,1]
    v_cvt_pk_bf16_f32 v11, v106, v107
    v_lshlrev_b32 v106, 16, v11
    v_and_b32 v107, 0xffff0000, v11
    v_pk_mul_f32 v[106:107], v[106:107], v[8:9] op_sel:[0,1] op_sel_hi:[1,1]
    v_cvt_pk_bf16_f32 v13, v106, v107
    v_lshlrev_b32 v106, 16, v13
    v_and_b32 v107, 0xffff0000, v13
    s_cmp_ge_u32 s2, 60
    s_cbranch_scc1 L_mega_fw
    s_sleep 20
L_mega_fw:
    s_cmp_eq_u32 s25, 0
    s_cbranch_scc0 L_wgw_29
    s_mov_b32 s40, 232
    s_mov_b32 s98, 0
    v_mov_b32 v250, 0
L_wait_30:
    buffer_load_dword v251, v250, s[84:87], s40 offen sc1
    s_waitcnt vmcnt(0)
    v_readfirstlane_b32 s99, v251
    s_cmp_ge_u32 s99, 20
    s_cbranch_scc1 L_ok_31
    s_sleep 3
    s_add_u32 s98, s98, 1
    s_cmp_lt_u32 s98, 1048576
    s_cbranch_scc1 L_wait_30
    s_branch L_mega_done
L_ok_31:
L_wgw_29:
    s_barrier
    v_and_b32 v3, 15, v1
    v_lshlrev_b32 v6, 5, v3
    s_mov_b32 s43, 2560
    buffer_load_dwordx4 v[140:143], v6, s[12:15], s43 offen offset:0 sc1
    buffer_load_dwordx4 v[144:147], v6, s[12:15], s43 offen offset:16 sc1
    buffer_load_dwordx4 v[148:151], v6, s[12:15], s43 offen offset:512 sc1
    buffer_load_dwordx4 v[152:155], v6, s[12:15], s43 offen offset:528 sc1
    buffer_load_dwordx4 v[156:159], v6, s[12:15], s43 offen offset:1024 sc1
    buffer_load_dwordx4 v[160:163], v6, s[12:15], s43 offen offset:1040 sc1
    buffer_load_dwordx4 v[164:167], v6, s[12:15], s43 offen offset:1536 sc1
    buffer_load_dwordx4 v[168:171], v6, s[12:15], s43 offen offset:1552 sc1
    buffer_load_dwordx4 v[172:175], v6, s[12:15], s43 offen offset:2048 sc1
    buffer_load_dwordx4 v[176:179], v6, s[12:15], s43 offen offset:2064 sc1
    s_mov_b32 s43, 0
    buffer_load_dwordx4 v[180:183], v6, s[12:15], s43 offen offset:0 sc1
    buffer_load_dwordx4 v[184:187], v6, s[12:15], s43 offen offset:16 sc1
    buffer_load_dwordx4 v[188:191], v6, s[12:15], s43 offen offset:512 sc1
    buffer_load_dwordx4 v[192:195], v6, s[12:15], s43 offen offset:528 sc1
    buffer_load_dwordx4 v[196:199], v6, s[12:15], s43 offen offset:1024 sc1
    buffer_load_dwordx4 v[200:203], v6, s[12:15], s43 offen offset:1040 sc1
    buffer_load_dwordx4 v[204:207], v6, s[12:15], s43 offen offset:1536 sc1
    buffer_load_dwordx4 v[208:211], v6, s[12:15], s43 offen offset:1552 sc1
    buffer_load_dwordx4 v[212:215], v6, s[12:15], s43 offen offset:2048 sc1
    buffer_load_dwordx4 v[216:219], v6, s[12:15], s43 offen offset:2064 sc1
    s_waitcnt vmcnt(10)
    v_add_f32 v140, 1.0, v140
    v_add_f32 v141, 1.0, v141
    v_cvt_pk_bf16_f32 v10, v140, v141
    v_lshlrev_b32 v140, 16, v10
    v_and_b32 v141, 0xffff0000, v10
    v_add_f32 v142, 1.0, v142
    v_add_f32 v143, 1.0, v143
    v_cvt_pk_bf16_f32 v10, v142, v143
    v_lshlrev_b32 v142, 16, v10
    v_and_b32 v143, 0xffff0000, v10
    v_add_f32 v144, 1.0, v144
    v_add_f32 v145, 1.0, v145
    v_cvt_pk_bf16_f32 v10, v144, v145
    v_lshlrev_b32 v144, 16, v10
    v_and_b32 v145, 0xffff0000, v10
    v_add_f32 v146, 1.0, v146
    v_add_f32 v147, 1.0, v147
    v_cvt_pk_bf16_f32 v10, v146, v147
    v_lshlrev_b32 v146, 16, v10
    v_and_b32 v147, 0xffff0000, v10
    v_add_f32 v148, 1.0, v148
    v_add_f32 v149, 1.0, v149
    v_cvt_pk_bf16_f32 v10, v148, v149
    v_lshlrev_b32 v148, 16, v10
    v_and_b32 v149, 0xffff0000, v10
    v_add_f32 v150, 1.0, v150
    v_add_f32 v151, 1.0, v151
    v_cvt_pk_bf16_f32 v10, v150, v151
    v_lshlrev_b32 v150, 16, v10
    v_and_b32 v151, 0xffff0000, v10
    v_add_f32 v152, 1.0, v152
    v_add_f32 v153, 1.0, v153
    v_cvt_pk_bf16_f32 v10, v152, v153
    v_lshlrev_b32 v152, 16, v10
    v_and_b32 v153, 0xffff0000, v10
    v_add_f32 v154, 1.0, v154
    v_add_f32 v155, 1.0, v155
    v_cvt_pk_bf16_f32 v10, v154, v155
    v_lshlrev_b32 v154, 16, v10
    v_and_b32 v155, 0xffff0000, v10
    v_add_f32 v156, 1.0, v156
    v_add_f32 v157, 1.0, v157
    v_cvt_pk_bf16_f32 v10, v156, v157
    v_lshlrev_b32 v156, 16, v10
    v_and_b32 v157, 0xffff0000, v10
    v_add_f32 v158, 1.0, v158
    v_add_f32 v159, 1.0, v159
    v_cvt_pk_bf16_f32 v10, v158, v159
    v_lshlrev_b32 v158, 16, v10
    v_and_b32 v159, 0xffff0000, v10
    v_add_f32 v160, 1.0, v160
    v_add_f32 v161, 1.0, v161
    v_cvt_pk_bf16_f32 v10, v160, v161
    v_lshlrev_b32 v160, 16, v10
    v_and_b32 v161, 0xffff0000, v10
    v_add_f32 v162, 1.0, v162
    v_add_f32 v163, 1.0, v163
    v_cvt_pk_bf16_f32 v10, v162, v163
    v_lshlrev_b32 v162, 16, v10
    v_and_b32 v163, 0xffff0000, v10
    v_add_f32 v164, 1.0, v164
    v_add_f32 v165, 1.0, v165
    v_cvt_pk_bf16_f32 v10, v164, v165
    v_lshlrev_b32 v164, 16, v10
    v_and_b32 v165, 0xffff0000, v10
    v_add_f32 v166, 1.0, v166
    v_add_f32 v167, 1.0, v167
    v_cvt_pk_bf16_f32 v10, v166, v167
    v_lshlrev_b32 v166, 16, v10
    v_and_b32 v167, 0xffff0000, v10
    v_add_f32 v168, 1.0, v168
    v_add_f32 v169, 1.0, v169
    v_cvt_pk_bf16_f32 v10, v168, v169
    v_lshlrev_b32 v168, 16, v10
    v_and_b32 v169, 0xffff0000, v10
    v_add_f32 v170, 1.0, v170
    v_add_f32 v171, 1.0, v171
    v_cvt_pk_bf16_f32 v10, v170, v171
    v_lshlrev_b32 v170, 16, v10
    v_and_b32 v171, 0xffff0000, v10
    v_add_f32 v172, 1.0, v172
    v_add_f32 v173, 1.0, v173
    v_cvt_pk_bf16_f32 v10, v172, v173
    v_lshlrev_b32 v172, 16, v10
    v_and_b32 v173, 0xffff0000, v10
    v_add_f32 v174, 1.0, v174
    v_add_f32 v175, 1.0, v175
    v_cvt_pk_bf16_f32 v10, v174, v175
    v_lshlrev_b32 v174, 16, v10
    v_and_b32 v175, 0xffff0000, v10
    v_add_f32 v176, 1.0, v176
    v_add_f32 v177, 1.0, v177
    v_cvt_pk_bf16_f32 v10, v176, v177
    v_lshlrev_b32 v176, 16, v10
    v_and_b32 v177, 0xffff0000, v10
    v_add_f32 v178, 1.0, v178
    v_add_f32 v179, 1.0, v179
    v_cvt_pk_bf16_f32 v10, v178, v179
    v_lshlrev_b32 v178, 16, v10
    v_and_b32 v179, 0xffff0000, v10
    s_waitcnt vmcnt(0)
    v_lshrrev_b32 v2, 4, v1
    v_and_b32 v3, 15, v1
    v_add_u32 v4, s29, v2
    v_lshrrev_b32 v11, 4, v4
    s_mov_b32 s40, 20480
    v_mul_lo_u32 v11, v11, s40
    v_and_b32 v12, 15, v4
    v_lshl_add_u32 v11, v12, 4, v11
    v_lshl_add_u32 v11, v3, 8, v11
    v_pk_mul_f32 v[28:29], v[28:29], v[140:141]
    v_cvt_pk_bf16_f32 v10, v28, v29
    v_lshlrev_b32 v28, 16, v10
    v_and_b32 v29, 0xffff0000, v10
    v_pk_add_f32 v[28:29], v[28:29], v[180:181]
    v_cvt_pk_bf16_f32 v220, v28, v29
    v_pk_mul_f32 v[30:31], v[30:31], v[142:143]
    v_cvt_pk_bf16_f32 v10, v30, v31
    v_lshlrev_b32 v30, 16, v10
    v_and_b32 v31, 0xffff0000, v10
    v_pk_add_f32 v[30:31], v[30:31], v[182:183]
    v_cvt_pk_bf16_f32 v221, v30, v31
    v_pk_mul_f32 v[32:33], v[32:33], v[144:145]
    v_cvt_pk_bf16_f32 v10, v32, v33
    v_lshlrev_b32 v32, 16, v10
    v_and_b32 v33, 0xffff0000, v10
    v_pk_add_f32 v[32:33], v[32:33], v[184:185]
    v_cvt_pk_bf16_f32 v222, v32, v33
    v_pk_mul_f32 v[34:35], v[34:35], v[146:147]
    v_cvt_pk_bf16_f32 v10, v34, v35
    v_lshlrev_b32 v34, 16, v10
    v_and_b32 v35, 0xffff0000, v10
    v_pk_add_f32 v[34:35], v[34:35], v[186:187]
    v_cvt_pk_bf16_f32 v223, v34, v35
    s_mov_b32 s41, 1048576
    buffer_store_dwordx4 v[220:223], v11, s[12:15], s41 offen sc1
    v_pk_mul_f32 v[36:37], v[36:37], v[148:149]
    v_cvt_pk_bf16_f32 v10, v36, v37
    v_lshlrev_b32 v36, 16, v10
    v_and_b32 v37, 0xffff0000, v10
    v_pk_add_f32 v[36:37], v[36:37], v[188:189]
    v_cvt_pk_bf16_f32 v224, v36, v37
    v_pk_mul_f32 v[38:39], v[38:39], v[150:151]
    v_cvt_pk_bf16_f32 v10, v38, v39
    v_lshlrev_b32 v38, 16, v10
    v_and_b32 v39, 0xffff0000, v10
    v_pk_add_f32 v[38:39], v[38:39], v[190:191]
    v_cvt_pk_bf16_f32 v225, v38, v39
    v_pk_mul_f32 v[40:41], v[40:41], v[152:153]
    v_cvt_pk_bf16_f32 v10, v40, v41
    v_lshlrev_b32 v40, 16, v10
    v_and_b32 v41, 0xffff0000, v10
    v_pk_add_f32 v[40:41], v[40:41], v[192:193]
    v_cvt_pk_bf16_f32 v226, v40, v41
    v_pk_mul_f32 v[42:43], v[42:43], v[154:155]
    v_cvt_pk_bf16_f32 v10, v42, v43
    v_lshlrev_b32 v42, 16, v10
    v_and_b32 v43, 0xffff0000, v10
    v_pk_add_f32 v[42:43], v[42:43], v[194:195]
    v_cvt_pk_bf16_f32 v227, v42, v43
    s_mov_b32 s41, 1052672
    buffer_store_dwordx4 v[224:227], v11, s[12:15], s41 offen sc1
    v_pk_mul_f32 v[44:45], v[44:45], v[156:157]
    v_cvt_pk_bf16_f32 v10, v44, v45
    v_lshlrev_b32 v44, 16, v10
    v_and_b32 v45, 0xffff0000, v10
    v_pk_add_f32 v[44:45], v[44:45], v[196:197]
    v_cvt_pk_bf16_f32 v228, v44, v45
    v_pk_mul_f32 v[46:47], v[46:47], v[158:159]
    v_cvt_pk_bf16_f32 v10, v46, v47
    v_lshlrev_b32 v46, 16, v10
    v_and_b32 v47, 0xffff0000, v10
    v_pk_add_f32 v[46:47], v[46:47], v[198:199]
    v_cvt_pk_bf16_f32 v229, v46, v47
    v_pk_mul_f32 v[48:49], v[48:49], v[160:161]
    v_cvt_pk_bf16_f32 v10, v48, v49
    v_lshlrev_b32 v48, 16, v10
    v_and_b32 v49, 0xffff0000, v10
    v_pk_add_f32 v[48:49], v[48:49], v[200:201]
    v_cvt_pk_bf16_f32 v230, v48, v49
    v_pk_mul_f32 v[50:51], v[50:51], v[162:163]
    v_cvt_pk_bf16_f32 v10, v50, v51
    v_lshlrev_b32 v50, 16, v10
    v_and_b32 v51, 0xffff0000, v10
    v_pk_add_f32 v[50:51], v[50:51], v[202:203]
    v_cvt_pk_bf16_f32 v231, v50, v51
    s_mov_b32 s41, 1056768
    buffer_store_dwordx4 v[228:231], v11, s[12:15], s41 offen sc1
    v_pk_mul_f32 v[52:53], v[52:53], v[164:165]
    v_cvt_pk_bf16_f32 v10, v52, v53
    v_lshlrev_b32 v52, 16, v10
    v_and_b32 v53, 0xffff0000, v10
    v_pk_add_f32 v[52:53], v[52:53], v[204:205]
    v_cvt_pk_bf16_f32 v232, v52, v53
    v_pk_mul_f32 v[54:55], v[54:55], v[166:167]
    v_cvt_pk_bf16_f32 v10, v54, v55
    v_lshlrev_b32 v54, 16, v10
    v_and_b32 v55, 0xffff0000, v10
    v_pk_add_f32 v[54:55], v[54:55], v[206:207]
    v_cvt_pk_bf16_f32 v233, v54, v55
    v_pk_mul_f32 v[56:57], v[56:57], v[168:169]
    v_cvt_pk_bf16_f32 v10, v56, v57
    v_lshlrev_b32 v56, 16, v10
    v_and_b32 v57, 0xffff0000, v10
    v_pk_add_f32 v[56:57], v[56:57], v[208:209]
    v_cvt_pk_bf16_f32 v234, v56, v57
    v_pk_mul_f32 v[58:59], v[58:59], v[170:171]
    v_cvt_pk_bf16_f32 v10, v58, v59
    v_lshlrev_b32 v58, 16, v10
    v_and_b32 v59, 0xffff0000, v10
    v_pk_add_f32 v[58:59], v[58:59], v[210:211]
    v_cvt_pk_bf16_f32 v235, v58, v59
    s_mov_b32 s41, 1060864
    buffer_store_dwordx4 v[232:235], v11, s[12:15], s41 offen sc1
    v_pk_mul_f32 v[60:61], v[60:61], v[172:173]
    v_cvt_pk_bf16_f32 v10, v60, v61
    v_lshlrev_b32 v60, 16, v10
    v_and_b32 v61, 0xffff0000, v10
    v_pk_add_f32 v[60:61], v[60:61], v[212:213]
    v_cvt_pk_bf16_f32 v236, v60, v61
    v_pk_mul_f32 v[62:63], v[62:63], v[174:175]
    v_cvt_pk_bf16_f32 v10, v62, v63
    v_lshlrev_b32 v62, 16, v10
    v_and_b32 v63, 0xffff0000, v10
    v_pk_add_f32 v[62:63], v[62:63], v[214:215]
    v_cvt_pk_bf16_f32 v237, v62, v63
    v_pk_mul_f32 v[64:65], v[64:65], v[176:177]
    v_cvt_pk_bf16_f32 v10, v64, v65
    v_lshlrev_b32 v64, 16, v10
    v_and_b32 v65, 0xffff0000, v10
    v_pk_add_f32 v[64:65], v[64:65], v[216:217]
    v_cvt_pk_bf16_f32 v238, v64, v65
    v_pk_mul_f32 v[66:67], v[66:67], v[178:179]
    v_cvt_pk_bf16_f32 v10, v66, v67
    v_lshlrev_b32 v66, 16, v10
    v_and_b32 v67, 0xffff0000, v10
    v_pk_add_f32 v[66:67], v[66:67], v[218:219]
    v_cvt_pk_bf16_f32 v239, v66, v67
    s_mov_b32 s41, 1064960
    buffer_store_dwordx4 v[236:239], v11, s[12:15], s41 offen sc1
    v_lshrrev_b32 v2, 4, v1
    v_and_b32 v3, 15, v1
    v_add_u32 v4, s30, v2
    v_lshrrev_b32 v11, 4, v4
    s_mov_b32 s40, 20480
    v_mul_lo_u32 v11, v11, s40
    v_and_b32 v12, 15, v4
    v_lshl_add_u32 v11, v12, 4, v11
    v_lshl_add_u32 v11, v3, 8, v11
    v_pk_mul_f32 v[68:69], v[68:69], v[140:141]
    v_cvt_pk_bf16_f32 v10, v68, v69
    v_lshlrev_b32 v68, 16, v10
    v_and_b32 v69, 0xffff0000, v10
    v_pk_add_f32 v[68:69], v[68:69], v[180:181]
    v_cvt_pk_bf16_f32 v112, v68, v69
    v_pk_mul_f32 v[70:71], v[70:71], v[142:143]
    v_cvt_pk_bf16_f32 v10, v70, v71
    v_lshlrev_b32 v70, 16, v10
    v_and_b32 v71, 0xffff0000, v10
    v_pk_add_f32 v[70:71], v[70:71], v[182:183]
    v_cvt_pk_bf16_f32 v113, v70, v71
    v_pk_mul_f32 v[72:73], v[72:73], v[144:145]
    v_cvt_pk_bf16_f32 v10, v72, v73
    v_lshlrev_b32 v72, 16, v10
    v_and_b32 v73, 0xffff0000, v10
    v_pk_add_f32 v[72:73], v[72:73], v[184:185]
    v_cvt_pk_bf16_f32 v114, v72, v73
    v_pk_mul_f32 v[74:75], v[74:75], v[146:147]
    v_cvt_pk_bf16_f32 v10, v74, v75
    v_lshlrev_b32 v74, 16, v10
    v_and_b32 v75, 0xffff0000, v10
    v_pk_add_f32 v[74:75], v[74:75], v[186:187]
    v_cvt_pk_bf16_f32 v115, v74, v75
    s_mov_b32 s41, 1048576
    buffer_store_dwordx4 v[112:115], v11, s[12:15], s41 offen sc1
    v_pk_mul_f32 v[76:77], v[76:77], v[148:149]
    v_cvt_pk_bf16_f32 v10, v76, v77
    v_lshlrev_b32 v76, 16, v10
    v_and_b32 v77, 0xffff0000, v10
    v_pk_add_f32 v[76:77], v[76:77], v[188:189]
    v_cvt_pk_bf16_f32 v116, v76, v77
    v_pk_mul_f32 v[78:79], v[78:79], v[150:151]
    v_cvt_pk_bf16_f32 v10, v78, v79
    v_lshlrev_b32 v78, 16, v10
    v_and_b32 v79, 0xffff0000, v10
    v_pk_add_f32 v[78:79], v[78:79], v[190:191]
    v_cvt_pk_bf16_f32 v117, v78, v79
    v_pk_mul_f32 v[80:81], v[80:81], v[152:153]
    v_cvt_pk_bf16_f32 v10, v80, v81
    v_lshlrev_b32 v80, 16, v10
    v_and_b32 v81, 0xffff0000, v10
    v_pk_add_f32 v[80:81], v[80:81], v[192:193]
    v_cvt_pk_bf16_f32 v118, v80, v81
    v_pk_mul_f32 v[82:83], v[82:83], v[154:155]
    v_cvt_pk_bf16_f32 v10, v82, v83
    v_lshlrev_b32 v82, 16, v10
    v_and_b32 v83, 0xffff0000, v10
    v_pk_add_f32 v[82:83], v[82:83], v[194:195]
    v_cvt_pk_bf16_f32 v119, v82, v83
    s_mov_b32 s41, 1052672
    buffer_store_dwordx4 v[116:119], v11, s[12:15], s41 offen sc1
    v_pk_mul_f32 v[84:85], v[84:85], v[156:157]
    v_cvt_pk_bf16_f32 v10, v84, v85
    v_lshlrev_b32 v84, 16, v10
    v_and_b32 v85, 0xffff0000, v10
    v_pk_add_f32 v[84:85], v[84:85], v[196:197]
    v_cvt_pk_bf16_f32 v120, v84, v85
    v_pk_mul_f32 v[86:87], v[86:87], v[158:159]
    v_cvt_pk_bf16_f32 v10, v86, v87
    v_lshlrev_b32 v86, 16, v10
    v_and_b32 v87, 0xffff0000, v10
    v_pk_add_f32 v[86:87], v[86:87], v[198:199]
    v_cvt_pk_bf16_f32 v121, v86, v87
    v_pk_mul_f32 v[88:89], v[88:89], v[160:161]
    v_cvt_pk_bf16_f32 v10, v88, v89
    v_lshlrev_b32 v88, 16, v10
    v_and_b32 v89, 0xffff0000, v10
    v_pk_add_f32 v[88:89], v[88:89], v[200:201]
    v_cvt_pk_bf16_f32 v122, v88, v89
    v_pk_mul_f32 v[90:91], v[90:91], v[162:163]
    v_cvt_pk_bf16_f32 v10, v90, v91
    v_lshlrev_b32 v90, 16, v10
    v_and_b32 v91, 0xffff0000, v10
    v_pk_add_f32 v[90:91], v[90:91], v[202:203]
    v_cvt_pk_bf16_f32 v123, v90, v91
    s_mov_b32 s41, 1056768
    buffer_store_dwordx4 v[120:123], v11, s[12:15], s41 offen sc1
    v_pk_mul_f32 v[92:93], v[92:93], v[164:165]
    v_cvt_pk_bf16_f32 v10, v92, v93
    v_lshlrev_b32 v92, 16, v10
    v_and_b32 v93, 0xffff0000, v10
    v_pk_add_f32 v[92:93], v[92:93], v[204:205]
    v_cvt_pk_bf16_f32 v124, v92, v93
    v_pk_mul_f32 v[94:95], v[94:95], v[166:167]
    v_cvt_pk_bf16_f32 v10, v94, v95
    v_lshlrev_b32 v94, 16, v10
    v_and_b32 v95, 0xffff0000, v10
    v_pk_add_f32 v[94:95], v[94:95], v[206:207]
    v_cvt_pk_bf16_f32 v125, v94, v95
    v_pk_mul_f32 v[96:97], v[96:97], v[168:169]
    v_cvt_pk_bf16_f32 v10, v96, v97
    v_lshlrev_b32 v96, 16, v10
    v_and_b32 v97, 0xffff0000, v10
    v_pk_add_f32 v[96:97], v[96:97], v[208:209]
    v_cvt_pk_bf16_f32 v126, v96, v97
    v_pk_mul_f32 v[98:99], v[98:99], v[170:171]
    v_cvt_pk_bf16_f32 v10, v98, v99
    v_lshlrev_b32 v98, 16, v10
    v_and_b32 v99, 0xffff0000, v10
    v_pk_add_f32 v[98:99], v[98:99], v[210:211]
    v_cvt_pk_bf16_f32 v127, v98, v99
    s_mov_b32 s41, 1060864
    buffer_store_dwordx4 v[124:127], v11, s[12:15], s41 offen sc1
    v_pk_mul_f32 v[100:101], v[100:101], v[172:173]
    v_cvt_pk_bf16_f32 v10, v100, v101
    v_lshlrev_b32 v100, 16, v10
    v_and_b32 v101, 0xffff0000, v10
    v_pk_add_f32 v[100:101], v[100:101], v[212:213]
    v_cvt_pk_bf16_f32 v128, v100, v101
    v_pk_mul_f32 v[102:103], v[102:103], v[174:175]
    v_cvt_pk_bf16_f32 v10, v102, v103
    v_lshlrev_b32 v102, 16, v10
    v_and_b32 v103, 0xffff0000, v10
    v_pk_add_f32 v[102:103], v[102:103], v[214:215]
    v_cvt_pk_bf16_f32 v129, v102, v103
    v_pk_mul_f32 v[104:105], v[104:105], v[176:177]
    v_cvt_pk_bf16_f32 v10, v104, v105
    v_lshlrev_b32 v104, 16, v10
    v_and_b32 v105, 0xffff0000, v10
    v_pk_add_f32 v[104:105], v[104:105], v[216:217]
    v_cvt_pk_bf16_f32 v130, v104, v105
    v_pk_mul_f32 v[106:107], v[106:107], v[178:179]
    v_cvt_pk_bf16_f32 v10, v106, v107
    v_lshlrev_b32 v106, 16, v10
    v_and_b32 v107, 0xffff0000, v10
    v_pk_add_f32 v[106:107], v[106:107], v[218:219]
    v_cvt_pk_bf16_f32 v131, v106, v107
    s_mov_b32 s41, 1064960
    buffer_store_dwordx4 v[128:131], v11, s[12:15], s41 offen sc1
    s_cmp_ge_u32 s2, 60
    s_cbranch_scc0 L_mega_nofast
    s_waitcnt vmcnt(0)
    s_barrier
    s_cmp_eq_u32 s25, 1
    s_cbranch_scc0 L_mega_nofast
    s_lshl_b32 s28, s2, 2
    v_mov_b32 v8, 0
    v_mov_b32 v9, 1
    s_mov_b64 exec, 1
    buffer_store_dword v9, v8, s[84:87], s28 offen sc1
    s_mov_b64 exec, -1
L_mega_nofast:
    v_lshlrev_b32 v8, 4, v0
    v_mov_b32 v12, -1
    v_mov_b32 v13, -1
    v_mov_b32 v14, -1
    v_mov_b32 v15, -1
    s_waitcnt vmcnt(0)
    s_barrier
    s_cmp_eq_u32 s25, 0
    s_cbranch_scc0 L_wgs_32
    s_mov_b32 s40, 192
    s_waitcnt vmcnt(0)
    v_mov_b32 v250, 0
    v_mov_b32 v251, 1
    s_mov_b64 exec, 1
    buffer_atomic_add v251, v250, s[84:87], s40 offen sc1
    s_mov_b64 exec, -1
L_wgs_32:
    s_cmp_eq_u32 s25, 0
    s_cbranch_scc0 L_wgw_33
    s_mov_b32 s40, 160
    s_mov_b32 s98, 0
    v_mov_b32 v250, 0
L_wait_34:
    buffer_load_dword v251, v250, s[84:87], s40 offen sc1
    s_waitcnt vmcnt(0)
    v_readfirstlane_b32 s99, v251
    s_cmp_ge_u32 s99, 64
    s_cbranch_scc1 L_ok_35
    s_sleep 30
    s_add_u32 s98, s98, 1
    s_cmp_lt_u32 s98, 1048576
    s_cbranch_scc1 L_wait_34
    s_branch L_mega_done
L_ok_35:
L_wgw_33:
    s_barrier
    v_and_b32 v2, 15, v1
    v_lshrrev_b32 v3, 4, v1
L_mega_pre_done:
    s_lshr_b32 s20, s2, 2
    s_and_b32 s21, s2, 3
    s_lshr_b32 s22, s20, 4
    s_and_b32 s23, s20, 15
    s_lshl_b32 s24, s22, 3
    s_add_u32 s24, s24, 16
    s_load_dwordx2 s[4:5], s[0:1], s24
    s_waitcnt lgkmcnt(0)
    s_mov_b32 s6, 5242880
    s_mov_b32 s7, 0x00020000
    v_lshlrev_b32 v4, 16, v3
    v_lshl_add_u32 v4, v2, 3, v4
    s_lshl_b32 s26, s23, 9
    s_lshl_b32 s27, s25, 7
    s_add_u32 s26, s26, s27
    v_add_u32 v4, s26, v4
    v_lshlrev_b32 v5, 4, v1
    s_mul_i32 s28, s25, 10240
    s_mul_i32 s29, s21, 40960
    s_add_u32 s29, s29, s28
    s_add_u32 s29, s29, 1048576
    s_mov_b32 s32, 0
    s_mov_b32 s34, 0x05040100
    s_mov_b32 s35, 0x07060302
    buffer_load_dwordx2 v[16:17], v4, s[4:7], s32 offen
    s_add_u32 s32, s32, 8192
    buffer_load_dwordx2 v[18:19], v4, s[4:7], s32 offen
    s_add_u32 s32, s32, 8192
    buffer_load_dwordx2 v[20:21], v4, s[4:7], s32 offen
    s_add_u32 s32, s32, 8192
    buffer_load_dwordx2 v[22:23], v4, s[4:7], s32 offen
    s_add_u32 s32, s32, 8192
    buffer_load_dwordx2 v[24:25], v4, s[4:7], s32 offen
    s_add_u32 s32, s32, 8192
    buffer_load_dwordx2 v[26:27], v4, s[4:7], s32 offen
    s_add_u32 s32, s32, 8192
    buffer_load_dwordx2 v[28:29], v4, s[4:7], s32 offen
    s_add_u32 s32, s32, 8192
    buffer_load_dwordx2 v[30:31], v4, s[4:7], s32 offen
    s_add_u32 s32, s32, 204800
    buffer_load_dwordx2 v[32:33], v4, s[4:7], s32 offen
    s_add_u32 s32, s32, 8192
    buffer_load_dwordx2 v[34:35], v4, s[4:7], s32 offen
    s_add_u32 s32, s32, 8192
    buffer_load_dwordx2 v[36:37], v4, s[4:7], s32 offen
    s_add_u32 s32, s32, 8192
    buffer_load_dwordx2 v[38:39], v4, s[4:7], s32 offen
    s_add_u32 s32, s32, 8192
    buffer_load_dwordx2 v[40:41], v4, s[4:7], s32 offen
    s_add_u32 s32, s32, 8192
    buffer_load_dwordx2 v[42:43], v4, s[4:7], s32 offen
    s_add_u32 s32, s32, 8192
    buffer_load_dwordx2 v[44:45], v4, s[4:7], s32 offen
    s_add_u32 s32, s32, 8192
    buffer_load_dwordx2 v[46:47], v4, s[4:7], s32 offen
    s_add_u32 s32, s32, 204800
    buffer_load_dwordx2 v[48:49], v4, s[4:7], s32 offen
    s_add_u32 s32, s32, 8192
    buffer_load_dwordx2 v[50:51], v4, s[4:7], s32 offen
    s_add_u32 s32, s32, 8192
    buffer_load_dwordx2 v[52:53], v4, s[4:7], s32 offen
    s_add_u32 s32, s32, 8192
    buffer_load_dwordx2 v[54:55], v4, s[4:7], s32 offen
    s_add_u32 s32, s32, 8192
    buffer_load_dwordx2 v[56:57], v4, s[4:7], s32 offen
    s_add_u32 s32, s32, 8192
    buffer_load_dwordx2 v[58:59], v4, s[4:7], s32 offen
    s_add_u32 s32, s32, 8192
    buffer_load_dwordx2 v[60:61], v4, s[4:7], s32 offen
    s_add_u32 s32, s32, 8192
    buffer_load_dwordx2 v[62:63], v4, s[4:7], s32 offen
    s_add_u32 s32, s32, 204800
    buffer_load_dwordx2 v[64:65], v4, s[4:7], s32 offen
    s_add_u32 s32, s32, 8192
    buffer_load_dwordx2 v[66:67], v4, s[4:7], s32 offen
    s_add_u32 s32, s32, 8192
    buffer_load_dwordx2 v[68:69], v4, s[4:7], s32 offen
    s_add_u32 s32, s32, 8192
    buffer_load_dwordx2 v[70:71], v4, s[4:7], s32 offen
    s_add_u32 s32, s32, 8192
    buffer_load_dwordx2 v[72:73], v4, s[4:7], s32 offen
    s_add_u32 s32, s32, 8192
    buffer_load_dwordx2 v[74:75], v4, s[4:7], s32 offen
    s_add_u32 s32, s32, 8192
    buffer_load_dwordx2 v[76:77], v4, s[4:7], s32 offen
    s_add_u32 s32, s32, 8192
    buffer_load_dwordx2 v[78:79], v4, s[4:7], s32 offen
    s_add_u32 s32, s32, 204800
    buffer_load_dwordx2 v[80:81], v4, s[4:7], s32 offen
    s_add_u32 s32, s32, 8192
    buffer_load_dwordx2 v[82:83], v4, s[4:7], s32 offen
    s_add_u32 s32, s32, 8192
    buffer_load_dwordx2 v[84:85], v4, s[4:7], s32 offen
    s_add_u32 s32, s32, 8192
    buffer_load_dwordx2 v[86:87], v4, s[4:7], s32 offen
    s_add_u32 s32, s32, 8192
    buffer_load_dwordx2 v[88:89], v4, s[4:7], s32 offen
    s_add_u32 s32, s32, 8192
    buffer_load_dwordx2 v[90:91], v4, s[4:7], s32 offen
    s_add_u32 s32, s32, 8192
    buffer_load_dwordx2 v[92:93], v4, s[4:7], s32 offen
    s_add_u32 s32, s32, 8192
    buffer_load_dwordx2 v[94:95], v4, s[4:7], s32 offen
    s_add_u32 s32, s32, 204800
    buffer_load_dwordx2 v[96:97], v4, s[4:7], s32 offen
    s_add_u32 s32, s32, 8192
    buffer_load_dwordx2 v[98:99], v4, s[4:7], s32 offen
    s_add_u32 s32, s32, 8192
    buffer_load_dwordx2 v[100:101], v4, s[4:7], s32 offen
    s_add_u32 s32, s32, 8192
    buffer_load_dwordx2 v[102:103], v4, s[4:7], s32 offen
    s_add_u32 s32, s32, 8192
    buffer_load_dwordx2 v[104:105], v4, s[4:7], s32 offen
    s_add_u32 s32, s32, 8192
    buffer_load_dwordx2 v[106:107], v4, s[4:7], s32 offen
    s_add_u32 s32, s32, 8192
    buffer_load_dwordx2 v[108:109], v4, s[4:7], s32 offen
    s_add_u32 s32, s32, 8192
    buffer_load_dwordx2 v[110:111], v4, s[4:7], s32 offen
    s_add_u32 s32, s32, 204800
    buffer_load_dwordx2 v[112:113], v4, s[4:7], s32 offen
    s_add_u32 s32, s32, 8192
    buffer_load_dwordx2 v[114:115], v4, s[4:7], s32 offen
    s_add_u32 s32, s32, 8192
    buffer_load_dwordx2 v[116:117], v4, s[4:7], s32 offen
    s_add_u32 s32, s32, 8192
    buffer_load_dwordx2 v[118:119], v4, s[4:7], s32 offen
    s_add_u32 s32, s32, 8192
    buffer_load_dwordx2 v[120:121], v4, s[4:7], s32 offen
    s_add_u32 s32, s32, 8192
    buffer_load_dwordx2 v[122:123], v4, s[4:7], s32 offen
    s_add_u32 s32, s32, 8192
    buffer_load_dwordx2 v[124:125], v4, s[4:7], s32 offen
    s_add_u32 s32, s32, 8192
    buffer_load_dwordx2 v[126:127], v4, s[4:7], s32 offen
    s_add_u32 s32, s32, 204800
    buffer_load_dwordx2 v[128:129], v4, s[4:7], s32 offen
    s_add_u32 s32, s32, 8192
    buffer_load_dwordx2 v[130:131], v4, s[4:7], s32 offen
    s_add_u32 s32, s32, 8192
    buffer_load_dwordx2 v[132:133], v4, s[4:7], s32 offen
    s_add_u32 s32, s32, 8192
    buffer_load_dwordx2 v[134:135], v4, s[4:7], s32 offen
    s_add_u32 s32, s32, 8192
    buffer_load_dwordx2 v[136:137], v4, s[4:7], s32 offen
    s_add_u32 s32, s32, 8192
    buffer_load_dwordx2 v[138:139], v4, s[4:7], s32 offen
    s_add_u32 s32, s32, 8192
    buffer_load_dwordx2 v[140:141], v4, s[4:7], s32 offen
    s_add_u32 s32, s32, 8192
    buffer_load_dwordx2 v[142:143], v4, s[4:7], s32 offen
    s_add_u32 s32, s32, 204800
    s_waitcnt vmcnt(32)
    v_perm_b32 v144, v18, v16, s34
    v_accvgpr_write_b32 a0, v144
    v_perm_b32 v145, v22, v20, s34
    v_accvgpr_write_b32 a1, v145
    v_perm_b32 v144, v26, v24, s34
    v_accvgpr_write_b32 a2, v144
    v_perm_b32 v145, v30, v28, s34
    v_accvgpr_write_b32 a3, v145
    v_perm_b32 v144, v18, v16, s35
    v_accvgpr_write_b32 a4, v144
    v_perm_b32 v145, v22, v20, s35
    v_accvgpr_write_b32 a5, v145
    v_perm_b32 v144, v26, v24, s35
    v_accvgpr_write_b32 a6, v144
    v_perm_b32 v145, v30, v28, s35
    v_accvgpr_write_b32 a7, v145
    v_perm_b32 v144, v19, v17, s34
    v_accvgpr_write_b32 a8, v144
    v_perm_b32 v145, v23, v21, s34
    v_accvgpr_write_b32 a9, v145
    v_perm_b32 v144, v27, v25, s34
    v_accvgpr_write_b32 a10, v144
    v_perm_b32 v145, v31, v29, s34
    v_accvgpr_write_b32 a11, v145
    v_perm_b32 v144, v19, v17, s35
    v_accvgpr_write_b32 a12, v144
    v_perm_b32 v145, v23, v21, s35
    v_accvgpr_write_b32 a13, v145
    v_perm_b32 v144, v27, v25, s35
    v_accvgpr_write_b32 a14, v144
    v_perm_b32 v145, v31, v29, s35
    v_accvgpr_write_b32 a15, v145
    v_perm_b32 v144, v34, v32, s34
    v_accvgpr_write_b32 a16, v144
    v_perm_b32 v145, v38, v36, s34
    v_accvgpr_write_b32 a17, v145
    v_perm_b32 v144, v42, v40, s34
    v_accvgpr_write_b32 a18, v144
    v_perm_b32 v145, v46, v44, s34
    v_accvgpr_write_b32 a19, v145
    v_perm_b32 v144, v34, v32, s35
    v_accvgpr_write_b32 a20, v144
    v_perm_b32 v145, v38, v36, s35
    v_accvgpr_write_b32 a21, v145
    v_perm_b32 v144, v42, v40, s35
    v_accvgpr_write_b32 a22, v144
    v_perm_b32 v145, v46, v44, s35
    v_accvgpr_write_b32 a23, v145
    v_perm_b32 v144, v35, v33, s34
    v_accvgpr_write_b32 a24, v144
    v_perm_b32 v145, v39, v37, s34
    v_accvgpr_write_b32 a25, v145
    v_perm_b32 v144, v43, v41, s34
    v_accvgpr_write_b32 a26, v144
    v_perm_b32 v145, v47, v45, s34
    v_accvgpr_write_b32 a27, v145
    v_perm_b32 v144, v35, v33, s35
    v_accvgpr_write_b32 a28, v144
    v_perm_b32 v145, v39, v37, s35
    v_accvgpr_write_b32 a29, v145
    v_perm_b32 v144, v43, v41, s35
    v_accvgpr_write_b32 a30, v144
    v_perm_b32 v145, v47, v45, s35
    v_accvgpr_write_b32 a31, v145
    v_perm_b32 v144, v50, v48, s34
    v_accvgpr_write_b32 a32, v144
    v_perm_b32 v145, v54, v52, s34
    v_accvgpr_write_b32 a33, v145
    v_perm_b32 v144, v58, v56, s34
    v_accvgpr_write_b32 a34, v144
    v_perm_b32 v145, v62, v60, s34
    v_accvgpr_write_b32 a35, v145
    v_perm_b32 v144, v50, v48, s35
    v_accvgpr_write_b32 a36, v144
    v_perm_b32 v145, v54, v52, s35
    v_accvgpr_write_b32 a37, v145
    v_perm_b32 v144, v58, v56, s35
    v_accvgpr_write_b32 a38, v144
    v_perm_b32 v145, v62, v60, s35
    v_accvgpr_write_b32 a39, v145
    v_perm_b32 v144, v51, v49, s34
    v_accvgpr_write_b32 a40, v144
    v_perm_b32 v145, v55, v53, s34
    v_accvgpr_write_b32 a41, v145
    v_perm_b32 v144, v59, v57, s34
    v_accvgpr_write_b32 a42, v144
    v_perm_b32 v145, v63, v61, s34
    v_accvgpr_write_b32 a43, v145
    v_perm_b32 v144, v51, v49, s35
    v_accvgpr_write_b32 a44, v144
    v_perm_b32 v145, v55, v53, s35
    v_accvgpr_write_b32 a45, v145
    v_perm_b32 v144, v59, v57, s35
    v_accvgpr_write_b32 a46, v144
    v_perm_b32 v145, v63, v61, s35
    v_accvgpr_write_b32 a47, v145
    v_perm_b32 v144, v66, v64, s34
    v_accvgpr_write_b32 a48, v144
    v_perm_b32 v145, v70, v68, s34
    v_accvgpr_write_b32 a49, v145
    v_perm_b32 v144, v74, v72, s34
    v_accvgpr_write_b32 a50, v144
    v_perm_b32 v145, v78, v76, s34
    v_accvgpr_write_b32 a51, v145
    v_perm_b32 v144, v66, v64, s35
    v_accvgpr_write_b32 a52, v144
    v_perm_b32 v145, v70, v68, s35
    v_accvgpr_write_b32 a53, v145
    v_perm_b32 v144, v74, v72, s35
    v_accvgpr_write_b32 a54, v144
    v_perm_b32 v145, v78, v76, s35
    v_accvgpr_write_b32 a55, v145
    v_perm_b32 v144, v67, v65, s34
    v_accvgpr_write_b32 a56, v144
    v_perm_b32 v145, v71, v69, s34
    v_accvgpr_write_b32 a57, v145
    v_perm_b32 v144, v75, v73, s34
    v_accvgpr_write_b32 a58, v144
    v_perm_b32 v145, v79, v77, s34
    v_accvgpr_write_b32 a59, v145
    v_perm_b32 v144, v67, v65, s35
    v_accvgpr_write_b32 a60, v144
    v_perm_b32 v145, v71, v69, s35
    v_accvgpr_write_b32 a61, v145
    v_perm_b32 v144, v75, v73, s35
    v_accvgpr_write_b32 a62, v144
    v_perm_b32 v145, v79, v77, s35
    v_accvgpr_write_b32 a63, v145
    buffer_load_dwordx2 v[16:17], v4, s[4:7], s32 offen
    s_add_u32 s32, s32, 8192
    buffer_load_dwordx2 v[18:19], v4, s[4:7], s32 offen
    s_add_u32 s32, s32, 8192
    buffer_load_dwordx2 v[20:21], v4, s[4:7], s32 offen
    s_add_u32 s32, s32, 8192
    buffer_load_dwordx2 v[22:23], v4, s[4:7], s32 offen
    s_add_u32 s32, s32, 8192
    buffer_load_dwordx2 v[24:25], v4, s[4:7], s32 offen
    s_add_u32 s32, s32, 8192
    buffer_load_dwordx2 v[26:27], v4, s[4:7], s32 offen
    s_add_u32 s32, s32, 8192
    buffer_load_dwordx2 v[28:29], v4, s[4:7], s32 offen
    s_add_u32 s32, s32, 8192
    buffer_load_dwordx2 v[30:31], v4, s[4:7], s32 offen
    s_add_u32 s32, s32, 204800
    buffer_load_dwordx2 v[32:33], v4, s[4:7], s32 offen
    s_add_u32 s32, s32, 8192
    buffer_load_dwordx2 v[34:35], v4, s[4:7], s32 offen
    s_add_u32 s32, s32, 8192
    buffer_load_dwordx2 v[36:37], v4, s[4:7], s32 offen
    s_add_u32 s32, s32, 8192
    buffer_load_dwordx2 v[38:39], v4, s[4:7], s32 offen
    s_add_u32 s32, s32, 8192
    buffer_load_dwordx2 v[40:41], v4, s[4:7], s32 offen
    s_add_u32 s32, s32, 8192
    buffer_load_dwordx2 v[42:43], v4, s[4:7], s32 offen
    s_add_u32 s32, s32, 8192
    buffer_load_dwordx2 v[44:45], v4, s[4:7], s32 offen
    s_add_u32 s32, s32, 8192
    buffer_load_dwordx2 v[46:47], v4, s[4:7], s32 offen
    s_add_u32 s32, s32, 204800
    buffer_load_dwordx2 v[48:49], v4, s[4:7], s32 offen
    s_add_u32 s32, s32, 8192
    buffer_load_dwordx2 v[50:51], v4, s[4:7], s32 offen
    s_add_u32 s32, s32, 8192
    buffer_load_dwordx2 v[52:53], v4, s[4:7], s32 offen
    s_add_u32 s32, s32, 8192
    buffer_load_dwordx2 v[54:55], v4, s[4:7], s32 offen
    s_add_u32 s32, s32, 8192
    buffer_load_dwordx2 v[56:57], v4, s[4:7], s32 offen
    s_add_u32 s32, s32, 8192
    buffer_load_dwordx2 v[58:59], v4, s[4:7], s32 offen
    s_add_u32 s32, s32, 8192
    buffer_load_dwordx2 v[60:61], v4, s[4:7], s32 offen
    s_add_u32 s32, s32, 8192
    buffer_load_dwordx2 v[62:63], v4, s[4:7], s32 offen
    s_add_u32 s32, s32, 204800
    buffer_load_dwordx2 v[64:65], v4, s[4:7], s32 offen
    s_add_u32 s32, s32, 8192
    buffer_load_dwordx2 v[66:67], v4, s[4:7], s32 offen
    s_add_u32 s32, s32, 8192
    buffer_load_dwordx2 v[68:69], v4, s[4:7], s32 offen
    s_add_u32 s32, s32, 8192
    buffer_load_dwordx2 v[70:71], v4, s[4:7], s32 offen
    s_add_u32 s32, s32, 8192
    buffer_load_dwordx2 v[72:73], v4, s[4:7], s32 offen
    s_add_u32 s32, s32, 8192
    buffer_load_dwordx2 v[74:75], v4, s[4:7], s32 offen
    s_add_u32 s32, s32, 8192
    buffer_load_dwordx2 v[76:77], v4, s[4:7], s32 offen
    s_add_u32 s32, s32, 8192
    buffer_load_dwordx2 v[78:79], v4, s[4:7], s32 offen
    s_add_u32 s32, s32, 204800
    s_waitcnt vmcnt(32)
    v_perm_b32 v144, v82, v80, s34
    v_accvgpr_write_b32 a64, v144
    v_perm_b32 v145, v86, v84, s34
    v_accvgpr_write_b32 a65, v145
    v_perm_b32 v144, v90, v88, s34
    v_accvgpr_write_b32 a66, v144
    v_perm_b32 v145, v94, v92, s34
    v_accvgpr_write_b32 a67, v145
    v_perm_b32 v144, v82, v80, s35
    v_accvgpr_write_b32 a68, v144
    v_perm_b32 v145, v86, v84, s35
    v_accvgpr_write_b32 a69, v145
    v_perm_b32 v144, v90, v88, s35
    v_accvgpr_write_b32 a70, v144
    v_perm_b32 v145, v94, v92, s35
    v_accvgpr_write_b32 a71, v145
    v_perm_b32 v144, v83, v81, s34
    v_accvgpr_write_b32 a72, v144
    v_perm_b32 v145, v87, v85, s34
    v_accvgpr_write_b32 a73, v145
    v_perm_b32 v144, v91, v89, s34
    v_accvgpr_write_b32 a74, v144
    v_perm_b32 v145, v95, v93, s34
    v_accvgpr_write_b32 a75, v145
    v_perm_b32 v144, v83, v81, s35
    v_accvgpr_write_b32 a76, v144
    v_perm_b32 v145, v87, v85, s35
    v_accvgpr_write_b32 a77, v145
    v_perm_b32 v144, v91, v89, s35
    v_accvgpr_write_b32 a78, v144
    v_perm_b32 v145, v95, v93, s35
    v_accvgpr_write_b32 a79, v145
    v_perm_b32 v144, v98, v96, s34
    v_accvgpr_write_b32 a80, v144
    v_perm_b32 v145, v102, v100, s34
    v_accvgpr_write_b32 a81, v145
    v_perm_b32 v144, v106, v104, s34
    v_accvgpr_write_b32 a82, v144
    v_perm_b32 v145, v110, v108, s34
    v_accvgpr_write_b32 a83, v145
    v_perm_b32 v144, v98, v96, s35
    v_accvgpr_write_b32 a84, v144
    v_perm_b32 v145, v102, v100, s35
    v_accvgpr_write_b32 a85, v145
    v_perm_b32 v144, v106, v104, s35
    v_accvgpr_write_b32 a86, v144
    v_perm_b32 v145, v110, v108, s35
    v_accvgpr_write_b32 a87, v145
    v_perm_b32 v144, v99, v97, s34
    v_accvgpr_write_b32 a88, v144
    v_perm_b32 v145, v103, v101, s34
    v_accvgpr_write_b32 a89, v145
    v_perm_b32 v144, v107, v105, s34
    v_accvgpr_write_b32 a90, v144
    v_perm_b32 v145, v111, v109, s34
    v_accvgpr_write_b32 a91, v145
    v_perm_b32 v144, v99, v97, s35
    v_accvgpr_write_b32 a92, v144
    v_perm_b32 v145, v103, v101, s35
    v_accvgpr_write_b32 a93, v145
    v_perm_b32 v144, v107, v105, s35
    v_accvgpr_write_b32 a94, v144
    v_perm_b32 v145, v111, v109, s35
    v_accvgpr_write_b32 a95, v145
    v_perm_b32 v144, v114, v112, s34
    v_accvgpr_write_b32 a96, v144
    v_perm_b32 v145, v118, v116, s34
    v_accvgpr_write_b32 a97, v145
    v_perm_b32 v144, v122, v120, s34
    v_accvgpr_write_b32 a98, v144
    v_perm_b32 v145, v126, v124, s34
    v_accvgpr_write_b32 a99, v145
    v_perm_b32 v144, v114, v112, s35
    v_accvgpr_write_b32 a100, v144
    v_perm_b32 v145, v118, v116, s35
    v_accvgpr_write_b32 a101, v145
    v_perm_b32 v144, v122, v120, s35
    v_accvgpr_write_b32 a102, v144
    v_perm_b32 v145, v126, v124, s35
    v_accvgpr_write_b32 a103, v145
    v_perm_b32 v144, v115, v113, s34
    v_accvgpr_write_b32 a104, v144
    v_perm_b32 v145, v119, v117, s34
    v_accvgpr_write_b32 a105, v145
    v_perm_b32 v144, v123, v121, s34
    v_accvgpr_write_b32 a106, v144
    v_perm_b32 v145, v127, v125, s34
    v_accvgpr_write_b32 a107, v145
    v_perm_b32 v144, v115, v113, s35
    v_accvgpr_write_b32 a108, v144
    v_perm_b32 v145, v119, v117, s35
    v_accvgpr_write_b32 a109, v145
    v_perm_b32 v144, v123, v121, s35
    v_accvgpr_write_b32 a110, v144
    v_perm_b32 v145, v127, v125, s35
    v_accvgpr_write_b32 a111, v145
    v_perm_b32 v144, v130, v128, s34
    v_accvgpr_write_b32 a112, v144
    v_perm_b32 v145, v134, v132, s34
    v_accvgpr_write_b32 a113, v145
    v_perm_b32 v144, v138, v136, s34
    v_accvgpr_write_b32 a114, v144
    v_perm_b32 v145, v142, v140, s34
    v_accvgpr_write_b32 a115, v145
    v_perm_b32 v144, v130, v128, s35
    v_accvgpr_write_b32 a116, v144
    v_perm_b32 v145, v134, v132, s35
    v_accvgpr_write_b32 a117, v145
    v_perm_b32 v144, v138, v136, s35
    v_accvgpr_write_b32 a118, v144
    v_perm_b32 v145, v142, v140, s35
    v_accvgpr_write_b32 a119, v145
    v_perm_b32 v144, v131, v129, s34
    v_accvgpr_write_b32 a120, v144
    v_perm_b32 v145, v135, v133, s34
    v_accvgpr_write_b32 a121, v145
    v_perm_b32 v144, v139, v137, s34
    v_accvgpr_write_b32 a122, v144
    v_perm_b32 v145, v143, v141, s34
    v_accvgpr_write_b32 a123, v145
    v_perm_b32 v144, v131, v129, s35
    v_accvgpr_write_b32 a124, v144
    v_perm_b32 v145, v135, v133, s35
    v_accvgpr_write_b32 a125, v145
    v_perm_b32 v144, v139, v137, s35
    v_accvgpr_write_b32 a126, v144
    v_perm_b32 v145, v143, v141, s35
    v_accvgpr_write_b32 a127, v145
    s_load_dwordx2 s[44:45], s[0:1], 16
    s_load_dwordx2 s[48:49], s[0:1], 40
    s_sub_u32 s40, s2, 64
    s_lshl_b32 s40, s40, 8
    v_add_u32 v190, s40, v0
    v_lshlrev_b32 v190, 7, v190
    s_waitcnt lgkmcnt(0)
    s_mov_b32 s46, 5242880
    s_mov_b32 s47, 0x00020000
    s_mov_b32 s50, 5242880
    s_mov_b32 s51, 0x00020000
    s_mov_b32 s40, 4194304
    buffer_load_dword v191, v190, s[44:47], 0 offen
    buffer_load_dword v191, v190, s[44:47], s40 offen
    buffer_load_dword v191, v190, s[48:51], 0 offen
    buffer_load_dword v191, v190, s[48:51], s40 offen
    buffer_load_dwordx2 v[80:81], v4, s[4:7], s32 offen
    s_add_u32 s32, s32, 8192
    buffer_load_dwordx2 v[82:83], v4, s[4:7], s32 offen
    s_add_u32 s32, s32, 8192
    buffer_load_dwordx2 v[84:85], v4, s[4:7], s32 offen
    s_add_u32 s32, s32, 8192
    buffer_load_dwordx2 v[86:87], v4, s[4:7], s32 offen
    s_add_u32 s32, s32, 8192
    buffer_load_dwordx2 v[88:89], v4, s[4:7], s32 offen
    s_add_u32 s32, s32, 8192
    buffer_load_dwordx2 v[90:91], v4, s[4:7], s32 offen
    s_add_u32 s32, s32, 8192
    buffer_load_dwordx2 v[92:93], v4, s[4:7], s32 offen
    s_add_u32 s32, s32, 8192
    buffer_load_dwordx2 v[94:95], v4, s[4:7], s32 offen
    s_add_u32 s32, s32, 204800
    buffer_load_dwordx2 v[96:97], v4, s[4:7], s32 offen
    s_add_u32 s32, s32, 8192
    buffer_load_dwordx2 v[98:99], v4, s[4:7], s32 offen
    s_add_u32 s32, s32, 8192
    buffer_load_dwordx2 v[100:101], v4, s[4:7], s32 offen
    s_add_u32 s32, s32, 8192
    buffer_load_dwordx2 v[102:103], v4, s[4:7], s32 offen
    s_add_u32 s32, s32, 8192
    buffer_load_dwordx2 v[104:105], v4, s[4:7], s32 offen
    s_add_u32 s32, s32, 8192
    buffer_load_dwordx2 v[106:107], v4, s[4:7], s32 offen
    s_add_u32 s32, s32, 8192
    buffer_load_dwordx2 v[108:109], v4, s[4:7], s32 offen
    s_add_u32 s32, s32, 8192
    buffer_load_dwordx2 v[110:111], v4, s[4:7], s32 offen
    s_add_u32 s32, s32, 204800
    buffer_load_dwordx2 v[112:113], v4, s[4:7], s32 offen
    s_add_u32 s32, s32, 8192
    buffer_load_dwordx2 v[114:115], v4, s[4:7], s32 offen
    s_add_u32 s32, s32, 8192
    buffer_load_dwordx2 v[116:117], v4, s[4:7], s32 offen
    s_add_u32 s32, s32, 8192
    buffer_load_dwordx2 v[118:119], v4, s[4:7], s32 offen
    s_add_u32 s32, s32, 8192
    buffer_load_dwordx2 v[120:121], v4, s[4:7], s32 offen
    s_add_u32 s32, s32, 8192
    buffer_load_dwordx2 v[122:123], v4, s[4:7], s32 offen
    s_add_u32 s32, s32, 8192
    buffer_load_dwordx2 v[124:125], v4, s[4:7], s32 offen
    s_add_u32 s32, s32, 8192
    buffer_load_dwordx2 v[126:127], v4, s[4:7], s32 offen
    s_add_u32 s32, s32, 204800
    buffer_load_dwordx2 v[128:129], v4, s[4:7], s32 offen
    s_add_u32 s32, s32, 8192
    buffer_load_dwordx2 v[130:131], v4, s[4:7], s32 offen
    s_add_u32 s32, s32, 8192
    buffer_load_dwordx2 v[132:133], v4, s[4:7], s32 offen
    s_add_u32 s32, s32, 8192
    buffer_load_dwordx2 v[134:135], v4, s[4:7], s32 offen
    s_add_u32 s32, s32, 8192
    buffer_load_dwordx2 v[136:137], v4, s[4:7], s32 offen
    s_add_u32 s32, s32, 8192
    buffer_load_dwordx2 v[138:139], v4, s[4:7], s32 offen
    s_add_u32 s32, s32, 8192
    buffer_load_dwordx2 v[140:141], v4, s[4:7], s32 offen
    s_add_u32 s32, s32, 8192
    buffer_load_dwordx2 v[142:143], v4, s[4:7], s32 offen
    s_add_u32 s32, s32, 204800
    s_waitcnt vmcnt(36)
    v_perm_b32 v144, v18, v16, s34
    v_accvgpr_write_b32 a128, v144
    v_perm_b32 v145, v22, v20, s34
    v_accvgpr_write_b32 a129, v145
    v_perm_b32 v144, v26, v24, s34
    v_accvgpr_write_b32 a130, v144
    v_perm_b32 v145, v30, v28, s34
    v_accvgpr_write_b32 a131, v145
    v_perm_b32 v144, v18, v16, s35
    v_accvgpr_write_b32 a132, v144
    v_perm_b32 v145, v22, v20, s35
    v_accvgpr_write_b32 a133, v145
    v_perm_b32 v144, v26, v24, s35
    v_accvgpr_write_b32 a134, v144
    v_perm_b32 v145, v30, v28, s35
    v_accvgpr_write_b32 a135, v145
    v_perm_b32 v144, v19, v17, s34
    v_accvgpr_write_b32 a136, v144
    v_perm_b32 v145, v23, v21, s34
    v_accvgpr_write_b32 a137, v145
    v_perm_b32 v144, v27, v25, s34
    v_accvgpr_write_b32 a138, v144
    v_perm_b32 v145, v31, v29, s34
    v_accvgpr_write_b32 a139, v145
    v_perm_b32 v144, v19, v17, s35
    v_accvgpr_write_b32 a140, v144
    v_perm_b32 v145, v23, v21, s35
    v_accvgpr_write_b32 a141, v145
    v_perm_b32 v144, v27, v25, s35
    v_accvgpr_write_b32 a142, v144
    v_perm_b32 v145, v31, v29, s35
    v_accvgpr_write_b32 a143, v145
    v_perm_b32 v144, v34, v32, s34
    v_accvgpr_write_b32 a144, v144
    v_perm_b32 v145, v38, v36, s34
    v_accvgpr_write_b32 a145, v145
    v_perm_b32 v144, v42, v40, s34
    v_accvgpr_write_b32 a146, v144
    v_perm_b32 v145, v46, v44, s34
    v_accvgpr_write_b32 a147, v145
    v_perm_b32 v144, v34, v32, s35
    v_accvgpr_write_b32 a148, v144
    v_perm_b32 v145, v38, v36, s35
    v_accvgpr_write_b32 a149, v145
    v_perm_b32 v144, v42, v40, s35
    v_accvgpr_write_b32 a150, v144
    v_perm_b32 v145, v46, v44, s35
    v_accvgpr_write_b32 a151, v145
    v_perm_b32 v144, v35, v33, s34
    v_accvgpr_write_b32 a152, v144
    v_perm_b32 v145, v39, v37, s34
    v_accvgpr_write_b32 a153, v145
    v_perm_b32 v144, v43, v41, s34
    v_accvgpr_write_b32 a154, v144
    v_perm_b32 v145, v47, v45, s34
    v_accvgpr_write_b32 a155, v145
    v_perm_b32 v144, v35, v33, s35
    v_accvgpr_write_b32 a156, v144
    v_perm_b32 v145, v39, v37, s35
    v_accvgpr_write_b32 a157, v145
    v_perm_b32 v144, v43, v41, s35
    v_accvgpr_write_b32 a158, v144
    v_perm_b32 v145, v47, v45, s35
    v_accvgpr_write_b32 a159, v145
    v_perm_b32 v144, v50, v48, s34
    v_accvgpr_write_b32 a160, v144
    v_perm_b32 v145, v54, v52, s34
    v_accvgpr_write_b32 a161, v145
    v_perm_b32 v144, v58, v56, s34
    v_accvgpr_write_b32 a162, v144
    v_perm_b32 v145, v62, v60, s34
    v_accvgpr_write_b32 a163, v145
    v_perm_b32 v144, v50, v48, s35
    v_accvgpr_write_b32 a164, v144
    v_perm_b32 v145, v54, v52, s35
    v_accvgpr_write_b32 a165, v145
    v_perm_b32 v144, v58, v56, s35
    v_accvgpr_write_b32 a166, v144
    v_perm_b32 v145, v62, v60, s35
    v_accvgpr_write_b32 a167, v145
    v_perm_b32 v144, v51, v49, s34
    v_accvgpr_write_b32 a168, v144
    v_perm_b32 v145, v55, v53, s34
    v_accvgpr_write_b32 a169, v145
    v_perm_b32 v144, v59, v57, s34
    v_accvgpr_write_b32 a170, v144
    v_perm_b32 v145, v63, v61, s34
    v_accvgpr_write_b32 a171, v145
    v_perm_b32 v144, v51, v49, s35
    v_accvgpr_write_b32 a172, v144
    v_perm_b32 v145, v55, v53, s35
    v_accvgpr_write_b32 a173, v145
    v_perm_b32 v144, v59, v57, s35
    v_accvgpr_write_b32 a174, v144
    v_perm_b32 v145, v63, v61, s35
    v_accvgpr_write_b32 a175, v145
    v_perm_b32 v144, v66, v64, s34
    v_accvgpr_write_b32 a176, v144
    v_perm_b32 v145, v70, v68, s34
    v_accvgpr_write_b32 a177, v145
    v_perm_b32 v144, v74, v72, s34
    v_accvgpr_write_b32 a178, v144
    v_perm_b32 v145, v78, v76, s34
    v_accvgpr_write_b32 a179, v145
    v_perm_b32 v144, v66, v64, s35
    v_accvgpr_write_b32 a180, v144
    v_perm_b32 v145, v70, v68, s35
    v_accvgpr_write_b32 a181, v145
    v_perm_b32 v144, v74, v72, s35
    v_accvgpr_write_b32 a182, v144
    v_perm_b32 v145, v78, v76, s35
    v_accvgpr_write_b32 a183, v145
    v_perm_b32 v144, v67, v65, s34
    v_accvgpr_write_b32 a184, v144
    v_perm_b32 v145, v71, v69, s34
    v_accvgpr_write_b32 a185, v145
    v_perm_b32 v144, v75, v73, s34
    v_accvgpr_write_b32 a186, v144
    v_perm_b32 v145, v79, v77, s34
    v_accvgpr_write_b32 a187, v145
    v_perm_b32 v144, v67, v65, s35
    v_accvgpr_write_b32 a188, v144
    v_perm_b32 v145, v71, v69, s35
    v_accvgpr_write_b32 a189, v145
    v_perm_b32 v144, v75, v73, s35
    v_accvgpr_write_b32 a190, v144
    v_perm_b32 v145, v79, v77, s35
    v_accvgpr_write_b32 a191, v145
    s_lshl_b32 s40, s21, 2
    s_add_u32 s40, s40, 240
    v_mov_b32 v186, 0
    buffer_load_dword v187, v186, s[84:87], s40 offen sc1
    buffer_load_dwordx2 v[16:17], v4, s[4:7], s32 offen
    s_add_u32 s32, s32, 8192
    buffer_load_dwordx2 v[18:19], v4, s[4:7], s32 offen
    s_add_u32 s32, s32, 8192
    buffer_load_dwordx2 v[20:21], v4, s[4:7], s32 offen
    s_add_u32 s32, s32, 8192
    buffer_load_dwordx2 v[22:23], v4, s[4:7], s32 offen
    s_add_u32 s32, s32, 8192
    buffer_load_dwordx2 v[24:25], v4, s[4:7], s32 offen
    s_add_u32 s32, s32, 8192
    buffer_load_dwordx2 v[26:27], v4, s[4:7], s32 offen
    s_add_u32 s32, s32, 8192
    buffer_load_dwordx2 v[28:29], v4, s[4:7], s32 offen
    s_add_u32 s32, s32, 8192
    buffer_load_dwordx2 v[30:31], v4, s[4:7], s32 offen
    s_add_u32 s32, s32, 204800
    buffer_load_dwordx2 v[32:33], v4, s[4:7], s32 offen
    s_add_u32 s32, s32, 8192
    buffer_load_dwordx2 v[34:35], v4, s[4:7], s32 offen
    s_add_u32 s32, s32, 8192
    buffer_load_dwordx2 v[36:37], v4, s[4:7], s32 offen
    s_add_u32 s32, s32, 8192
    buffer_load_dwordx2 v[38:39], v4, s[4:7], s32 offen
    s_add_u32 s32, s32, 8192
    buffer_load_dwordx2 v[40:41], v4, s[4:7], s32 offen
    s_add_u32 s32, s32, 8192
    buffer_load_dwordx2 v[42:43], v4, s[4:7], s32 offen
    s_add_u32 s32, s32, 8192
    buffer_load_dwordx2 v[44:45], v4, s[4:7], s32 offen
    s_add_u32 s32, s32, 8192
    buffer_load_dwordx2 v[46:47], v4, s[4:7], s32 offen
    s_add_u32 s32, s32, 204800
    buffer_load_dwordx2 v[48:49], v4, s[4:7], s32 offen
    s_add_u32 s32, s32, 8192
    buffer_load_dwordx2 v[50:51], v4, s[4:7], s32 offen
    s_add_u32 s32, s32, 8192
    buffer_load_dwordx2 v[52:53], v4, s[4:7], s32 offen
    s_add_u32 s32, s32, 8192
    buffer_load_dwordx2 v[54:55], v4, s[4:7], s32 offen
    s_add_u32 s32, s32, 8192
    buffer_load_dwordx2 v[56:57], v4, s[4:7], s32 offen
    s_add_u32 s32, s32, 8192
    buffer_load_dwordx2 v[58:59], v4, s[4:7], s32 offen
    s_add_u32 s32, s32, 8192
    buffer_load_dwordx2 v[60:61], v4, s[4:7], s32 offen
    s_add_u32 s32, s32, 8192
    buffer_load_dwordx2 v[62:63], v4, s[4:7], s32 offen
    s_add_u32 s32, s32, 204800
    buffer_load_dwordx2 v[64:65], v4, s[4:7], s32 offen
    s_add_u32 s32, s32, 8192
    buffer_load_dwordx2 v[66:67], v4, s[4:7], s32 offen
    s_add_u32 s32, s32, 8192
    buffer_load_dwordx2 v[68:69], v4, s[4:7], s32 offen
    s_add_u32 s32, s32, 8192
    buffer_load_dwordx2 v[70:71], v4, s[4:7], s32 offen
    s_add_u32 s32, s32, 8192
    buffer_load_dwordx2 v[72:73], v4, s[4:7], s32 offen
    s_add_u32 s32, s32, 8192
    buffer_load_dwordx2 v[74:75], v4, s[4:7], s32 offen
    s_add_u32 s32, s32, 8192
    buffer_load_dwordx2 v[76:77], v4, s[4:7], s32 offen
    s_add_u32 s32, s32, 8192
    buffer_load_dwordx2 v[78:79], v4, s[4:7], s32 offen
    s_add_u32 s32, s32, 204800
    s_waitcnt vmcnt(33)
    v_perm_b32 v144, v82, v80, s34
    v_accvgpr_write_b32 a192, v144
    v_perm_b32 v145, v86, v84, s34
    v_accvgpr_write_b32 a193, v145
    v_perm_b32 v144, v90, v88, s34
    v_accvgpr_write_b32 a194, v144
    v_perm_b32 v145, v94, v92, s34
    v_accvgpr_write_b32 a195, v145
    v_perm_b32 v144, v82, v80, s35
    v_accvgpr_write_b32 a196, v144
    v_perm_b32 v145, v86, v84, s35
    v_accvgpr_write_b32 a197, v145
    v_perm_b32 v144, v90, v88, s35
    v_accvgpr_write_b32 a198, v144
    v_perm_b32 v145, v94, v92, s35
    v_accvgpr_write_b32 a199, v145
    v_perm_b32 v144, v83, v81, s34
    v_accvgpr_write_b32 a200, v144
    v_perm_b32 v145, v87, v85, s34
    v_accvgpr_write_b32 a201, v145
    v_perm_b32 v144, v91, v89, s34
    v_accvgpr_write_b32 a202, v144
    v_perm_b32 v145, v95, v93, s34
    v_accvgpr_write_b32 a203, v145
    v_perm_b32 v144, v83, v81, s35
    v_accvgpr_write_b32 a204, v144
    v_perm_b32 v145, v87, v85, s35
    v_accvgpr_write_b32 a205, v145
    v_perm_b32 v144, v91, v89, s35
    v_accvgpr_write_b32 a206, v144
    v_perm_b32 v145, v95, v93, s35
    v_accvgpr_write_b32 a207, v145
    v_perm_b32 v144, v98, v96, s34
    v_accvgpr_write_b32 a208, v144
    v_perm_b32 v145, v102, v100, s34
    v_accvgpr_write_b32 a209, v145
    v_perm_b32 v144, v106, v104, s34
    v_accvgpr_write_b32 a210, v144
    v_perm_b32 v145, v110, v108, s34
    v_accvgpr_write_b32 a211, v145
    v_perm_b32 v144, v98, v96, s35
    v_accvgpr_write_b32 a212, v144
    v_perm_b32 v145, v102, v100, s35
    v_accvgpr_write_b32 a213, v145
    v_perm_b32 v144, v106, v104, s35
    v_accvgpr_write_b32 a214, v144
    v_perm_b32 v145, v110, v108, s35
    v_accvgpr_write_b32 a215, v145
    v_perm_b32 v144, v99, v97, s34
    v_accvgpr_write_b32 a216, v144
    v_perm_b32 v145, v103, v101, s34
    v_accvgpr_write_b32 a217, v145
    v_perm_b32 v144, v107, v105, s34
    v_accvgpr_write_b32 a218, v144
    v_perm_b32 v145, v111, v109, s34
    v_accvgpr_write_b32 a219, v145
    v_perm_b32 v144, v99, v97, s35
    v_accvgpr_write_b32 a220, v144
    v_perm_b32 v145, v103, v101, s35
    v_accvgpr_write_b32 a221, v145
    v_perm_b32 v144, v107, v105, s35
    v_accvgpr_write_b32 a222, v144
    v_perm_b32 v145, v111, v109, s35
    v_accvgpr_write_b32 a223, v145
    v_perm_b32 v144, v114, v112, s34
    v_accvgpr_write_b32 a224, v144
    v_perm_b32 v145, v118, v116, s34
    v_accvgpr_write_b32 a225, v145
    v_perm_b32 v144, v122, v120, s34
    v_accvgpr_write_b32 a226, v144
    v_perm_b32 v145, v126, v124, s34
    v_accvgpr_write_b32 a227, v145
    v_perm_b32 v144, v114, v112, s35
    v_accvgpr_write_b32 a228, v144
    v_perm_b32 v145, v118, v116, s35
    v_accvgpr_write_b32 a229, v145
    v_perm_b32 v144, v122, v120, s35
    v_accvgpr_write_b32 a230, v144
    v_perm_b32 v145, v126, v124, s35
    v_accvgpr_write_b32 a231, v145
    v_perm_b32 v144, v115, v113, s34
    v_accvgpr_write_b32 a232, v144
    v_perm_b32 v145, v119, v117, s34
    v_accvgpr_write_b32 a233, v145
    v_perm_b32 v144, v123, v121, s34
    v_accvgpr_write_b32 a234, v144
    v_perm_b32 v145, v127, v125, s34
    v_accvgpr_write_b32 a235, v145
    v_perm_b32 v144, v115, v113, s35
    v_accvgpr_write_b32 a236, v144
    v_perm_b32 v145, v119, v117, s35
    v_accvgpr_write_b32 a237, v145
    v_perm_b32 v144, v123, v121, s35
    v_accvgpr_write_b32 a238, v144
    v_perm_b32 v145, v127, v125, s35
    v_accvgpr_write_b32 a239, v145
    v_perm_b32 v144, v130, v128, s34
    v_accvgpr_write_b32 a240, v144
    v_perm_b32 v145, v134, v132, s34
    v_accvgpr_write_b32 a241, v145
    v_perm_b32 v144, v138, v136, s34
    v_accvgpr_write_b32 a242, v144
    v_perm_b32 v145, v142, v140, s34
    v_accvgpr_write_b32 a243, v145
    v_perm_b32 v144, v130, v128, s35
    v_accvgpr_write_b32 a244, v144
    v_perm_b32 v145, v134, v132, s35
    v_accvgpr_write_b32 a245, v145
    v_perm_b32 v144, v138, v136, s35
    v_accvgpr_write_b32 a246, v144
    v_perm_b32 v145, v142, v140, s35
    v_accvgpr_write_b32 a247, v145
    v_perm_b32 v144, v131, v129, s34
    v_accvgpr_write_b32 a248, v144
    v_perm_b32 v145, v135, v133, s34
    v_accvgpr_write_b32 a249, v145
    v_perm_b32 v144, v139, v137, s34
    v_accvgpr_write_b32 a250, v144
    v_perm_b32 v145, v143, v141, s34
    v_accvgpr_write_b32 a251, v145
    v_perm_b32 v144, v131, v129, s35
    v_accvgpr_write_b32 a252, v144
    v_perm_b32 v145, v135, v133, s35
    v_accvgpr_write_b32 a253, v145
    v_perm_b32 v144, v139, v137, s35
    v_accvgpr_write_b32 a254, v144
    v_perm_b32 v145, v143, v141, s35
    v_accvgpr_write_b32 a255, v145
    s_waitcnt vmcnt(32)
    v_readfirstlane_b32 s53, v187
    s_cmp_eq_u32 s53, 0
    s_cbranch_scc1 L_mq_noe
    s_mov_b32 s30, s29
    s_mov_b32 s31, s28
    s_mov_b32 m0, s31
    s_nop 0
    buffer_load_dwordx4 v5, s[12:15], s30 offen offset:0 sc1 lds
    buffer_load_dwordx4 v5, s[12:15], s30 offen offset:1024 sc1 lds
    buffer_load_dwordx4 v5, s[12:15], s30 offen offset:2048 sc1 lds
    buffer_load_dwordx4 v5, s[12:15], s30 offen offset:3072 sc1 lds
    s_add_u32 s31, s31, 4096
    s_add_u32 s30, s30, 4096
    s_mov_b32 m0, s31
    s_nop 0
    buffer_load_dwordx4 v5, s[12:15], s30 offen offset:0 sc1 lds
    buffer_load_dwordx4 v5, s[12:15], s30 offen offset:1024 sc1 lds
    buffer_load_dwordx4 v5, s[12:15], s30 offen offset:2048 sc1 lds
    buffer_load_dwordx4 v5, s[12:15], s30 offen offset:3072 sc1 lds
    s_add_u32 s31, s31, 4096
    s_add_u32 s30, s30, 4096
    s_mov_b32 m0, s31
    s_nop 0
    buffer_load_dwordx4 v5, s[12:15], s30 offen offset:0 sc1 lds
    buffer_load_dwordx4 v5, s[12:15], s30 offen offset:1024 sc1 lds
L_mq_noe:
    s_waitcnt vmcnt(0)
    v_perm_b32 v192, v18, v16, s34
    v_perm_b32 v193, v22, v20, s34
    v_perm_b32 v194, v26, v24, s34
    v_perm_b32 v195, v30, v28, s34
    v_perm_b32 v196, v18, v16, s35
    v_perm_b32 v197, v22, v20, s35
    v_perm_b32 v198, v26, v24, s35
    v_perm_b32 v199, v30, v28, s35
    v_perm_b32 v200, v19, v17, s34
    v_perm_b32 v201, v23, v21, s34
    v_perm_b32 v202, v27, v25, s34
    v_perm_b32 v203, v31, v29, s34
    v_perm_b32 v204, v19, v17, s35
    v_perm_b32 v205, v23, v21, s35
    v_perm_b32 v206, v27, v25, s35
    v_perm_b32 v207, v31, v29, s35
    v_perm_b32 v208, v34, v32, s34
    v_perm_b32 v209, v38, v36, s34
    v_perm_b32 v210, v42, v40, s34
    v_perm_b32 v211, v46, v44, s34
    v_perm_b32 v212, v34, v32, s35
    v_perm_b32 v213, v38, v36, s35
    v_perm_b32 v214, v42, v40, s35
    v_perm_b32 v215, v46, v44, s35
    v_perm_b32 v216, v35, v33, s34
    v_perm_b32 v217, v39, v37, s34
    v_perm_b32 v218, v43, v41, s34
    v_perm_b32 v219, v47, v45, s34
    v_perm_b32 v220, v35, v33, s35
    v_perm_b32 v221, v39, v37, s35
    v_perm_b32 v222, v43, v41, s35
    v_perm_b32 v223, v47, v45, s35
    v_perm_b32 v224, v50, v48, s34
    v_perm_b32 v225, v54, v52, s34
    v_perm_b32 v226, v58, v56, s34
    v_perm_b32 v227, v62, v60, s34
    v_perm_b32 v228, v50, v48, s35
    v_perm_b32 v229, v54, v52, s35
    v_perm_b32 v230, v58, v56, s35
    v_perm_b32 v231, v62, v60, s35
    v_perm_b32 v232, v51, v49, s34
    v_perm_b32 v233, v55, v53, s34
    v_perm_b32 v234, v59, v57, s34
    v_perm_b32 v235, v63, v61, s34
    v_perm_b32 v236, v51, v49, s35
    v_perm_b32 v237, v55, v53, s35
    v_perm_b32 v238, v59, v57, s35
    v_perm_b32 v239, v63, v61, s35
    v_perm_b32 v240, v66, v64, s34
    v_perm_b32 v241, v70, v68, s34
    v_perm_b32 v242, v74, v72, s34
    v_perm_b32 v243, v78, v76, s34
    v_perm_b32 v244, v66, v64, s35
    v_perm_b32 v245, v70, v68, s35
    v_perm_b32 v246, v74, v72, s35
    v_perm_b32 v247, v78, v76, s35
    v_perm_b32 v248, v67, v65, s34
    v_perm_b32 v249, v71, v69, s34
    v_perm_b32 v250, v75, v73, s34
    v_perm_b32 v251, v79, v77, s34
    v_perm_b32 v252, v67, v65, s35
    v_perm_b32 v253, v71, v69, s35
    v_perm_b32 v254, v75, v73, s35
    v_perm_b32 v255, v79, v77, s35
    s_cmp_lt_u32 s2, 64
    s_cbranch_scc1 L_mq_nofill
    v_lshlrev_b32 v8, 4, v0
    s_cmp_lt_u32 s2, 72
    s_cbranch_scc0 L_mega_fill1
    v_mov_b32 v12, 0
    v_mov_b32 v13, 0
    v_mov_b32 v14, 0
    v_mov_b32 v15, 0
    s_sub_u32 s42, s2, 64
    s_lshl_b32 s42, s42, 12
    s_add_u32 s42, s42, 116523008
    buffer_store_dwordx4 v[12:15], v8, s[12:15], s42 offen sc1
L_mega_fill1:
L_mq_nofill:
    s_cmp_eq_u32 s53, 0
    s_cbranch_scc0 L_mq_dmaok
    s_lshl_b32 s40, s21, 2
    s_add_u32 s40, s40, 240
    s_mov_b32 s98, 0
    v_mov_b32 v14, 0
L_wait_36:
    buffer_load_dword v15, v14, s[84:87], s40 offen sc1
    s_waitcnt vmcnt(0)
    v_readfirstlane_b32 s99, v15
    s_cmp_ge_u32 s99, 1
    s_cbranch_scc1 L_ok_37
    s_sleep 8
    s_add_u32 s98, s98, 1
    s_cmp_lt_u32 s98, 1048576
    s_cbranch_scc1 L_wait_36
    s_branch L_mega_done
L_ok_37:
    s_mov_b32 s30, s29
    s_mov_b32 s31, s28
    s_mov_b32 m0, s31
    s_nop 0
    buffer_load_dwordx4 v5, s[12:15], s30 offen offset:0 sc1 lds
    buffer_load_dwordx4 v5, s[12:15], s30 offen offset:1024 sc1 lds
    buffer_load_dwordx4 v5, s[12:15], s30 offen offset:2048 sc1 lds
    buffer_load_dwordx4 v5, s[12:15], s30 offen offset:3072 sc1 lds
    s_add_u32 s31, s31, 4096
    s_add_u32 s30, s30, 4096
    s_mov_b32 m0, s31
    s_nop 0
    buffer_load_dwordx4 v5, s[12:15], s30 offen offset:0 sc1 lds
    buffer_load_dwordx4 v5, s[12:15], s30 offen offset:1024 sc1 lds
    buffer_load_dwordx4 v5, s[12:15], s30 offen offset:2048 sc1 lds
    buffer_load_dwordx4 v5, s[12:15], s30 offen offset:3072 sc1 lds
    s_add_u32 s31, s31, 4096
    s_add_u32 s30, s30, 4096
    s_mov_b32 m0, s31
    s_nop 0
    buffer_load_dwordx4 v5, s[12:15], s30 offen offset:0 sc1 lds
    buffer_load_dwordx4 v5, s[12:15], s30 offen offset:1024 sc1 lds
L_mq_dmaok:
    s_lshl_b32 s36, s23, 1
    s_lshr_b32 s37, s25, 1
    s_add_u32 s36, s36, s37
    s_and_b32 s37, s25, 1
    s_lshl_b32 s38, s36, 13
    s_mul_i32 s39, s22, 16777216
    s_add_u32 s38, s38, s39
    s_add_u32 s38, s38, 4194304
    s_lshl_b32 s39, s21, 18
    s_add_u32 s38, s38, s39
    v_lshrrev_b32 v6, 1, v3
    v_lshlrev_b32 v6, 10, v6
    v_and_b32 v7, 1, v3
    v_lshl_add_u32 v6, v7, 9, v6
    v_lshl_add_u32 v6, v2, 4, v6
    s_lshl_b32 s39, s37, 11
    v_add_u32 v6, s39, v6
    s_lshl_b32 s39, s37, 12
    v_add_u32 v7, s39, v5
    s_mov_b32 s33, 0
    s_mov_b32 s44, 0
    s_lshl_b32 s47, s20, 6
    s_lshl_b32 s46, s21, 2
    s_add_u32 s47, s47, s46
    s_add_u32 s47, s47, 116555776
    v_mov_b32 v10, 0
    v_lshlrev_b32 v8, 4, v0
    v_mov_b32 v12, -1
    v_mov_b32 v13, -1
    v_mov_b32 v14, -1
    v_mov_b32 v15, -1
    s_lshl_b32 s50, s21, 16
    s_lshl_b32 s51, s23, 12
    s_add_u32 s50, s50, s51
    s_add_u32 s51, s50, 112328704
    s_add_u32 s52, s50, 108134400
    s_add_u32 s50, s50, 103940096
L_mq_loop:
    s_waitcnt vmcnt(4)
    s_sub_u32 s48, s33, 1
    s_sub_u32 s49, s33, 2
    s_cmp_lt_u32 s49, 14
    s_cbranch_scc1 L_mq_lazy
    s_waitcnt vmcnt(0)
    s_mov_b32 s48, s33
L_mq_lazy:
    s_barrier
    s_cmp_eq_u32 s25, 0
    s_cbranch_scc0 L_mq_noprog
    v_mov_b32 v11, s48
    s_mov_b64 exec, 1
    buffer_store_dword v11, v10, s[12:15], s47 offen sc1
    s_mov_b64 exec, -1
    s_cmp_eq_u32 s33, 0
    s_cbranch_scc0 L_mq_noprog
    s_cmp_lt_u32 s2, 64
    s_cbranch_scc1 L_mq_noprog
    v_mov_b32 v11, 1
    s_mov_b32 s40, 64
    s_mov_b64 exec, 1
    buffer_atomic_add v11, v10, s[84:87], s40 offen sc1
    s_mov_b64 exec, -1
L_mq_noprog:
    s_cmp_ge_u32 s33, 16
    s_cbranch_scc1 L_mq_end
    s_cmp_eq_u32 s33, 0
    s_cbranch_scc1 L_mq_nodma
    s_cmp_eq_u32 s33, 1
    s_cbranch_scc0 L_mq_not1b
    s_cmp_eq_u32 s25, 0
    s_cbranch_scc0 L_wgw_38
    s_mov_b32 s40, 192
    s_mov_b32 s98, 0
    v_mov_b32 v16, 0
L_wait_39:
    buffer_load_dword v17, v16, s[84:87], s40 offen sc1
    s_waitcnt vmcnt(0)
    v_readfirstlane_b32 s99, v17
    s_cmp_ge_u32 s99, 64
    s_cbranch_scc1 L_ok_40
    s_sleep 6
    s_add_u32 s98, s98, 1
    s_cmp_lt_u32 s98, 1048576
    s_cbranch_scc1 L_wait_39
    s_branch L_mega_done
L_ok_40:
L_wgw_38:
    s_barrier
    s_add_u32 s29, s29, 163840
    s_mov_b32 s30, s29
    s_add_u32 s45, s44, s28
    s_mov_b32 s31, s45
    s_mov_b32 m0, s31
    s_nop 0
    buffer_load_dwordx4 v5, s[12:15], s30 offen offset:0 sc1 lds
    buffer_load_dwordx4 v5, s[12:15], s30 offen offset:1024 sc1 lds
    buffer_load_dwordx4 v5, s[12:15], s30 offen offset:2048 sc1 lds
    buffer_load_dwordx4 v5, s[12:15], s30 offen offset:3072 sc1 lds
    s_add_u32 s31, s31, 4096
    s_add_u32 s30, s30, 4096
    s_mov_b32 m0, s31
    s_nop 0
    buffer_load_dwordx4 v5, s[12:15], s30 offen offset:0 sc1 lds
    buffer_load_dwordx4 v5, s[12:15], s30 offen offset:1024 sc1 lds
    buffer_load_dwordx4 v5, s[12:15], s30 offen offset:2048 sc1 lds
    buffer_load_dwordx4 v5, s[12:15], s30 offen offset:3072 sc1 lds
    s_add_u32 s31, s31, 4096
    s_add_u32 s30, s30, 4096
    s_mov_b32 m0, s31
    s_nop 0
    buffer_load_dwordx4 v5, s[12:15], s30 offen offset:0 sc1 lds
    buffer_load_dwordx4 v5, s[12:15], s30 offen offset:1024 sc1 lds
    s_waitcnt vmcnt(0)
    s_barrier
L_mq_not1b:
    s_cmp_ge_u32 s33, 15
    s_cbranch_scc1 L_mq_nodma
    s_add_u32 s29, s29, 163840
    s_mov_b32 s30, s29
    s_xor_b32 s45, s44, 40960
    s_add_u32 s45, s45, s28
    s_mov_b32 s31, s45
    s_mov_b32 m0, s31
    s_nop 0
    buffer_load_dwordx4 v5, s[12:15], s30 offen offset:0 sc1 lds
    buffer_load_dwordx4 v5, s[12:15], s30 offen offset:1024 sc1 lds
    buffer_load_dwordx4 v5, s[12:15], s30 offen offset:2048 sc1 lds
    buffer_load_dwordx4 v5, s[12:15], s30 offen offset:3072 sc1 lds
    s_add_u32 s31, s31, 4096
    s_add_u32 s30, s30, 4096
    s_mov_b32 m0, s31
    s_nop 0
    buffer_load_dwordx4 v5, s[12:15], s30 offen offset:0 sc1 lds
    buffer_load_dwordx4 v5, s[12:15], s30 offen offset:1024 sc1 lds
    buffer_load_dwordx4 v5, s[12:15], s30 offen offset:2048 sc1 lds
    buffer_load_dwordx4 v5, s[12:15], s30 offen offset:3072 sc1 lds
    s_add_u32 s31, s31, 4096
    s_add_u32 s30, s30, 4096
    s_mov_b32 m0, s31
    s_nop 0
    buffer_load_dwordx4 v5, s[12:15], s30 offen offset:0 sc1 lds
    buffer_load_dwordx4 v5, s[12:15], s30 offen offset:1024 sc1 lds
L_mq_nodma:
    v_add_u32 v9, s44, v5
    s_cmp_eq_u32 s22, 2
    s_cbranch_scc1 L_mq_v
    s_cmp_eq_u32 s22, 1
    s_cbranch_scc0 L_mq_nokf
    buffer_store_dwordx4 v[12:15], v8, s[12:15], s50 offen sc1
    buffer_store_dwordx4 v[12:15], v8, s[12:15], s51 offen sc1
    s_add_u32 s50, s50, 262144
    s_add_u32 s51, s51, 262144
L_mq_nokf:
    ds_read_b128 v[96:99], v9 offset:0
    ds_read_b128 v[100:103], v9 offset:1024
    ds_read_b128 v[104:107], v9 offset:2048
    ds_read_b128 v[108:111], v9 offset:3072
    ds_read_b128 v[112:115], v9 offset:4096
    ds_read_b128 v[116:119], v9 offset:5120
    ds_read_b128 v[120:123], v9 offset:6144
    ds_read_b128 v[124:127], v9 offset:7168
    s_waitcnt lgkmcnt(7)
    v_mfma_f32_16x16x32_bf16 v[160:163], a[0:3], v[96:99], 0
    v_mfma_f32_16x16x32_bf16 v[164:167], a[4:7], v[96:99], 0
    v_mfma_f32_16x16x32_bf16 v[168:171], a[8:11], v[96:99], 0
    v_mfma_f32_16x16x32_bf16 v[172:175], a[12:15], v[96:99], 0
    ds_read_b128 v[96:99], v9 offset:8192
    s_waitcnt lgkmcnt(7)
    v_mfma_f32_16x16x32_bf16 v[160:163], a[16:19], v[100:103], v[160:163]
    v_mfma_f32_16x16x32_bf16 v[164:167], a[20:23], v[100:103], v[164:167]
    v_mfma_f32_16x16x32_bf16 v[168:171], a[24:27], v[100:103], v[168:171]
    v_mfma_f32_16x16x32_bf16 v[172:175], a[28:31], v[100:103], v[172:175]
    ds_read_b128 v[100:103], v9 offset:9216
    s_waitcnt lgkmcnt(7)
    v_mfma_f32_16x16x32_bf16 v[160:163], a[32:35], v[104:107], v[160:163]
    v_mfma_f32_16x16x32_bf16 v[164:167], a[36:39], v[104:107], v[164:167]
    v_mfma_f32_16x16x32_bf16 v[168:171], a[40:43], v[104:107], v[168:171]
    v_mfma_f32_16x16x32_bf16 v[172:175], a[44:47], v[104:107], v[172:175]
    ds_read_b128 v[104:107], v9 offset:10240
    s_waitcnt lgkmcnt(7)
    v_mfma_f32_16x16x32_bf16 v[160:163], a[48:51], v[108:111], v[160:163]
    v_mfma_f32_16x16x32_bf16 v[164:167], a[52:55], v[108:111], v[164:167]
    v_mfma_f32_16x16x32_bf16 v[168:171], a[56:59], v[108:111], v[168:171]
    v_mfma_f32_16x16x32_bf16 v[172:175], a[60:63], v[108:111], v[172:175]
    ds_read_b128 v[108:111], v9 offset:11264
    s_waitcnt lgkmcnt(7)
    v_mfma_f32_16x16x32_bf16 v[160:163], a[64:67], v[112:115], v[160:163]
    v_mfma_f32_16x16x32_bf16 v[164:167], a[68:71], v[112:115], v[164:167]
    v_mfma_f32_16x16x32_bf16 v[168:171], a[72:75], v[112:115], v[168:171]
    v_mfma_f32_16x16x32_bf16 v[172:175], a[76:79], v[112:115], v[172:175]
    ds_read_b128 v[112:115], v9 offset:12288
    s_waitcnt lgkmcnt(7)
    v_mfma_f32_16x16x32_bf16 v[160:163], a[80:83], v[116:119], v[160:163]
    v_mfma_f32_16x16x32_bf16 v[164:167], a[84:87], v[116:119], v[164:167]
    v_mfma_f32_16x16x32_bf16 v[168:171], a[88:91], v[116:119], v[168:171]
    v_mfma_f32_16x16x32_bf16 v[172:175], a[92:95], v[116:119], v[172:175]
    ds_read_b128 v[116:119], v9 offset:13312
    s_waitcnt lgkmcnt(7)
    v_mfma_f32_16x16x32_bf16 v[160:163], a[96:99], v[120:123], v[160:163]
    v_mfma_f32_16x16x32_bf16 v[164:167], a[100:103], v[120:123], v[164:167]
    v_mfma_f32_16x16x32_bf16 v[168:171], a[104:107], v[120:123], v[168:171]
    v_mfma_f32_16x16x32_bf16 v[172:175], a[108:111], v[120:123], v[172:175]
    ds_read_b128 v[120:123], v9 offset:14336
    s_waitcnt lgkmcnt(7)
    v_mfma_f32_16x16x32_bf16 v[160:163], a[112:115], v[124:127], v[160:163]
    v_mfma_f32_16x16x32_bf16 v[164:167], a[116:119], v[124:127], v[164:167]
    v_mfma_f32_16x16x32_bf16 v[168:171], a[120:123], v[124:127], v[168:171]
    v_mfma_f32_16x16x32_bf16 v[172:175], a[124:127], v[124:127], v[172:175]
    ds_read_b128 v[124:127], v9 offset:15360
    s_waitcnt lgkmcnt(7)
    v_mfma_f32_16x16x32_bf16 v[160:163], a[128:131], v[96:99], v[160:163]
    v_mfma_f32_16x16x32_bf16 v[164:167], a[132:135], v[96:99], v[164:167]
    v_mfma_f32_16x16x32_bf16 v[168:171], a[136:139], v[96:99], v[168:171]
    v_mfma_f32_16x16x32_bf16 v[172:175], a[140:143], v[96:99], v[172:175]
    ds_read_b128 v[96:99], v9 offset:16384
    s_waitcnt lgkmcnt(7)
    v_mfma_f32_16x16x32_bf16 v[160:163], a[144:147], v[100:103], v[160:163]
    v_mfma_f32_16x16x32_bf16 v[164:167], a[148:151], v[100:103], v[164:167]
    v_mfma_f32_16x16x32_bf16 v[168:171], a[152:155], v[100:103], v[168:171]
    v_mfma_f32_16x16x32_bf16 v[172:175], a[156:159], v[100:103], v[172:175]
    ds_read_b128 v[100:103], v9 offset:17408
    s_waitcnt lgkmcnt(7)
    v_mfma_f32_16x16x32_bf16 v[160:163], a[160:163], v[104:107], v[160:163]
    v_mfma_f32_16x16x32_bf16 v[164:167], a[164:167], v[104:107], v[164:167]
    v_mfma_f32_16x16x32_bf16 v[168:171], a[168:171], v[104:107], v[168:171]
    v_mfma_f32_16x16x32_bf16 v[172:175], a[172:175], v[104:107], v[172:175]
    ds_read_b128 v[104:107], v9 offset:18432
    s_waitcnt lgkmcnt(7)
    v_mfma_f32_16x16x32_bf16 v[160:163], a[176:179], v[108:111], v[160:163]
    v_mfma_f32_16x16x32_bf16 v[164:167], a[180:183], v[108:111], v[164:167]
    v_mfma_f32_16x16x32_bf16 v[168:171], a[184:187], v[108:111], v[168:171]
    v_mfma_f32_16x16x32_bf16 v[172:175], a[188:191], v[108:111], v[172:175]
    ds_read_b128 v[108:111], v9 offset:19456
    s_waitcnt lgkmcnt(7)
    v_mfma_f32_16x16x32_bf16 v[160:163], a[192:195], v[112:115], v[160:163]
    v_mfma_f32_16x16x32_bf16 v[164:167], a[196:199], v[112:115], v[164:167]
    v_mfma_f32_16x16x32_bf16 v[168:171], a[200:203], v[112:115], v[168:171]
    v_mfma_f32_16x16x32_bf16 v[172:175], a[204:207], v[112:115], v[172:175]
    ds_read_b128 v[112:115], v9 offset:20480
    s_waitcnt lgkmcnt(7)
    v_mfma_f32_16x16x32_bf16 v[160:163], a[208:211], v[116:119], v[160:163]
    v_mfma_f32_16x16x32_bf16 v[164:167], a[212:215], v[116:119], v[164:167]
    v_mfma_f32_16x16x32_bf16 v[168:171], a[216:219], v[116:119], v[168:171]
    v_mfma_f32_16x16x32_bf16 v[172:175], a[220:223], v[116:119], v[172:175]
    ds_read_b128 v[116:119], v9 offset:21504
    s_waitcnt lgkmcnt(7)
    v_mfma_f32_16x16x32_bf16 v[160:163], a[224:227], v[120:123], v[160:163]
    v_mfma_f32_16x16x32_bf16 v[164:167], a[228:231], v[120:123], v[164:167]
    v_mfma_f32_16x16x32_bf16 v[168:171], a[232:235], v[120:123], v[168:171]
    v_mfma_f32_16x16x32_bf16 v[172:175], a[236:239], v[120:123], v[172:175]
    ds_read_b128 v[120:123], v9 offset:22528
    s_waitcnt lgkmcnt(7)
    v_mfma_f32_16x16x32_bf16 v[160:163], a[240:243], v[124:127], v[160:163]
    v_mfma_f32_16x16x32_bf16 v[164:167], a[244:247], v[124:127], v[164:167]
    v_mfma_f32_16x16x32_bf16 v[168:171], a[248:251], v[124:127], v[168:171]
    v_mfma_f32_16x16x32_bf16 v[172:175], a[252:255], v[124:127], v[172:175]
    ds_read_b128 v[124:127], v9 offset:23552
    s_waitcnt lgkmcnt(7)
    v_mfma_f32_16x16x32_bf16 v[160:163], v[192:195], v[96:99], v[160:163]
    v_mfma_f32_16x16x32_bf16 v[164:167], v[196:199], v[96:99], v[164:167]
    v_mfma_f32_16x16x32_bf16 v[168:171], v[200:203], v[96:99], v[168:171]
    v_mfma_f32_16x16x32_bf16 v[172:175], v[204:207], v[96:99], v[172:175]
    ds_read_b128 v[96:99], v9 offset:24576
    s_waitcnt lgkmcnt(7)
    v_mfma_f32_16x16x32_bf16 v[160:163], v[208:211], v[100:103], v[160:163]
    v_mfma_f32_16x16x32_bf16 v[164:167], v[212:215], v[100:103], v[164:167]
    v_mfma_f32_16x16x32_bf16 v[168:171], v[216:219], v[100:103], v[168:171]
    v_mfma_f32_16x16x32_bf16 v[172:175], v[220:223], v[100:103], v[172:175]
    ds_read_b128 v[100:103], v9 offset:25600
    s_waitcnt lgkmcnt(7)
    v_mfma_f32_16x16x32_bf16 v[160:163], v[224:227], v[104:107], v[160:163]
    v_mfma_f32_16x16x32_bf16 v[164:167], v[228:231], v[104:107], v[164:167]
    v_mfma_f32_16x16x32_bf16 v[168:171], v[232:235], v[104:107], v[168:171]
    v_mfma_f32_16x16x32_bf16 v[172:175], v[236:239], v[104:107], v[172:175]
    ds_read_b128 v[104:107], v9 offset:26624
    s_waitcnt lgkmcnt(7)
    v_mfma_f32_16x16x32_bf16 v[160:163], v[240:243], v[108:111], v[160:163]
    v_mfma_f32_16x16x32_bf16 v[164:167], v[244:247], v[108:111], v[164:167]
    v_mfma_f32_16x16x32_bf16 v[168:171], v[248:251], v[108:111], v[168:171]
    v_mfma_f32_16x16x32_bf16 v[172:175], v[252:255], v[108:111], v[172:175]
    ds_read_b128 v[108:111], v9 offset:27648
    s_waitcnt lgkmcnt(7)
    v_mfma_f32_16x16x32_bf16 v[176:179], a[0:3], v[112:115], 0
    v_mfma_f32_16x16x32_bf16 v[180:183], a[4:7], v[112:115], 0
    v_mfma_f32_16x16x32_bf16 v[184:187], a[8:11], v[112:115], 0
    v_mfma_f32_16x16x32_bf16 v[188:191], a[12:15], v[112:115], 0
    ds_read_b128 v[112:115], v9 offset:28672
    s_waitcnt lgkmcnt(7)
    v_mfma_f32_16x16x32_bf16 v[176:179], a[16:19], v[116:119], v[176:179]
    v_mfma_f32_16x16x32_bf16 v[180:183], a[20:23], v[116:119], v[180:183]
    v_mfma_f32_16x16x32_bf16 v[184:187], a[24:27], v[116:119], v[184:187]
    v_mfma_f32_16x16x32_bf16 v[188:191], a[28:31], v[116:119], v[188:191]
    ds_read_b128 v[116:119], v9 offset:29696
    s_waitcnt lgkmcnt(7)
    v_mfma_f32_16x16x32_bf16 v[176:179], a[32:35], v[120:123], v[176:179]
    v_mfma_f32_16x16x32_bf16 v[180:183], a[36:39], v[120:123], v[180:183]
    v_mfma_f32_16x16x32_bf16 v[184:187], a[40:43], v[120:123], v[184:187]
    v_mfma_f32_16x16x32_bf16 v[188:191], a[44:47], v[120:123], v[188:191]
    ds_read_b128 v[120:123], v9 offset:30720
    s_waitcnt lgkmcnt(7)
    v_mfma_f32_16x16x32_bf16 v[176:179], a[48:51], v[124:127], v[176:179]
    v_mfma_f32_16x16x32_bf16 v[180:183], a[52:55], v[124:127], v[180:183]
    v_mfma_f32_16x16x32_bf16 v[184:187], a[56:59], v[124:127], v[184:187]
    v_mfma_f32_16x16x32_bf16 v[188:191], a[60:63], v[124:127], v[188:191]
    ds_read_b128 v[124:127], v9 offset:31744
    s_waitcnt lgkmcnt(7)
    v_mfma_f32_16x16x32_bf16 v[176:179], a[64:67], v[96:99], v[176:179]
    v_mfma_f32_16x16x32_bf16 v[180:183], a[68:71], v[96:99], v[180:183]
    v_mfma_f32_16x16x32_bf16 v[184:187], a[72:75], v[96:99], v[184:187]
    v_mfma_f32_16x16x32_bf16 v[188:191], a[76:79], v[96:99], v[188:191]
    ds_read_b128 v[96:99], v9 offset:32768
    s_waitcnt lgkmcnt(7)
    v_mfma_f32_16x16x32_bf16 v[176:179], a[80:83], v[100:103], v[176:179]
    v_mfma_f32_16x16x32_bf16 v[180:183], a[84:87], v[100:103], v[180:183]
    v_mfma_f32_16x16x32_bf16 v[184:187], a[88:91], v[100:103], v[184:187]
    v_mfma_f32_16x16x32_bf16 v[188:191], a[92:95], v[100:103], v[188:191]
    ds_read_b128 v[100:103], v9 offset:33792
    s_waitcnt lgkmcnt(7)
    v_mfma_f32_16x16x32_bf16 v[176:179], a[96:99], v[104:107], v[176:179]
    v_mfma_f32_16x16x32_bf16 v[180:183], a[100:103], v[104:107], v[180:183]
    v_mfma_f32_16x16x32_bf16 v[184:187], a[104:107], v[104:107], v[184:187]
    v_mfma_f32_16x16x32_bf16 v[188:191], a[108:111], v[104:107], v[188:191]
    ds_read_b128 v[104:107], v9 offset:34816
    s_waitcnt lgkmcnt(7)
    v_mfma_f32_16x16x32_bf16 v[176:179], a[112:115], v[108:111], v[176:179]
    v_mfma_f32_16x16x32_bf16 v[180:183], a[116:119], v[108:111], v[180:183]
    v_mfma_f32_16x16x32_bf16 v[184:187], a[120:123], v[108:111], v[184:187]
    v_mfma_f32_16x16x32_bf16 v[188:191], a[124:127], v[108:111], v[188:191]
    ds_read_b128 v[108:111], v9 offset:35840
    s_waitcnt lgkmcnt(7)
    v_mfma_f32_16x16x32_bf16 v[176:179], a[128:131], v[112:115], v[176:179]
    v_mfma_f32_16x16x32_bf16 v[180:183], a[132:135], v[112:115], v[180:183]
    v_mfma_f32_16x16x32_bf16 v[184:187], a[136:139], v[112:115], v[184:187]
    v_mfma_f32_16x16x32_bf16 v[188:191], a[140:143], v[112:115], v[188:191]
    ds_read_b128 v[112:115], v9 offset:36864
    s_waitcnt lgkmcnt(7)
    v_mfma_f32_16x16x32_bf16 v[176:179], a[144:147], v[116:119], v[176:179]
    v_mfma_f32_16x16x32_bf16 v[180:183], a[148:151], v[116:119], v[180:183]
    v_mfma_f32_16x16x32_bf16 v[184:187], a[152:155], v[116:119], v[184:187]
    v_mfma_f32_16x16x32_bf16 v[188:191], a[156:159], v[116:119], v[188:191]
    ds_read_b128 v[116:119], v9 offset:37888
    s_waitcnt lgkmcnt(7)
    v_mfma_f32_16x16x32_bf16 v[176:179], a[160:163], v[120:123], v[176:179]
    v_mfma_f32_16x16x32_bf16 v[180:183], a[164:167], v[120:123], v[180:183]
    v_mfma_f32_16x16x32_bf16 v[184:187], a[168:171], v[120:123], v[184:187]
    v_mfma_f32_16x16x32_bf16 v[188:191], a[172:175], v[120:123], v[188:191]
    ds_read_b128 v[120:123], v9 offset:38912
    s_waitcnt lgkmcnt(7)
    v_mfma_f32_16x16x32_bf16 v[176:179], a[176:179], v[124:127], v[176:179]
    v_mfma_f32_16x16x32_bf16 v[180:183], a[180:183], v[124:127], v[180:183]
    v_mfma_f32_16x16x32_bf16 v[184:187], a[184:187], v[124:127], v[184:187]
    v_mfma_f32_16x16x32_bf16 v[188:191], a[188:191], v[124:127], v[188:191]
    ds_read_b128 v[124:127], v9 offset:39936
    s_waitcnt lgkmcnt(7)
    v_mfma_f32_16x16x32_bf16 v[176:179], a[192:195], v[96:99], v[176:179]
    v_mfma_f32_16x16x32_bf16 v[180:183], a[196:199], v[96:99], v[180:183]
    v_mfma_f32_16x16x32_bf16 v[184:187], a[200:203], v[96:99], v[184:187]
    v_mfma_f32_16x16x32_bf16 v[188:191], a[204:207], v[96:99], v[188:191]
    s_waitcnt lgkmcnt(6)
    v_mfma_f32_16x16x32_bf16 v[176:179], a[208:211], v[100:103], v[176:179]
    v_mfma_f32_16x16x32_bf16 v[180:183], a[212:215], v[100:103], v[180:183]
    v_mfma_f32_16x16x32_bf16 v[184:187], a[216:219], v[100:103], v[184:187]
    v_mfma_f32_16x16x32_bf16 v[188:191], a[220:223], v[100:103], v[188:191]
    s_waitcnt lgkmcnt(5)
    v_mfma_f32_16x16x32_bf16 v[176:179], a[224:227], v[104:107], v[176:179]
    v_mfma_f32_16x16x32_bf16 v[180:183], a[228:231], v[104:107], v[180:183]
    v_mfma_f32_16x16x32_bf16 v[184:187], a[232:235], v[104:107], v[184:187]
    v_mfma_f32_16x16x32_bf16 v[188:191], a[236:239], v[104:107], v[188:191]
    s_waitcnt lgkmcnt(4)
    v_mfma_f32_16x16x32_bf16 v[176:179], a[240:243], v[108:111], v[176:179]
    v_mfma_f32_16x16x32_bf16 v[180:183], a[244:247], v[108:111], v[180:183]
    v_mfma_f32_16x16x32_bf16 v[184:187], a[248:251], v[108:111], v[184:187]
    v_mfma_f32_16x16x32_bf16 v[188:191], a[252:255], v[108:111], v[188:191]
    s_waitcnt lgkmcnt(3)
    v_mfma_f32_16x16x32_bf16 v[176:179], v[192:195], v[112:115], v[176:179]
    v_mfma_f32_16x16x32_bf16 v[180:183], v[196:199], v[112:115], v[180:183]
    v_mfma_f32_16x16x32_bf16 v[184:187], v[200:203], v[112:115], v[184:187]
    v_mfma_f32_16x16x32_bf16 v[188:191], v[204:207], v[112:115], v[188:191]
    s_waitcnt lgkmcnt(2)
    v_mfma_f32_16x16x32_bf16 v[176:179], v[208:211], v[116:119], v[176:179]
    v_mfma_f32_16x16x32_bf16 v[180:183], v[212:215], v[116:119], v[180:183]
    v_mfma_f32_16x16x32_bf16 v[184:187], v[216:219], v[116:119], v[184:187]
    v_mfma_f32_16x16x32_bf16 v[188:191], v[220:223], v[116:119], v[188:191]
    s_waitcnt lgkmcnt(1)
    v_mfma_f32_16x16x32_bf16 v[176:179], v[224:227], v[120:123], v[176:179]
    v_mfma_f32_16x16x32_bf16 v[180:183], v[228:231], v[120:123], v[180:183]
    v_mfma_f32_16x16x32_bf16 v[184:187], v[232:235], v[120:123], v[184:187]
    v_mfma_f32_16x16x32_bf16 v[188:191], v[236:239], v[120:123], v[188:191]
    s_waitcnt lgkmcnt(0)
    v_mfma_f32_16x16x32_bf16 v[176:179], v[240:243], v[124:127], v[176:179]
    v_mfma_f32_16x16x32_bf16 v[180:183], v[244:247], v[124:127], v[180:183]
    v_mfma_f32_16x16x32_bf16 v[184:187], v[248:251], v[124:127], v[184:187]
    v_mfma_f32_16x16x32_bf16 v[188:191], v[252:255], v[124:127], v[188:191]
    v_cvt_pk_bf16_f32 v128, v160, v164
    v_cvt_pk_bf16_f32 v129, v168, v172
    v_cvt_pk_bf16_f32 v130, v161, v165
    v_cvt_pk_bf16_f32 v131, v169, v173
    buffer_store_dwordx4 v[128:131], v6, s[12:15], s38 offen offset:0 sc1
    v_cvt_pk_bf16_f32 v132, v162, v166
    v_cvt_pk_bf16_f32 v133, v170, v174
    v_cvt_pk_bf16_f32 v134, v163, v167
    v_cvt_pk_bf16_f32 v135, v171, v175
    buffer_store_dwordx4 v[132:135], v6, s[12:15], s38 offen offset:256 sc1
    v_cvt_pk_bf16_f32 v136, v176, v180
    v_cvt_pk_bf16_f32 v137, v184, v188
    v_cvt_pk_bf16_f32 v138, v177, v181
    v_cvt_pk_bf16_f32 v139, v185, v189
    s_add_u32 s46, s38, 4096
    buffer_store_dwordx4 v[136:139], v6, s[12:15], s46 offen offset:0 sc1
    v_cvt_pk_bf16_f32 v140, v178, v182
    v_cvt_pk_bf16_f32 v141, v186, v190
    v_cvt_pk_bf16_f32 v142, v179, v183
    v_cvt_pk_bf16_f32 v143, v187, v191
    buffer_store_dwordx4 v[140:143], v6, s[12:15], s46 offen offset:256 sc1
    s_branch L_mq_next
L_mq_v:
    buffer_store_dwordx4 v[12:15], v8, s[12:15], s52 offen sc1
    s_add_u32 s52, s52, 262144
    ds_read_b128 v[96:99], v9 offset:0
    ds_read_b128 v[100:103], v9 offset:1024
    ds_read_b128 v[104:107], v9 offset:2048
    ds_read_b128 v[108:111], v9 offset:3072
    ds_read_b128 v[112:115], v9 offset:4096
    ds_read_b128 v[116:119], v9 offset:5120
    ds_read_b128 v[120:123], v9 offset:6144
    ds_read_b128 v[124:127], v9 offset:7168
    s_waitcnt lgkmcnt(7)
    v_mfma_f32_16x16x32_bf16 v[160:163], v[96:99], a[0:3], 0
    v_mfma_f32_16x16x32_bf16 v[164:167], v[96:99], a[4:7], 0
    v_mfma_f32_16x16x32_bf16 v[168:171], v[96:99], a[8:11], 0
    v_mfma_f32_16x16x32_bf16 v[172:175], v[96:99], a[12:15], 0
    ds_read_b128 v[96:99], v9 offset:8192
    s_waitcnt lgkmcnt(7)
    v_mfma_f32_16x16x32_bf16 v[160:163], v[100:103], a[16:19], v[160:163]
    v_mfma_f32_16x16x32_bf16 v[164:167], v[100:103], a[20:23], v[164:167]
    v_mfma_f32_16x16x32_bf16 v[168:171], v[100:103], a[24:27], v[168:171]
    v_mfma_f32_16x16x32_bf16 v[172:175], v[100:103], a[28:31], v[172:175]
    ds_read_b128 v[100:103], v9 offset:9216
    s_waitcnt lgkmcnt(7)
    v_mfma_f32_16x16x32_bf16 v[160:163], v[104:107], a[32:35], v[160:163]
    v_mfma_f32_16x16x32_bf16 v[164:167], v[104:107], a[36:39], v[164:167]
    v_mfma_f32_16x16x32_bf16 v[168:171], v[104:107], a[40:43], v[168:171]
    v_mfma_f32_16x16x32_bf16 v[172:175], v[104:107], a[44:47], v[172:175]
    ds_read_b128 v[104:107], v9 offset:10240
    s_waitcnt lgkmcnt(7)
    v_mfma_f32_16x16x32_bf16 v[160:163], v[108:111], a[48:51], v[160:163]
    v_mfma_f32_16x16x32_bf16 v[164:167], v[108:111], a[52:55], v[164:167]
    v_mfma_f32_16x16x32_bf16 v[168:171], v[108:111], a[56:59], v[168:171]
    v_mfma_f32_16x16x32_bf16 v[172:175], v[108:111], a[60:63], v[172:175]
    ds_read_b128 v[108:111], v9 offset:11264
    s_waitcnt lgkmcnt(7)
    v_mfma_f32_16x16x32_bf16 v[160:163], v[112:115], a[64:67], v[160:163]
    v_mfma_f32_16x16x32_bf16 v[164:167], v[112:115], a[68:71], v[164:167]
    v_mfma_f32_16x16x32_bf16 v[168:171], v[112:115], a[72:75], v[168:171]
    v_mfma_f32_16x16x32_bf16 v[172:175], v[112:115], a[76:79], v[172:175]
    ds_read_b128 v[112:115], v9 offset:12288
    s_waitcnt lgkmcnt(7)
    v_mfma_f32_16x16x32_bf16 v[160:163], v[116:119], a[80:83], v[160:163]
    v_mfma_f32_16x16x32_bf16 v[164:167], v[116:119], a[84:87], v[164:167]
    v_mfma_f32_16x16x32_bf16 v[168:171], v[116:119], a[88:91], v[168:171]
    v_mfma_f32_16x16x32_bf16 v[172:175], v[116:119], a[92:95], v[172:175]
    ds_read_b128 v[116:119], v9 offset:13312
    s_waitcnt lgkmcnt(7)
    v_mfma_f32_16x16x32_bf16 v[160:163], v[120:123], a[96:99], v[160:163]
    v_mfma_f32_16x16x32_bf16 v[164:167], v[120:123], a[100:103], v[164:167]
    v_mfma_f32_16x16x32_bf16 v[168:171], v[120:123], a[104:107], v[168:171]
    v_mfma_f32_16x16x32_bf16 v[172:175], v[120:123], a[108:111], v[172:175]
    ds_read_b128 v[120:123], v9 offset:14336
    s_waitcnt lgkmcnt(7)
    v_mfma_f32_16x16x32_bf16 v[160:163], v[124:127], a[112:115], v[160:163]
    v_mfma_f32_16x16x32_bf16 v[164:167], v[124:127], a[116:119], v[164:167]
    v_mfma_f32_16x16x32_bf16 v[168:171], v[124:127], a[120:123], v[168:171]
    v_mfma_f32_16x16x32_bf16 v[172:175], v[124:127], a[124:127], v[172:175]
    ds_read_b128 v[124:127], v9 offset:15360
    s_waitcnt lgkmcnt(7)
    v_mfma_f32_16x16x32_bf16 v[160:163], v[96:99], a[128:131], v[160:163]
    v_mfma_f32_16x16x32_bf16 v[164:167], v[96:99], a[132:135], v[164:167]
    v_mfma_f32_16x16x32_bf16 v[168:171], v[96:99], a[136:139], v[168:171]
    v_mfma_f32_16x16x32_bf16 v[172:175], v[96:99], a[140:143], v[172:175]
    ds_read_b128 v[96:99], v9 offset:16384
    s_waitcnt lgkmcnt(7)
    v_mfma_f32_16x16x32_bf16 v[160:163], v[100:103], a[144:147], v[160:163]
    v_mfma_f32_16x16x32_bf16 v[164:167], v[100:103], a[148:151], v[164:167]
    v_mfma_f32_16x16x32_bf16 v[168:171], v[100:103], a[152:155], v[168:171]
    v_mfma_f32_16x16x32_bf16 v[172:175], v[100:103], a[156:159], v[172:175]
    ds_read_b128 v[100:103], v9 offset:17408
    s_waitcnt lgkmcnt(7)
    v_mfma_f32_16x16x32_bf16 v[160:163], v[104:107], a[160:163], v[160:163]
    v_mfma_f32_16x16x32_bf16 v[164:167], v[104:107], a[164:167], v[164:167]
    v_mfma_f32_16x16x32_bf16 v[168:171], v[104:107], a[168:171], v[168:171]
    v_mfma_f32_16x16x32_bf16 v[172:175], v[104:107], a[172:175], v[172:175]
    ds_read_b128 v[104:107], v9 offset:18432
    s_waitcnt lgkmcnt(7)
    v_mfma_f32_16x16x32_bf16 v[160:163], v[108:111], a[176:179], v[160:163]
    v_mfma_f32_16x16x32_bf16 v[164:167], v[108:111], a[180:183], v[164:167]
    v_mfma_f32_16x16x32_bf16 v[168:171], v[108:111], a[184:187], v[168:171]
    v_mfma_f32_16x16x32_bf16 v[172:175], v[108:111], a[188:191], v[172:175]
    ds_read_b128 v[108:111], v9 offset:19456
    s_waitcnt lgkmcnt(7)
    v_mfma_f32_16x16x32_bf16 v[160:163], v[112:115], a[192:195], v[160:163]
    v_mfma_f32_16x16x32_bf16 v[164:167], v[112:115], a[196:199], v[164:167]
    v_mfma_f32_16x16x32_bf16 v[168:171], v[112:115], a[200:203], v[168:171]
    v_mfma_f32_16x16x32_bf16 v[172:175], v[112:115], a[204:207], v[172:175]
    ds_read_b128 v[112:115], v9 offset:20480
    s_waitcnt lgkmcnt(7)
    v_mfma_f32_16x16x32_bf16 v[160:163], v[116:119], a[208:211], v[160:163]
    v_mfma_f32_16x16x32_bf16 v[164:167], v[116:119], a[212:215], v[164:167]
    v_mfma_f32_16x16x32_bf16 v[168:171], v[116:119], a[216:219], v[168:171]
    v_mfma_f32_16x16x32_bf16 v[172:175], v[116:119], a[220:223], v[172:175]
    ds_read_b128 v[116:119], v9 offset:21504
    s_waitcnt lgkmcnt(7)
    v_mfma_f32_16x16x32_bf16 v[160:163], v[120:123], a[224:227], v[160:163]
    v_mfma_f32_16x16x32_bf16 v[164:167], v[120:123], a[228:231], v[164:167]
    v_mfma_f32_16x16x32_bf16 v[168:171], v[120:123], a[232:235], v[168:171]
    v_mfma_f32_16x16x32_bf16 v[172:175], v[120:123], a[236:239], v[172:175]
    ds_read_b128 v[120:123], v9 offset:22528
    s_waitcnt lgkmcnt(7)
    v_mfma_f32_16x16x32_bf16 v[160:163], v[124:127], a[240:243], v[160:163]
    v_mfma_f32_16x16x32_bf16 v[164:167], v[124:127], a[244:247], v[164:167]
    v_mfma_f32_16x16x32_bf16 v[168:171], v[124:127], a[248:251], v[168:171]
    v_mfma_f32_16x16x32_bf16 v[172:175], v[124:127], a[252:255], v[172:175]
    ds_read_b128 v[124:127], v9 offset:23552
    s_waitcnt lgkmcnt(7)
    v_mfma_f32_16x16x32_bf16 v[160:163], v[96:99], v[192:195], v[160:163]
    v_mfma_f32_16x16x32_bf16 v[164:167], v[96:99], v[196:199], v[164:167]
    v_mfma_f32_16x16x32_bf16 v[168:171], v[96:99], v[200:203], v[168:171]
    v_mfma_f32_16x16x32_bf16 v[172:175], v[96:99], v[204:207], v[172:175]
    ds_read_b128 v[96:99], v9 offset:24576
    s_waitcnt lgkmcnt(7)
    v_mfma_f32_16x16x32_bf16 v[160:163], v[100:103], v[208:211], v[160:163]
    v_mfma_f32_16x16x32_bf16 v[164:167], v[100:103], v[212:215], v[164:167]
    v_mfma_f32_16x16x32_bf16 v[168:171], v[100:103], v[216:219], v[168:171]
    v_mfma_f32_16x16x32_bf16 v[172:175], v[100:103], v[220:223], v[172:175]
    ds_read_b128 v[100:103], v9 offset:25600
    s_waitcnt lgkmcnt(7)
    v_mfma_f32_16x16x32_bf16 v[160:163], v[104:107], v[224:227], v[160:163]
    v_mfma_f32_16x16x32_bf16 v[164:167], v[104:107], v[228:231], v[164:167]
    v_mfma_f32_16x16x32_bf16 v[168:171], v[104:107], v[232:235], v[168:171]
    v_mfma_f32_16x16x32_bf16 v[172:175], v[104:107], v[236:239], v[172:175]
    ds_read_b128 v[104:107], v9 offset:26624
    s_waitcnt lgkmcnt(7)
    v_mfma_f32_16x16x32_bf16 v[160:163], v[108:111], v[240:243], v[160:163]
    v_mfma_f32_16x16x32_bf16 v[164:167], v[108:111], v[244:247], v[164:167]
    v_mfma_f32_16x16x32_bf16 v[168:171], v[108:111], v[248:251], v[168:171]
    v_mfma_f32_16x16x32_bf16 v[172:175], v[108:111], v[252:255], v[172:175]
    ds_read_b128 v[108:111], v9 offset:27648
    s_waitcnt lgkmcnt(7)
    v_mfma_f32_16x16x32_bf16 v[176:179], v[112:115], a[0:3], 0
    v_mfma_f32_16x16x32_bf16 v[180:183], v[112:115], a[4:7], 0
    v_mfma_f32_16x16x32_bf16 v[184:187], v[112:115], a[8:11], 0
    v_mfma_f32_16x16x32_bf16 v[188:191], v[112:115], a[12:15], 0
    ds_read_b128 v[112:115], v9 offset:28672
    s_waitcnt lgkmcnt(7)
    v_mfma_f32_16x16x32_bf16 v[176:179], v[116:119], a[16:19], v[176:179]
    v_mfma_f32_16x16x32_bf16 v[180:183], v[116:119], a[20:23], v[180:183]
    v_mfma_f32_16x16x32_bf16 v[184:187], v[116:119], a[24:27], v[184:187]
    v_mfma_f32_16x16x32_bf16 v[188:191], v[116:119], a[28:31], v[188:191]
    ds_read_b128 v[116:119], v9 offset:29696
    s_waitcnt lgkmcnt(7)
    v_mfma_f32_16x16x32_bf16 v[176:179], v[120:123], a[32:35], v[176:179]
    v_mfma_f32_16x16x32_bf16 v[180:183], v[120:123], a[36:39], v[180:183]
    v_mfma_f32_16x16x32_bf16 v[184:187], v[120:123], a[40:43], v[184:187]
    v_mfma_f32_16x16x32_bf16 v[188:191], v[120:123], a[44:47], v[188:191]
    ds_read_b128 v[120:123], v9 offset:30720
    s_waitcnt lgkmcnt(7)
    v_mfma_f32_16x16x32_bf16 v[176:179], v[124:127], a[48:51], v[176:179]
    v_mfma_f32_16x16x32_bf16 v[180:183], v[124:127], a[52:55], v[180:183]
    v_mfma_f32_16x16x32_bf16 v[184:187], v[124:127], a[56:59], v[184:187]
    v_mfma_f32_16x16x32_bf16 v[188:191], v[124:127], a[60:63], v[188:191]
    ds_read_b128 v[124:127], v9 offset:31744
    s_waitcnt lgkmcnt(7)
    v_mfma_f32_16x16x32_bf16 v[176:179], v[96:99], a[64:67], v[176:179]
    v_mfma_f32_16x16x32_bf16 v[180:183], v[96:99], a[68:71], v[180:183]
    v_mfma_f32_16x16x32_bf16 v[184:187], v[96:99], a[72:75], v[184:187]
    v_mfma_f32_16x16x32_bf16 v[188:191], v[96:99], a[76:79], v[188:191]
    ds_read_b128 v[96:99], v9 offset:32768
    s_waitcnt lgkmcnt(7)
    v_mfma_f32_16x16x32_bf16 v[176:179], v[100:103], a[80:83], v[176:179]
    v_mfma_f32_16x16x32_bf16 v[180:183], v[100:103], a[84:87], v[180:183]
    v_mfma_f32_16x16x32_bf16 v[184:187], v[100:103], a[88:91], v[184:187]
    v_mfma_f32_16x16x32_bf16 v[188:191], v[100:103], a[92:95], v[188:191]
    ds_read_b128 v[100:103], v9 offset:33792
    s_waitcnt lgkmcnt(7)
    v_mfma_f32_16x16x32_bf16 v[176:179], v[104:107], a[96:99], v[176:179]
    v_mfma_f32_16x16x32_bf16 v[180:183], v[104:107], a[100:103], v[180:183]
    v_mfma_f32_16x16x32_bf16 v[184:187], v[104:107], a[104:107], v[184:187]
    v_mfma_f32_16x16x32_bf16 v[188:191], v[104:107], a[108:111], v[188:191]
    ds_read_b128 v[104:107], v9 offset:34816
    s_waitcnt lgkmcnt(7)
    v_mfma_f32_16x16x32_bf16 v[176:179], v[108:111], a[112:115], v[176:179]
    v_mfma_f32_16x16x32_bf16 v[180:183], v[108:111], a[116:119], v[180:183]
    v_mfma_f32_16x16x32_bf16 v[184:187], v[108:111], a[120:123], v[184:187]
    v_mfma_f32_16x16x32_bf16 v[188:191], v[108:111], a[124:127], v[188:191]
    ds_read_b128 v[108:111], v9 offset:35840
    s_waitcnt lgkmcnt(7)
    v_mfma_f32_16x16x32_bf16 v[176:179], v[112:115], a[128:131], v[176:179]
    v_mfma_f32_16x16x32_bf16 v[180:183], v[112:115], a[132:135], v[180:183]
    v_mfma_f32_16x16x32_bf16 v[184:187], v[112:115], a[136:139], v[184:187]
    v_mfma_f32_16x16x32_bf16 v[188:191], v[112:115], a[140:143], v[188:191]
    ds_read_b128 v[112:115], v9 offset:36864
    s_waitcnt lgkmcnt(7)
    v_mfma_f32_16x16x32_bf16 v[176:179], v[116:119], a[144:147], v[176:179]
    v_mfma_f32_16x16x32_bf16 v[180:183], v[116:119], a[148:151], v[180:183]
    v_mfma_f32_16x16x32_bf16 v[184:187], v[116:119], a[152:155], v[184:187]
    v_mfma_f32_16x16x32_bf16 v[188:191], v[116:119], a[156:159], v[188:191]
    ds_read_b128 v[116:119], v9 offset:37888
    s_waitcnt lgkmcnt(7)
    v_mfma_f32_16x16x32_bf16 v[176:179], v[120:123], a[160:163], v[176:179]
    v_mfma_f32_16x16x32_bf16 v[180:183], v[120:123], a[164:167], v[180:183]
    v_mfma_f32_16x16x32_bf16 v[184:187], v[120:123], a[168:171], v[184:187]
    v_mfma_f32_16x16x32_bf16 v[188:191], v[120:123], a[172:175], v[188:191]
    ds_read_b128 v[120:123], v9 offset:38912
    s_waitcnt lgkmcnt(7)
    v_mfma_f32_16x16x32_bf16 v[176:179], v[124:127], a[176:179], v[176:179]
    v_mfma_f32_16x16x32_bf16 v[180:183], v[124:127], a[180:183], v[180:183]
    v_mfma_f32_16x16x32_bf16 v[184:187], v[124:127], a[184:187], v[184:187]
    v_mfma_f32_16x16x32_bf16 v[188:191], v[124:127], a[188:191], v[188:191]
    ds_read_b128 v[124:127], v9 offset:39936
    s_waitcnt lgkmcnt(7)
    v_mfma_f32_16x16x32_bf16 v[176:179], v[96:99], a[192:195], v[176:179]
    v_mfma_f32_16x16x32_bf16 v[180:183], v[96:99], a[196:199], v[180:183]
    v_mfma_f32_16x16x32_bf16 v[184:187], v[96:99], a[200:203], v[184:187]
    v_mfma_f32_16x16x32_bf16 v[188:191], v[96:99], a[204:207], v[188:191]
    s_waitcnt lgkmcnt(6)
    v_mfma_f32_16x16x32_bf16 v[176:179], v[100:103], a[208:211], v[176:179]
    v_mfma_f32_16x16x32_bf16 v[180:183], v[100:103], a[212:215], v[180:183]
    v_mfma_f32_16x16x32_bf16 v[184:187], v[100:103], a[216:219], v[184:187]
    v_mfma_f32_16x16x32_bf16 v[188:191], v[100:103], a[220:223], v[188:191]
    s_waitcnt lgkmcnt(5)
    v_mfma_f32_16x16x32_bf16 v[176:179], v[104:107], a[224:227], v[176:179]
    v_mfma_f32_16x16x32_bf16 v[180:183], v[104:107], a[228:231], v[180:183]
    v_mfma_f32_16x16x32_bf16 v[184:187], v[104:107], a[232:235], v[184:187]
    v_mfma_f32_16x16x32_bf16 v[188:191], v[104:107], a[236:239], v[188:191]
    s_waitcnt lgkmcnt(4)
    v_mfma_f32_16x16x32_bf16 v[176:179], v[108:111], a[240:243], v[176:179]
    v_mfma_f32_16x16x32_bf16 v[180:183], v[108:111], a[244:247], v[180:183]
    v_mfma_f32_16x16x32_bf16 v[184:187], v[108:111], a[248:251], v[184:187]
    v_mfma_f32_16x16x32_bf16 v[188:191], v[108:111], a[252:255], v[188:191]
    s_waitcnt lgkmcnt(3)
    v_mfma_f32_16x16x32_bf16 v[176:179], v[112:115], v[192:195], v[176:179]
    v_mfma_f32_16x16x32_bf16 v[180:183], v[112:115], v[196:199], v[180:183]
    v_mfma_f32_16x16x32_bf16 v[184:187], v[112:115], v[200:203], v[184:187]
    v_mfma_f32_16x16x32_bf16 v[188:191], v[112:115], v[204:207], v[188:191]
    s_waitcnt lgkmcnt(2)
    v_mfma_f32_16x16x32_bf16 v[176:179], v[116:119], v[208:211], v[176:179]
    v_mfma_f32_16x16x32_bf16 v[180:183], v[116:119], v[212:215], v[180:183]
    v_mfma_f32_16x16x32_bf16 v[184:187], v[116:119], v[216:219], v[184:187]
    v_mfma_f32_16x16x32_bf16 v[188:191], v[116:119], v[220:223], v[188:191]
    s_waitcnt lgkmcnt(1)
    v_mfma_f32_16x16x32_bf16 v[176:179], v[120:123], v[224:227], v[176:179]
    v_mfma_f32_16x16x32_bf16 v[180:183], v[120:123], v[228:231], v[180:183]
    v_mfma_f32_16x16x32_bf16 v[184:187], v[120:123], v[232:235], v[184:187]
    v_mfma_f32_16x16x32_bf16 v[188:191], v[120:123], v[236:239], v[188:191]
    s_waitcnt lgkmcnt(0)
    v_mfma_f32_16x16x32_bf16 v[176:179], v[124:127], v[240:243], v[176:179]
    v_mfma_f32_16x16x32_bf16 v[180:183], v[124:127], v[244:247], v[180:183]
    v_mfma_f32_16x16x32_bf16 v[184:187], v[124:127], v[248:251], v[184:187]
    v_mfma_f32_16x16x32_bf16 v[188:191], v[124:127], v[252:255], v[188:191]
    v_cvt_pk_bf16_f32 v128, v160, v161
    v_cvt_pk_bf16_f32 v129, v162, v163
    v_cvt_pk_bf16_f32 v130, v176, v177
    v_cvt_pk_bf16_f32 v131, v178, v179
    buffer_store_dwordx4 v[128:131], v7, s[12:15], s38 offen offset:0 sc1
    v_cvt_pk_bf16_f32 v132, v164, v165
    v_cvt_pk_bf16_f32 v133, v166, v167
    v_cvt_pk_bf16_f32 v134, v180, v181
    v_cvt_pk_bf16_f32 v135, v182, v183
    buffer_store_dwordx4 v[132:135], v7, s[12:15], s38 offen offset:1024 sc1
    v_cvt_pk_bf16_f32 v136, v168, v169
    v_cvt_pk_bf16_f32 v137, v170, v171
    v_cvt_pk_bf16_f32 v138, v184, v185
    v_cvt_pk_bf16_f32 v139, v186, v187
    buffer_store_dwordx4 v[136:139], v7, s[12:15], s38 offen offset:2048 sc1
    v_cvt_pk_bf16_f32 v140, v172, v173
    v_cvt_pk_bf16_f32 v141, v174, v175
    v_cvt_pk_bf16_f32 v142, v188, v189
    v_cvt_pk_bf16_f32 v143, v190, v191
    buffer_store_dwordx4 v[140:143], v7, s[12:15], s38 offen offset:3072 sc1
L_mq_next:
    s_add_u32 s38, s38, 1048576
    s_xor_b32 s44, s44, 40960
    s_add_u32 s33, s33, 1
    s_branch L_mq_loop
L_mq_end:
    s_cmp_eq_u32 s25, 0
    s_cbranch_scc0 L_wgw_41
    s_mov_b32 s40, 64
    s_mov_b32 s98, 0
    v_mov_b32 v14, 0
L_wait_42:
    buffer_load_dword v15, v14, s[84:87], s40 offen sc1
    s_waitcnt vmcnt(0)
    v_readfirstlane_b32 s99, v15
    s_cmp_ge_u32 s99, 128
    s_cbranch_scc1 L_ok_43
    s_sleep 6
    s_add_u32 s98, s98, 1
    s_cmp_lt_u32 s98, 1048576
    s_cbranch_scc1 L_wait_42
    s_branch L_mega_done
L_ok_43:
    s_mov_b32 s40, 128
    s_mov_b32 s98, 0
    v_mov_b32 v14, 0
L_wait_44:
    buffer_load_dword v15, v14, s[84:87], s40 offen sc1
    s_waitcnt vmcnt(0)
    v_readfirstlane_b32 s99, v15
    s_cmp_ge_u32 s99, 40
    s_cbranch_scc1 L_ok_45
    s_sleep 6
    s_add_u32 s98, s98, 1
    s_cmp_lt_u32 s98, 1048576
    s_cbranch_scc1 L_wait_44
    s_branch L_mega_done
L_ok_45:
L_wgw_41:
    s_barrier
    s_cmp_ge_u32 s2, 166
    s_cbranch_scc1 L_mega_xa
    s_cmp_lt_u32 s2, 30
    s_cbranch_scc1 L_mega_dn
    s_mov_b32 s21, 27
    s_sub_u32 s20, s2, 30
    s_cmp_lt_u32 s2, 44
    s_cbranch_scc1 L_mega_up2
    s_sub_u32 s20, s2, 44
    s_cmp_lt_u32 s2, 64
    s_cbranch_scc1 L_mega_wo2
    s_cmp_ge_u32 s2, 124
    s_cbranch_scc1 L_mega_up
    s_sub_u32 s24, s2, 64
    s_mov_b32 s20, 214748365
    s_mul_hi_u32 s21, s24, s20
    s_mul_i32 s20, s21, 20
    s_sub_u32 s20, s24, s20
L_mega_wo2:
    s_load_dwordx2 s[4:5], s[0:1], 40
    s_load_dwordx2 s[8:9], s[0:1], 0
    s_mov_b32 s22, s25
    s_waitcnt lgkmcnt(0)
    s_mov_b32 s6, 5242880
    s_mov_b32 s7, 0x00020000
    s_mov_b32 s10, 2621440
    s_mov_b32 s11, 0x00020000
    s_lshl_b32 s23, s22, 5
    v_and_b32 v4, 1, v3
    v_lshlrev_b32 v4, 5, v4
    v_lshrrev_b32 v5, 1, v3
    v_add_u32 v4, v4, v5
    s_mov_b32 s24, 1280
    v_mul_lo_u32 v4, v4, s24
    v_lshl_add_u32 v4, v2, 2, v4
    s_lshl_b32 s24, s20, 6
    v_add_u32 v4, s24, v4
    s_mul_i32 s32, s23, 40960
    s_mov_b32 s34, 0x05040100
    s_mov_b32 s35, 0x07060302
    buffer_load_dword v32, v4, s[4:7], s32 offen
    s_add_u32 s32, s32, 5120
    buffer_load_dword v33, v4, s[4:7], s32 offen
    s_add_u32 s32, s32, 5120
    buffer_load_dword v34, v4, s[4:7], s32 offen
    s_add_u32 s32, s32, 5120
    buffer_load_dword v35, v4, s[4:7], s32 offen
    s_add_u32 s32, s32, 5120
    buffer_load_dword v36, v4, s[4:7], s32 offen
    s_add_u32 s32, s32, 5120
    buffer_load_dword v37, v4, s[4:7], s32 offen
    s_add_u32 s32, s32, 5120
    buffer_load_dword v38, v4, s[4:7], s32 offen
    s_add_u32 s32, s32, 5120
    buffer_load_dword v39, v4, s[4:7], s32 offen
    s_sub_u32 s32, s32, 33280
    buffer_load_dword v40, v4, s[4:7], s32 offen
    s_add_u32 s32, s32, 5120
    buffer_load_dword v41, v4, s[4:7], s32 offen
    s_add_u32 s32, s32, 5120
    buffer_load_dword v42, v4, s[4:7], s32 offen
    s_add_u32 s32, s32, 5120
    buffer_load_dword v43, v4, s[4:7], s32 offen
    s_add_u32 s32, s32, 5120
    buffer_load_dword v44, v4, s[4:7], s32 offen
    s_add_u32 s32, s32, 5120
    buffer_load_dword v45, v4, s[4:7], s32 offen
    s_add_u32 s32, s32, 5120
    buffer_load_dword v46, v4, s[4:7], s32 offen
    s_add_u32 s32, s32, 5120
    buffer_load_dword v47, v4, s[4:7], s32 offen
    s_add_u32 s32, s32, 43520
    buffer_load_dword v48, v4, s[4:7], s32 offen
    s_add_u32 s32, s32, 5120
    buffer_load_dword v49, v4, s[4:7], s32 offen
    s_add_u32 s32, s32, 5120
    buffer_load_dword v50, v4, s[4:7], s32 offen
    s_add_u32 s32, s32, 5120
    buffer_load_dword v51, v4, s[4:7], s32 offen
    s_add_u32 s32, s32, 5120
    buffer_load_dword v52, v4, s[4:7], s32 offen
    s_add_u32 s32, s32, 5120
    buffer_load_dword v53, v4, s[4:7], s32 offen
    s_add_u32 s32, s32, 5120
    buffer_load_dword v54, v4, s[4:7], s32 offen
    s_add_u32 s32, s32, 5120
    buffer_load_dword v55, v4, s[4:7], s32 offen
    s_sub_u32 s32, s32, 33280
    buffer_load_dword v56, v4, s[4:7], s32 offen
    s_add_u32 s32, s32, 5120
    buffer_load_dword v57, v4, s[4:7], s32 offen
    s_add_u32 s32, s32, 5120
    buffer_load_dword v58, v4, s[4:7], s32 offen
    s_add_u32 s32, s32, 5120
    buffer_load_dword v59, v4, s[4:7], s32 offen
    s_add_u32 s32, s32, 5120
    buffer_load_dword v60, v4, s[4:7], s32 offen
    s_add_u32 s32, s32, 5120
    buffer_load_dword v61, v4, s[4:7], s32 offen
    s_add_u32 s32, s32, 5120
    buffer_load_dword v62, v4, s[4:7], s32 offen
    s_add_u32 s32, s32, 5120
    buffer_load_dword v63, v4, s[4:7], s32 offen
    s_add_u32 s32, s32, 43520
    buffer_load_dword v64, v4, s[4:7], s32 offen
    s_add_u32 s32, s32, 5120
    buffer_load_dword v65, v4, s[4:7], s32 offen
    s_add_u32 s32, s32, 5120
    buffer_load_dword v66, v4, s[4:7], s32 offen
    s_add_u32 s32, s32, 5120
    buffer_load_dword v67, v4, s[4:7], s32 offen
    s_add_u32 s32, s32, 5120
    buffer_load_dword v68, v4, s[4:7], s32 offen
    s_add_u32 s32, s32, 5120
    buffer_load_dword v69, v4, s[4:7], s32 offen
    s_add_u32 s32, s32, 5120
    buffer_load_dword v70, v4, s[4:7], s32 offen
    s_add_u32 s32, s32, 5120
    buffer_load_dword v71, v4, s[4:7], s32 offen
    s_sub_u32 s32, s32, 33280
    buffer_load_dword v72, v4, s[4:7], s32 offen
    s_add_u32 s32, s32, 5120
    buffer_load_dword v73, v4, s[4:7], s32 offen
    s_add_u32 s32, s32, 5120
    buffer_load_dword v74, v4, s[4:7], s32 offen
    s_add_u32 s32, s32, 5120
    buffer_load_dword v75, v4, s[4:7], s32 offen
    s_add_u32 s32, s32, 5120
    buffer_load_dword v76, v4, s[4:7], s32 offen
    s_add_u32 s32, s32, 5120
    buffer_load_dword v77, v4, s[4:7], s32 offen
    s_add_u32 s32, s32, 5120
    buffer_load_dword v78, v4, s[4:7], s32 offen
    s_add_u32 s32, s32, 5120
    buffer_load_dword v79, v4, s[4:7], s32 offen
    s_add_u32 s32, s32, 43520
    buffer_load_dword v80, v4, s[4:7], s32 offen
    s_add_u32 s32, s32, 5120
    buffer_load_dword v81, v4, s[4:7], s32 offen
    s_add_u32 s32, s32, 5120
    buffer_load_dword v82, v4, s[4:7], s32 offen
    s_add_u32 s32, s32, 5120
    buffer_load_dword v83, v4, s[4:7], s32 offen
    s_add_u32 s32, s32, 5120
    buffer_load_dword v84, v4, s[4:7], s32 offen
    s_add_u32 s32, s32, 5120
    buffer_load_dword v85, v4, s[4:7], s32 offen
    s_add_u32 s32, s32, 5120
    buffer_load_dword v86, v4, s[4:7], s32 offen
    s_add_u32 s32, s32, 5120
    buffer_load_dword v87, v4, s[4:7], s32 offen
    s_sub_u32 s32, s32, 33280
    buffer_load_dword v88, v4, s[4:7], s32 offen
    s_add_u32 s32, s32, 5120
    buffer_load_dword v89, v4, s[4:7], s32 offen
    s_add_u32 s32, s32, 5120
    buffer_load_dword v90, v4, s[4:7], s32 offen
    s_add_u32 s32, s32, 5120
    buffer_load_dword v91, v4, s[4:7], s32 offen
    s_add_u32 s32, s32, 5120
    buffer_load_dword v92, v4, s[4:7], s32 offen
    s_add_u32 s32, s32, 5120
    buffer_load_dword v93, v4, s[4:7], s32 offen
    s_add_u32 s32, s32, 5120
    buffer_load_dword v94, v4, s[4:7], s32 offen
    s_add_u32 s32, s32, 5120
    buffer_load_dword v95, v4, s[4:7], s32 offen
    s_add_u32 s32, s32, 43520
    s_waitcnt vmcnt(32)
    v_perm_b32 v96, v33, v32, s34
    v_accvgpr_write_b32 a0, v96
    v_perm_b32 v97, v35, v34, s34
    v_accvgpr_write_b32 a1, v97
    v_perm_b32 v96, v37, v36, s34
    v_accvgpr_write_b32 a2, v96
    v_perm_b32 v97, v39, v38, s34
    v_accvgpr_write_b32 a3, v97
    v_perm_b32 v96, v33, v32, s35
    v_accvgpr_write_b32 a4, v96
    v_perm_b32 v97, v35, v34, s35
    v_accvgpr_write_b32 a5, v97
    v_perm_b32 v96, v37, v36, s35
    v_accvgpr_write_b32 a6, v96
    v_perm_b32 v97, v39, v38, s35
    v_accvgpr_write_b32 a7, v97
    v_perm_b32 v96, v41, v40, s34
    v_accvgpr_write_b32 a8, v96
    v_perm_b32 v97, v43, v42, s34
    v_accvgpr_write_b32 a9, v97
    v_perm_b32 v96, v45, v44, s34
    v_accvgpr_write_b32 a10, v96
    v_perm_b32 v97, v47, v46, s34
    v_accvgpr_write_b32 a11, v97
    v_perm_b32 v96, v41, v40, s35
    v_accvgpr_write_b32 a12, v96
    v_perm_b32 v97, v43, v42, s35
    v_accvgpr_write_b32 a13, v97
    v_perm_b32 v96, v45, v44, s35
    v_accvgpr_write_b32 a14, v96
    v_perm_b32 v97, v47, v46, s35
    v_accvgpr_write_b32 a15, v97
    v_perm_b32 v96, v49, v48, s34
    v_accvgpr_write_b32 a16, v96
    v_perm_b32 v97, v51, v50, s34
    v_accvgpr_write_b32 a17, v97
    v_perm_b32 v96, v53, v52, s34
    v_accvgpr_write_b32 a18, v96
    v_perm_b32 v97, v55, v54, s34
    v_accvgpr_write_b32 a19, v97
    v_perm_b32 v96, v49, v48, s35
    v_accvgpr_write_b32 a20, v96
    v_perm_b32 v97, v51, v50, s35
    v_accvgpr_write_b32 a21, v97
    v_perm_b32 v96, v53, v52, s35
    v_accvgpr_write_b32 a22, v96
    v_perm_b32 v97, v55, v54, s35
    v_accvgpr_write_b32 a23, v97
    v_perm_b32 v96, v57, v56, s34
    v_accvgpr_write_b32 a24, v96
    v_perm_b32 v97, v59, v58, s34
    v_accvgpr_write_b32 a25, v97
    v_perm_b32 v96, v61, v60, s34
    v_accvgpr_write_b32 a26, v96
    v_perm_b32 v97, v63, v62, s34
    v_accvgpr_write_b32 a27, v97
    v_perm_b32 v96, v57, v56, s35
    v_accvgpr_write_b32 a28, v96
    v_perm_b32 v97, v59, v58, s35
    v_accvgpr_write_b32 a29, v97
    v_perm_b32 v96, v61, v60, s35
    v_accvgpr_write_b32 a30, v96
    v_perm_b32 v97, v63, v62, s35
    v_accvgpr_write_b32 a31, v97
    buffer_load_dword v32, v4, s[4:7], s32 offen
    s_add_u32 s32, s32, 5120
    buffer_load_dword v33, v4, s[4:7], s32 offen
    s_add_u32 s32, s32, 5120
    buffer_load_dword v34, v4, s[4:7], s32 offen
    s_add_u32 s32, s32, 5120
    buffer_load_dword v35, v4, s[4:7], s32 offen
    s_add_u32 s32, s32, 5120
    buffer_load_dword v36, v4, s[4:7], s32 offen
    s_add_u32 s32, s32, 5120
    buffer_load_dword v37, v4, s[4:7], s32 offen
    s_add_u32 s32, s32, 5120
    buffer_load_dword v38, v4, s[4:7], s32 offen
    s_add_u32 s32, s32, 5120
    buffer_load_dword v39, v4, s[4:7], s32 offen
    s_sub_u32 s32, s32, 33280
    buffer_load_dword v40, v4, s[4:7], s32 offen
    s_add_u32 s32, s32, 5120
    buffer_load_dword v41, v4, s[4:7], s32 offen
    s_add_u32 s32, s32, 5120
    buffer_load_dword v42, v4, s[4:7], s32 offen
    s_add_u32 s32, s32, 5120
    buffer_load_dword v43, v4, s[4:7], s32 offen
    s_add_u32 s32, s32, 5120
    buffer_load_dword v44, v4, s[4:7], s32 offen
    s_add_u32 s32, s32, 5120
    buffer_load_dword v45, v4, s[4:7], s32 offen
    s_add_u32 s32, s32, 5120
    buffer_load_dword v46, v4, s[4:7], s32 offen
    s_add_u32 s32, s32, 5120
    buffer_load_dword v47, v4, s[4:7], s32 offen
    s_add_u32 s32, s32, 43520
    buffer_load_dword v48, v4, s[4:7], s32 offen
    s_add_u32 s32, s32, 5120
    buffer_load_dword v49, v4, s[4:7], s32 offen
    s_add_u32 s32, s32, 5120
    buffer_load_dword v50, v4, s[4:7], s32 offen
    s_add_u32 s32, s32, 5120
    buffer_load_dword v51, v4, s[4:7], s32 offen
    s_add_u32 s32, s32, 5120
    buffer_load_dword v52, v4, s[4:7], s32 offen
    s_add_u32 s32, s32, 5120
    buffer_load_dword v53, v4, s[4:7], s32 offen
    s_add_u32 s32, s32, 5120
    buffer_load_dword v54, v4, s[4:7], s32 offen
    s_add_u32 s32, s32, 5120
    buffer_load_dword v55, v4, s[4:7], s32 offen
    s_sub_u32 s32, s32, 33280
    buffer_load_dword v56, v4, s[4:7], s32 offen
    s_add_u32 s32, s32, 5120
    buffer_load_dword v57, v4, s[4:7], s32 offen
    s_add_u32 s32, s32, 5120
    buffer_load_dword v58, v4, s[4:7], s32 offen
    s_add_u32 s32, s32, 5120
    buffer_load_dword v59, v4, s[4:7], s32 offen
    s_add_u32 s32, s32, 5120
    buffer_load_dword v60, v4, s[4:7], s32 offen
    s_add_u32 s32, s32, 5120
    buffer_load_dword v61, v4, s[4:7], s32 offen
    s_add_u32 s32, s32, 5120
    buffer_load_dword v62, v4, s[4:7], s32 offen
    s_add_u32 s32, s32, 5120
    buffer_load_dword v63, v4, s[4:7], s32 offen
    s_add_u32 s32, s32, 43520
    s_waitcnt vmcnt(32)
    v_perm_b32 v96, v65, v64, s34
    v_accvgpr_write_b32 a32, v96
    v_perm_b32 v97, v67, v66, s34
    v_accvgpr_write_b32 a33, v97
    v_perm_b32 v96, v69, v68, s34
    v_accvgpr_write_b32 a34, v96
    v_perm_b32 v97, v71, v70, s34
    v_accvgpr_write_b32 a35, v97
    v_perm_b32 v96, v65, v64, s35
    v_accvgpr_write_b32 a36, v96
    v_perm_b32 v97, v67, v66, s35
    v_accvgpr_write_b32 a37, v97
    v_perm_b32 v96, v69, v68, s35
    v_accvgpr_write_b32 a38, v96
    v_perm_b32 v97, v71, v70, s35
    v_accvgpr_write_b32 a39, v97
    v_perm_b32 v96, v73, v72, s34
    v_accvgpr_write_b32 a40, v96
    v_perm_b32 v97, v75, v74, s34
    v_accvgpr_write_b32 a41, v97
    v_perm_b32 v96, v77, v76, s34
    v_accvgpr_write_b32 a42, v96
    v_perm_b32 v97, v79, v78, s34
    v_accvgpr_write_b32 a43, v97
    v_perm_b32 v96, v73, v72, s35
    v_accvgpr_write_b32 a44, v96
    v_perm_b32 v97, v75, v74, s35
    v_accvgpr_write_b32 a45, v97
    v_perm_b32 v96, v77, v76, s35
    v_accvgpr_write_b32 a46, v96
    v_perm_b32 v97, v79, v78, s35
    v_accvgpr_write_b32 a47, v97
    v_perm_b32 v96, v81, v80, s34
    v_accvgpr_write_b32 a48, v96
    v_perm_b32 v97, v83, v82, s34
    v_accvgpr_write_b32 a49, v97
    v_perm_b32 v96, v85, v84, s34
    v_accvgpr_write_b32 a50, v96
    v_perm_b32 v97, v87, v86, s34
    v_accvgpr_write_b32 a51, v97
    v_perm_b32 v96, v81, v80, s35
    v_accvgpr_write_b32 a52, v96
    v_perm_b32 v97, v83, v82, s35
    v_accvgpr_write_b32 a53, v97
    v_perm_b32 v96, v85, v84, s35
    v_accvgpr_write_b32 a54, v96
    v_perm_b32 v97, v87, v86, s35
    v_accvgpr_write_b32 a55, v97
    v_perm_b32 v96, v89, v88, s34
    v_accvgpr_write_b32 a56, v96
    v_perm_b32 v97, v91, v90, s34
    v_accvgpr_write_b32 a57, v97
    v_perm_b32 v96, v93, v92, s34
    v_accvgpr_write_b32 a58, v96
    v_perm_b32 v97, v95, v94, s34
    v_accvgpr_write_b32 a59, v97
    v_perm_b32 v96, v89, v88, s35
    v_accvgpr_write_b32 a60, v96
    v_perm_b32 v97, v91, v90, s35
    v_accvgpr_write_b32 a61, v97
    v_perm_b32 v96, v93, v92, s35
    v_accvgpr_write_b32 a62, v96
    v_perm_b32 v97, v95, v94, s35
    v_accvgpr_write_b32 a63, v97
    buffer_load_dword v64, v4, s[4:7], s32 offen
    s_add_u32 s32, s32, 5120
    buffer_load_dword v65, v4, s[4:7], s32 offen
    s_add_u32 s32, s32, 5120
    buffer_load_dword v66, v4, s[4:7], s32 offen
    s_add_u32 s32, s32, 5120
    buffer_load_dword v67, v4, s[4:7], s32 offen
    s_add_u32 s32, s32, 5120
    buffer_load_dword v68, v4, s[4:7], s32 offen
    s_add_u32 s32, s32, 5120
    buffer_load_dword v69, v4, s[4:7], s32 offen
    s_add_u32 s32, s32, 5120
    buffer_load_dword v70, v4, s[4:7], s32 offen
    s_add_u32 s32, s32, 5120
    buffer_load_dword v71, v4, s[4:7], s32 offen
    s_sub_u32 s32, s32, 33280
    buffer_load_dword v72, v4, s[4:7], s32 offen
    s_add_u32 s32, s32, 5120
    buffer_load_dword v73, v4, s[4:7], s32 offen
    s_add_u32 s32, s32, 5120
    buffer_load_dword v74, v4, s[4:7], s32 offen
    s_add_u32 s32, s32, 5120
    buffer_load_dword v75, v4, s[4:7], s32 offen
    s_add_u32 s32, s32, 5120
    buffer_load_dword v76, v4, s[4:7], s32 offen
    s_add_u32 s32, s32, 5120
    buffer_load_dword v77, v4, s[4:7], s32 offen
    s_add_u32 s32, s32, 5120
    buffer_load_dword v78, v4, s[4:7], s32 offen
    s_add_u32 s32, s32, 5120
    buffer_load_dword v79, v4, s[4:7], s32 offen
    s_add_u32 s32, s32, 43520
    buffer_load_dword v80, v4, s[4:7], s32 offen
    s_add_u32 s32, s32, 5120
    buffer_load_dword v81, v4, s[4:7], s32 offen
    s_add_u32 s32, s32, 5120
    buffer_load_dword v82, v4, s[4:7], s32 offen
    s_add_u32 s32, s32, 5120
    buffer_load_dword v83, v4, s[4:7], s32 offen
    s_add_u32 s32, s32, 5120
    buffer_load_dword v84, v4, s[4:7], s32 offen
    s_add_u32 s32, s32, 5120
    buffer_load_dword v85, v4, s[4:7], s32 offen
    s_add_u32 s32, s32, 5120
    buffer_load_dword v86, v4, s[4:7], s32 offen
    s_add_u32 s32, s32, 5120
    buffer_load_dword v87, v4, s[4:7], s32 offen
    s_sub_u32 s32, s32, 33280
    buffer_load_dword v88, v4, s[4:7], s32 offen
    s_add_u32 s32, s32, 5120
    buffer_load_dword v89, v4, s[4:7], s32 offen
    s_add_u32 s32, s32, 5120
    buffer_load_dword v90, v4, s[4:7], s32 offen
    s_add_u32 s32, s32, 5120
    buffer_load_dword v91, v4, s[4:7], s32 offen
    s_add_u32 s32, s32, 5120
    buffer_load_dword v92, v4, s[4:7], s32 offen
    s_add_u32 s32, s32, 5120
    buffer_load_dword v93, v4, s[4:7], s32 offen
    s_add_u32 s32, s32, 5120
    buffer_load_dword v94, v4, s[4:7], s32 offen
    s_add_u32 s32, s32, 5120
    buffer_load_dword v95, v4, s[4:7], s32 offen
    s_add_u32 s32, s32, 43520
    s_waitcnt vmcnt(32)
    v_perm_b32 v96, v33, v32, s34
    v_accvgpr_write_b32 a64, v96
    v_perm_b32 v97, v35, v34, s34
    v_accvgpr_write_b32 a65, v97
    v_perm_b32 v96, v37, v36, s34
    v_accvgpr_write_b32 a66, v96
    v_perm_b32 v97, v39, v38, s34
    v_accvgpr_write_b32 a67, v97
    v_perm_b32 v96, v33, v32, s35
    v_accvgpr_write_b32 a68, v96
    v_perm_b32 v97, v35, v34, s35
    v_accvgpr_write_b32 a69, v97
    v_perm_b32 v96, v37, v36, s35
    v_accvgpr_write_b32 a70, v96
    v_perm_b32 v97, v39, v38, s35
    v_accvgpr_write_b32 a71, v97
    v_perm_b32 v96, v41, v40, s34
    v_accvgpr_write_b32 a72, v96
    v_perm_b32 v97, v43, v42, s34
    v_accvgpr_write_b32 a73, v97
    v_perm_b32 v96, v45, v44, s34
    v_accvgpr_write_b32 a74, v96
    v_perm_b32 v97, v47, v46, s34
    v_accvgpr_write_b32 a75, v97
    v_perm_b32 v96, v41, v40, s35
    v_accvgpr_write_b32 a76, v96
    v_perm_b32 v97, v43, v42, s35
    v_accvgpr_write_b32 a77, v97
    v_perm_b32 v96, v45, v44, s35
    v_accvgpr_write_b32 a78, v96
    v_perm_b32 v97, v47, v46, s35
    v_accvgpr_write_b32 a79, v97
    v_perm_b32 v96, v49, v48, s34
    v_accvgpr_write_b32 a80, v96
    v_perm_b32 v97, v51, v50, s34
    v_accvgpr_write_b32 a81, v97
    v_perm_b32 v96, v53, v52, s34
    v_accvgpr_write_b32 a82, v96
    v_perm_b32 v97, v55, v54, s34
    v_accvgpr_write_b32 a83, v97
    v_perm_b32 v96, v49, v48, s35
    v_accvgpr_write_b32 a84, v96
    v_perm_b32 v97, v51, v50, s35
    v_accvgpr_write_b32 a85, v97
    v_perm_b32 v96, v53, v52, s35
    v_accvgpr_write_b32 a86, v96
    v_perm_b32 v97, v55, v54, s35
    v_accvgpr_write_b32 a87, v97
    v_perm_b32 v96, v57, v56, s34
    v_accvgpr_write_b32 a88, v96
    v_perm_b32 v97, v59, v58, s34
    v_accvgpr_write_b32 a89, v97
    v_perm_b32 v96, v61, v60, s34
    v_accvgpr_write_b32 a90, v96
    v_perm_b32 v97, v63, v62, s34
    v_accvgpr_write_b32 a91, v97
    v_perm_b32 v96, v57, v56, s35
    v_accvgpr_write_b32 a92, v96
    v_perm_b32 v97, v59, v58, s35
    v_accvgpr_write_b32 a93, v97
    v_perm_b32 v96, v61, v60, s35
    v_accvgpr_write_b32 a94, v96
    v_perm_b32 v97, v63, v62, s35
    v_accvgpr_write_b32 a95, v97
    buffer_load_dword v32, v4, s[4:7], s32 offen
    s_add_u32 s32, s32, 5120
    buffer_load_dword v33, v4, s[4:7], s32 offen
    s_add_u32 s32, s32, 5120
    buffer_load_dword v34, v4, s[4:7], s32 offen
    s_add_u32 s32, s32, 5120
    buffer_load_dword v35, v4, s[4:7], s32 offen
    s_add_u32 s32, s32, 5120
    buffer_load_dword v36, v4, s[4:7], s32 offen
    s_add_u32 s32, s32, 5120
    buffer_load_dword v37, v4, s[4:7], s32 offen
    s_add_u32 s32, s32, 5120
    buffer_load_dword v38, v4, s[4:7], s32 offen
    s_add_u32 s32, s32, 5120
    buffer_load_dword v39, v4, s[4:7], s32 offen
    s_sub_u32 s32, s32, 33280
    buffer_load_dword v40, v4, s[4:7], s32 offen
    s_add_u32 s32, s32, 5120
    buffer_load_dword v41, v4, s[4:7], s32 offen
    s_add_u32 s32, s32, 5120
    buffer_load_dword v42, v4, s[4:7], s32 offen
    s_add_u32 s32, s32, 5120
    buffer_load_dword v43, v4, s[4:7], s32 offen
    s_add_u32 s32, s32, 5120
    buffer_load_dword v44, v4, s[4:7], s32 offen
    s_add_u32 s32, s32, 5120
    buffer_load_dword v45, v4, s[4:7], s32 offen
    s_add_u32 s32, s32, 5120
    buffer_load_dword v46, v4, s[4:7], s32 offen
    s_add_u32 s32, s32, 5120
    buffer_load_dword v47, v4, s[4:7], s32 offen
    s_add_u32 s32, s32, 43520
    buffer_load_dword v48, v4, s[4:7], s32 offen
    s_add_u32 s32, s32, 5120
    buffer_load_dword v49, v4, s[4:7], s32 offen
    s_add_u32 s32, s32, 5120
    buffer_load_dword v50, v4, s[4:7], s32 offen
    s_add_u32 s32, s32, 5120
    buffer_load_dword v51, v4, s[4:7], s32 offen
    s_add_u32 s32, s32, 5120
    buffer_load_dword v52, v4, s[4:7], s32 offen
    s_add_u32 s32, s32, 5120
    buffer_load_dword v53, v4, s[4:7], s32 offen
    s_add_u32 s32, s32, 5120
    buffer_load_dword v54, v4, s[4:7], s32 offen
    s_add_u32 s32, s32, 5120
    buffer_load_dword v55, v4, s[4:7], s32 offen
    s_sub_u32 s32, s32, 33280
    buffer_load_dword v56, v4, s[4:7], s32 offen
    s_add_u32 s32, s32, 5120
    buffer_load_dword v57, v4, s[4:7], s32 offen
    s_add_u32 s32, s32, 5120
    buffer_load_dword v58, v4, s[4:7], s32 offen
    s_add_u32 s32, s32, 5120
    buffer_load_dword v59, v4, s[4:7], s32 offen
    s_add_u32 s32, s32, 5120
    buffer_load_dword v60, v4, s[4:7], s32 offen
    s_add_u32 s32, s32, 5120
    buffer_load_dword v61, v4, s[4:7], s32 offen
    s_add_u32 s32, s32, 5120
    buffer_load_dword v62, v4, s[4:7], s32 offen
    s_add_u32 s32, s32, 5120
    buffer_load_dword v63, v4, s[4:7], s32 offen
    s_add_u32 s32, s32, 43520
    s_waitcnt vmcnt(32)
    v_perm_b32 v96, v65, v64, s34
    v_accvgpr_write_b32 a96, v96
    v_perm_b32 v97, v67, v66, s34
    v_accvgpr_write_b32 a97, v97
    v_perm_b32 v96, v69, v68, s34
    v_accvgpr_write_b32 a98, v96
    v_perm_b32 v97, v71, v70, s34
    v_accvgpr_write_b32 a99, v97
    v_perm_b32 v96, v65, v64, s35
    v_accvgpr_write_b32 a100, v96
    v_perm_b32 v97, v67, v66, s35
    v_accvgpr_write_b32 a101, v97
    v_perm_b32 v96, v69, v68, s35
    v_accvgpr_write_b32 a102, v96
    v_perm_b32 v97, v71, v70, s35
    v_accvgpr_write_b32 a103, v97
    v_perm_b32 v96, v73, v72, s34
    v_accvgpr_write_b32 a104, v96
    v_perm_b32 v97, v75, v74, s34
    v_accvgpr_write_b32 a105, v97
    v_perm_b32 v96, v77, v76, s34
    v_accvgpr_write_b32 a106, v96
    v_perm_b32 v97, v79, v78, s34
    v_accvgpr_write_b32 a107, v97
    v_perm_b32 v96, v73, v72, s35
    v_accvgpr_write_b32 a108, v96
    v_perm_b32 v97, v75, v74, s35
    v_accvgpr_write_b32 a109, v97
    v_perm_b32 v96, v77, v76, s35
    v_accvgpr_write_b32 a110, v96
    v_perm_b32 v97, v79, v78, s35
    v_accvgpr_write_b32 a111, v97
    v_perm_b32 v96, v81, v80, s34
    v_accvgpr_write_b32 a112, v96
    v_perm_b32 v97, v83, v82, s34
    v_accvgpr_write_b32 a113, v97
    v_perm_b32 v96, v85, v84, s34
    v_accvgpr_write_b32 a114, v96
    v_perm_b32 v97, v87, v86, s34
    v_accvgpr_write_b32 a115, v97
    v_perm_b32 v96, v81, v80, s35
    v_accvgpr_write_b32 a116, v96
    v_perm_b32 v97, v83, v82, s35
    v_accvgpr_write_b32 a117, v97
    v_perm_b32 v96, v85, v84, s35
    v_accvgpr_write_b32 a118, v96
    v_perm_b32 v97, v87, v86, s35
    v_accvgpr_write_b32 a119, v97
    v_perm_b32 v96, v89, v88, s34
    v_accvgpr_write_b32 a120, v96
    v_perm_b32 v97, v91, v90, s34
    v_accvgpr_write_b32 a121, v97
    v_perm_b32 v96, v93, v92, s34
    v_accvgpr_write_b32 a122, v96
    v_perm_b32 v97, v95, v94, s34
    v_accvgpr_write_b32 a123, v97
    v_perm_b32 v96, v89, v88, s35
    v_accvgpr_write_b32 a124, v96
    v_perm_b32 v97, v91, v90, s35
    v_accvgpr_write_b32 a125, v97
    v_perm_b32 v96, v93, v92, s35
    v_accvgpr_write_b32 a126, v96
    v_perm_b32 v97, v95, v94, s35
    v_accvgpr_write_b32 a127, v97
    buffer_load_dword v64, v4, s[4:7], s32 offen
    s_add_u32 s32, s32, 5120
    buffer_load_dword v65, v4, s[4:7], s32 offen
    s_add_u32 s32, s32, 5120
    buffer_load_dword v66, v4, s[4:7], s32 offen
    s_add_u32 s32, s32, 5120
    buffer_load_dword v67, v4, s[4:7], s32 offen
    s_add_u32 s32, s32, 5120
    buffer_load_dword v68, v4, s[4:7], s32 offen
    s_add_u32 s32, s32, 5120
    buffer_load_dword v69, v4, s[4:7], s32 offen
    s_add_u32 s32, s32, 5120
    buffer_load_dword v70, v4, s[4:7], s32 offen
    s_add_u32 s32, s32, 5120
    buffer_load_dword v71, v4, s[4:7], s32 offen
    s_sub_u32 s32, s32, 33280
    buffer_load_dword v72, v4, s[4:7], s32 offen
    s_add_u32 s32, s32, 5120
    buffer_load_dword v73, v4, s[4:7], s32 offen
    s_add_u32 s32, s32, 5120
    buffer_load_dword v74, v4, s[4:7], s32 offen
    s_add_u32 s32, s32, 5120
    buffer_load_dword v75, v4, s[4:7], s32 offen
    s_add_u32 s32, s32, 5120
    buffer_load_dword v76, v4, s[4:7], s32 offen
    s_add_u32 s32, s32, 5120
    buffer_load_dword v77, v4, s[4:7], s32 offen
    s_add_u32 s32, s32, 5120
    buffer_load_dword v78, v4, s[4:7], s32 offen
    s_add_u32 s32, s32, 5120
    buffer_load_dword v79, v4, s[4:7], s32 offen
    s_add_u32 s32, s32, 43520
    buffer_load_dword v80, v4, s[4:7], s32 offen
    s_add_u32 s32, s32, 5120
    buffer_load_dword v81, v4, s[4:7], s32 offen
    s_add_u32 s32, s32, 5120
    buffer_load_dword v82, v4, s[4:7], s32 offen
    s_add_u32 s32, s32, 5120
    buffer_load_dword v83, v4, s[4:7], s32 offen
    s_add_u32 s32, s32, 5120
    buffer_load_dword v84, v4, s[4:7], s32 offen
    s_add_u32 s32, s32, 5120
    buffer_load_dword v85, v4, s[4:7], s32 offen
    s_add_u32 s32, s32, 5120
    buffer_load_dword v86, v4, s[4:7], s32 offen
    s_add_u32 s32, s32, 5120
    buffer_load_dword v87, v4, s[4:7], s32 offen
    s_sub_u32 s32, s32, 33280
    buffer_load_dword v88, v4, s[4:7], s32 offen
    s_add_u32 s32, s32, 5120
    buffer_load_dword v89, v4, s[4:7], s32 offen
    s_add_u32 s32, s32, 5120
    buffer_load_dword v90, v4, s[4:7], s32 offen
    s_add_u32 s32, s32, 5120
    buffer_load_dword v91, v4, s[4:7], s32 offen
    s_add_u32 s32, s32, 5120
    buffer_load_dword v92, v4, s[4:7], s32 offen
    s_add_u32 s32, s32, 5120
    buffer_load_dword v93, v4, s[4:7], s32 offen
    s_add_u32 s32, s32, 5120
    buffer_load_dword v94, v4, s[4:7], s32 offen
    s_add_u32 s32, s32, 5120
    buffer_load_dword v95, v4, s[4:7], s32 offen
    s_add_u32 s32, s32, 43520
    s_waitcnt vmcnt(32)
    v_perm_b32 v96, v33, v32, s34
    v_accvgpr_write_b32 a128, v96
    v_perm_b32 v97, v35, v34, s34
    v_accvgpr_write_b32 a129, v97
    v_perm_b32 v96, v37, v36, s34
    v_accvgpr_write_b32 a130, v96
    v_perm_b32 v97, v39, v38, s34
    v_accvgpr_write_b32 a131, v97
    v_perm_b32 v96, v33, v32, s35
    v_accvgpr_write_b32 a132, v96
    v_perm_b32 v97, v35, v34, s35
    v_accvgpr_write_b32 a133, v97
    v_perm_b32 v96, v37, v36, s35
    v_accvgpr_write_b32 a134, v96
    v_perm_b32 v97, v39, v38, s35
    v_accvgpr_write_b32 a135, v97
    v_perm_b32 v96, v41, v40, s34
    v_accvgpr_write_b32 a136, v96
    v_perm_b32 v97, v43, v42, s34
    v_accvgpr_write_b32 a137, v97
    v_perm_b32 v96, v45, v44, s34
    v_accvgpr_write_b32 a138, v96
    v_perm_b32 v97, v47, v46, s34
    v_accvgpr_write_b32 a139, v97
    v_perm_b32 v96, v41, v40, s35
    v_accvgpr_write_b32 a140, v96
    v_perm_b32 v97, v43, v42, s35
    v_accvgpr_write_b32 a141, v97
    v_perm_b32 v96, v45, v44, s35
    v_accvgpr_write_b32 a142, v96
    v_perm_b32 v97, v47, v46, s35
    v_accvgpr_write_b32 a143, v97
    v_perm_b32 v96, v49, v48, s34
    v_accvgpr_write_b32 a144, v96
    v_perm_b32 v97, v51, v50, s34
    v_accvgpr_write_b32 a145, v97
    v_perm_b32 v96, v53, v52, s34
    v_accvgpr_write_b32 a146, v96
    v_perm_b32 v97, v55, v54, s34
    v_accvgpr_write_b32 a147, v97
    v_perm_b32 v96, v49, v48, s35
    v_accvgpr_write_b32 a148, v96
    v_perm_b32 v97, v51, v50, s35
    v_accvgpr_write_b32 a149, v97
    v_perm_b32 v96, v53, v52, s35
    v_accvgpr_write_b32 a150, v96
    v_perm_b32 v97, v55, v54, s35
    v_accvgpr_write_b32 a151, v97
    v_perm_b32 v96, v57, v56, s34
    v_accvgpr_write_b32 a152, v96
    v_perm_b32 v97, v59, v58, s34
    v_accvgpr_write_b32 a153, v97
    v_perm_b32 v96, v61, v60, s34
    v_accvgpr_write_b32 a154, v96
    v_perm_b32 v97, v63, v62, s34
    v_accvgpr_write_b32 a155, v97
    v_perm_b32 v96, v57, v56, s35
    v_accvgpr_write_b32 a156, v96
    v_perm_b32 v97, v59, v58, s35
    v_accvgpr_write_b32 a157, v97
    v_perm_b32 v96, v61, v60, s35
    v_accvgpr_write_b32 a158, v96
    v_perm_b32 v97, v63, v62, s35
    v_accvgpr_write_b32 a159, v97
    buffer_load_dword v32, v4, s[4:7], s32 offen
    s_add_u32 s32, s32, 5120
    buffer_load_dword v33, v4, s[4:7], s32 offen
    s_add_u32 s32, s32, 5120
    buffer_load_dword v34, v4, s[4:7], s32 offen
    s_add_u32 s32, s32, 5120
    buffer_load_dword v35, v4, s[4:7], s32 offen
    s_add_u32 s32, s32, 5120
    buffer_load_dword v36, v4, s[4:7], s32 offen
    s_add_u32 s32, s32, 5120
    buffer_load_dword v37, v4, s[4:7], s32 offen
    s_add_u32 s32, s32, 5120
    buffer_load_dword v38, v4, s[4:7], s32 offen
    s_add_u32 s32, s32, 5120
    buffer_load_dword v39, v4, s[4:7], s32 offen
    s_sub_u32 s32, s32, 33280
    buffer_load_dword v40, v4, s[4:7], s32 offen
    s_add_u32 s32, s32, 5120
    buffer_load_dword v41, v4, s[4:7], s32 offen
    s_add_u32 s32, s32, 5120
    buffer_load_dword v42, v4, s[4:7], s32 offen
    s_add_u32 s32, s32, 5120
    buffer_load_dword v43, v4, s[4:7], s32 offen
    s_add_u32 s32, s32, 5120
    buffer_load_dword v44, v4, s[4:7], s32 offen
    s_add_u32 s32, s32, 5120
    buffer_load_dword v45, v4, s[4:7], s32 offen
    s_add_u32 s32, s32, 5120
    buffer_load_dword v46, v4, s[4:7], s32 offen
    s_add_u32 s32, s32, 5120
    buffer_load_dword v47, v4, s[4:7], s32 offen
    s_add_u32 s32, s32, 43520
    buffer_load_dword v48, v4, s[4:7], s32 offen
    s_add_u32 s32, s32, 5120
    buffer_load_dword v49, v4, s[4:7], s32 offen
    s_add_u32 s32, s32, 5120
    buffer_load_dword v50, v4, s[4:7], s32 offen
    s_add_u32 s32, s32, 5120
    buffer_load_dword v51, v4, s[4:7], s32 offen
    s_add_u32 s32, s32, 5120
    buffer_load_dword v52, v4, s[4:7], s32 offen
    s_add_u32 s32, s32, 5120
    buffer_load_dword v53, v4, s[4:7], s32 offen
    s_add_u32 s32, s32, 5120
    buffer_load_dword v54, v4, s[4:7], s32 offen
    s_add_u32 s32, s32, 5120
    buffer_load_dword v55, v4, s[4:7], s32 offen
    s_sub_u32 s32, s32, 33280
    buffer_load_dword v56, v4, s[4:7], s32 offen
    s_add_u32 s32, s32, 5120
    buffer_load_dword v57, v4, s[4:7], s32 offen
    s_add_u32 s32, s32, 5120
    buffer_load_dword v58, v4, s[4:7], s32 offen
    s_add_u32 s32, s32, 5120
    buffer_load_dword v59, v4, s[4:7], s32 offen
    s_add_u32 s32, s32, 5120
    buffer_load_dword v60, v4, s[4:7], s32 offen
    s_add_u32 s32, s32, 5120
    buffer_load_dword v61, v4, s[4:7], s32 offen
    s_add_u32 s32, s32, 5120
    buffer_load_dword v62, v4, s[4:7], s32 offen
    s_add_u32 s32, s32, 5120
    buffer_load_dword v63, v4, s[4:7], s32 offen
    s_add_u32 s32, s32, 43520
    s_waitcnt vmcnt(32)
    v_perm_b32 v96, v65, v64, s34
    v_accvgpr_write_b32 a160, v96
    v_perm_b32 v97, v67, v66, s34
    v_accvgpr_write_b32 a161, v97
    v_perm_b32 v96, v69, v68, s34
    v_accvgpr_write_b32 a162, v96
    v_perm_b32 v97, v71, v70, s34
    v_accvgpr_write_b32 a163, v97
    v_perm_b32 v96, v65, v64, s35
    v_accvgpr_write_b32 a164, v96
    v_perm_b32 v97, v67, v66, s35
    v_accvgpr_write_b32 a165, v97
    v_perm_b32 v96, v69, v68, s35
    v_accvgpr_write_b32 a166, v96
    v_perm_b32 v97, v71, v70, s35
    v_accvgpr_write_b32 a167, v97
    v_perm_b32 v96, v73, v72, s34
    v_accvgpr_write_b32 a168, v96
    v_perm_b32 v97, v75, v74, s34
    v_accvgpr_write_b32 a169, v97
    v_perm_b32 v96, v77, v76, s34
    v_accvgpr_write_b32 a170, v96
    v_perm_b32 v97, v79, v78, s34
    v_accvgpr_write_b32 a171, v97
    v_perm_b32 v96, v73, v72, s35
    v_accvgpr_write_b32 a172, v96
    v_perm_b32 v97, v75, v74, s35
    v_accvgpr_write_b32 a173, v97
    v_perm_b32 v96, v77, v76, s35
    v_accvgpr_write_b32 a174, v96
    v_perm_b32 v97, v79, v78, s35
    v_accvgpr_write_b32 a175, v97
    v_perm_b32 v96, v81, v80, s34
    v_accvgpr_write_b32 a176, v96
    v_perm_b32 v97, v83, v82, s34
    v_accvgpr_write_b32 a177, v97
    v_perm_b32 v96, v85, v84, s34
    v_accvgpr_write_b32 a178, v96
    v_perm_b32 v97, v87, v86, s34
    v_accvgpr_write_b32 a179, v97
    v_perm_b32 v96, v81, v80, s35
    v_accvgpr_write_b32 a180, v96
    v_perm_b32 v97, v83, v82, s35
    v_accvgpr_write_b32 a181, v97
    v_perm_b32 v96, v85, v84, s35
    v_accvgpr_write_b32 a182, v96
    v_perm_b32 v97, v87, v86, s35
    v_accvgpr_write_b32 a183, v97
    v_perm_b32 v96, v89, v88, s34
    v_accvgpr_write_b32 a184, v96
    v_perm_b32 v97, v91, v90, s34
    v_accvgpr_write_b32 a185, v97
    v_perm_b32 v96, v93, v92, s34
    v_accvgpr_write_b32 a186, v96
    v_perm_b32 v97, v95, v94, s34
    v_accvgpr_write_b32 a187, v97
    v_perm_b32 v96, v89, v88, s35
    v_accvgpr_write_b32 a188, v96
    v_perm_b32 v97, v91, v90, s35
    v_accvgpr_write_b32 a189, v97
    v_perm_b32 v96, v93, v92, s35
    v_accvgpr_write_b32 a190, v96
    v_perm_b32 v97, v95, v94, s35
    v_accvgpr_write_b32 a191, v97
    buffer_load_dword v64, v4, s[4:7], s32 offen
    s_add_u32 s32, s32, 5120
    buffer_load_dword v65, v4, s[4:7], s32 offen
    s_add_u32 s32, s32, 5120
    buffer_load_dword v66, v4, s[4:7], s32 offen
    s_add_u32 s32, s32, 5120
    buffer_load_dword v67, v4, s[4:7], s32 offen
    s_add_u32 s32, s32, 5120
    buffer_load_dword v68, v4, s[4:7], s32 offen
    s_add_u32 s32, s32, 5120
    buffer_load_dword v69, v4, s[4:7], s32 offen
    s_add_u32 s32, s32, 5120
    buffer_load_dword v70, v4, s[4:7], s32 offen
    s_add_u32 s32, s32, 5120
    buffer_load_dword v71, v4, s[4:7], s32 offen
    s_sub_u32 s32, s32, 33280
    buffer_load_dword v72, v4, s[4:7], s32 offen
    s_add_u32 s32, s32, 5120
    buffer_load_dword v73, v4, s[4:7], s32 offen
    s_add_u32 s32, s32, 5120
    buffer_load_dword v74, v4, s[4:7], s32 offen
    s_add_u32 s32, s32, 5120
    buffer_load_dword v75, v4, s[4:7], s32 offen
    s_add_u32 s32, s32, 5120
    buffer_load_dword v76, v4, s[4:7], s32 offen
    s_add_u32 s32, s32, 5120
    buffer_load_dword v77, v4, s[4:7], s32 offen
    s_add_u32 s32, s32, 5120
    buffer_load_dword v78, v4, s[4:7], s32 offen
    s_add_u32 s32, s32, 5120
    buffer_load_dword v79, v4, s[4:7], s32 offen
    s_add_u32 s32, s32, 43520
    buffer_load_dword v80, v4, s[4:7], s32 offen
    s_add_u32 s32, s32, 5120
    buffer_load_dword v81, v4, s[4:7], s32 offen
    s_add_u32 s32, s32, 5120
    buffer_load_dword v82, v4, s[4:7], s32 offen
    s_add_u32 s32, s32, 5120
    buffer_load_dword v83, v4, s[4:7], s32 offen
    s_add_u32 s32, s32, 5120
    buffer_load_dword v84, v4, s[4:7], s32 offen
    s_add_u32 s32, s32, 5120
    buffer_load_dword v85, v4, s[4:7], s32 offen
    s_add_u32 s32, s32, 5120
    buffer_load_dword v86, v4, s[4:7], s32 offen
    s_add_u32 s32, s32, 5120
    buffer_load_dword v87, v4, s[4:7], s32 offen
    s_sub_u32 s32, s32, 33280
    buffer_load_dword v88, v4, s[4:7], s32 offen
    s_add_u32 s32, s32, 5120
    buffer_load_dword v89, v4, s[4:7], s32 offen
    s_add_u32 s32, s32, 5120
    buffer_load_dword v90, v4, s[4:7], s32 offen
    s_add_u32 s32, s32, 5120
    buffer_load_dword v91, v4, s[4:7], s32 offen
    s_add_u32 s32, s32, 5120
    buffer_load_dword v92, v4, s[4:7], s32 offen
    s_add_u32 s32, s32, 5120
    buffer_load_dword v93, v4, s[4:7], s32 offen
    s_add_u32 s32, s32, 5120
    buffer_load_dword v94, v4, s[4:7], s32 offen
    s_add_u32 s32, s32, 5120
    buffer_load_dword v95, v4, s[4:7], s32 offen
    s_add_u32 s32, s32, 43520
    s_waitcnt vmcnt(32)
    v_perm_b32 v96, v33, v32, s34
    v_accvgpr_write_b32 a192, v96
    v_perm_b32 v97, v35, v34, s34
    v_accvgpr_write_b32 a193, v97
    v_perm_b32 v96, v37, v36, s34
    v_accvgpr_write_b32 a194, v96
    v_perm_b32 v97, v39, v38, s34
    v_accvgpr_write_b32 a195, v97
    v_perm_b32 v96, v33, v32, s35
    v_accvgpr_write_b32 a196, v96
    v_perm_b32 v97, v35, v34, s35
    v_accvgpr_write_b32 a197, v97
    v_perm_b32 v96, v37, v36, s35
    v_accvgpr_write_b32 a198, v96
    v_perm_b32 v97, v39, v38, s35
    v_accvgpr_write_b32 a199, v97
    v_perm_b32 v96, v41, v40, s34
    v_accvgpr_write_b32 a200, v96
    v_perm_b32 v97, v43, v42, s34
    v_accvgpr_write_b32 a201, v97
    v_perm_b32 v96, v45, v44, s34
    v_accvgpr_write_b32 a202, v96
    v_perm_b32 v97, v47, v46, s34
    v_accvgpr_write_b32 a203, v97
    v_perm_b32 v96, v41, v40, s35
    v_accvgpr_write_b32 a204, v96
    v_perm_b32 v97, v43, v42, s35
    v_accvgpr_write_b32 a205, v97
    v_perm_b32 v96, v45, v44, s35
    v_accvgpr_write_b32 a206, v96
    v_perm_b32 v97, v47, v46, s35
    v_accvgpr_write_b32 a207, v97
    v_perm_b32 v96, v49, v48, s34
    v_accvgpr_write_b32 a208, v96
    v_perm_b32 v97, v51, v50, s34
    v_accvgpr_write_b32 a209, v97
    v_perm_b32 v96, v53, v52, s34
    v_accvgpr_write_b32 a210, v96
    v_perm_b32 v97, v55, v54, s34
    v_accvgpr_write_b32 a211, v97
    v_perm_b32 v96, v49, v48, s35
    v_accvgpr_write_b32 a212, v96
    v_perm_b32 v97, v51, v50, s35
    v_accvgpr_write_b32 a213, v97
    v_perm_b32 v96, v53, v52, s35
    v_accvgpr_write_b32 a214, v96
    v_perm_b32 v97, v55, v54, s35
    v_accvgpr_write_b32 a215, v97
    v_perm_b32 v96, v57, v56, s34
    v_accvgpr_write_b32 a216, v96
    v_perm_b32 v97, v59, v58, s34
    v_accvgpr_write_b32 a217, v97
    v_perm_b32 v96, v61, v60, s34
    v_accvgpr_write_b32 a218, v96
    v_perm_b32 v97, v63, v62, s34
    v_accvgpr_write_b32 a219, v97
    v_perm_b32 v96, v57, v56, s35
    v_accvgpr_write_b32 a220, v96
    v_perm_b32 v97, v59, v58, s35
    v_accvgpr_write_b32 a221, v97
    v_perm_b32 v96, v61, v60, s35
    v_accvgpr_write_b32 a222, v96
    v_perm_b32 v97, v63, v62, s35
    v_accvgpr_write_b32 a223, v97
    s_waitcnt vmcnt(0)
    v_perm_b32 v96, v65, v64, s34
    v_accvgpr_write_b32 a224, v96
    v_perm_b32 v97, v67, v66, s34
    v_accvgpr_write_b32 a225, v97
    v_perm_b32 v96, v69, v68, s34
    v_accvgpr_write_b32 a226, v96
    v_perm_b32 v97, v71, v70, s34
    v_accvgpr_write_b32 a227, v97
    v_perm_b32 v96, v65, v64, s35
    v_accvgpr_write_b32 a228, v96
    v_perm_b32 v97, v67, v66, s35
    v_accvgpr_write_b32 a229, v97
    v_perm_b32 v96, v69, v68, s35
    v_accvgpr_write_b32 a230, v96
    v_perm_b32 v97, v71, v70, s35
    v_accvgpr_write_b32 a231, v97
    v_perm_b32 v96, v73, v72, s34
    v_accvgpr_write_b32 a232, v96
    v_perm_b32 v97, v75, v74, s34
    v_accvgpr_write_b32 a233, v97
    v_perm_b32 v96, v77, v76, s34
    v_accvgpr_write_b32 a234, v96
    v_perm_b32 v97, v79, v78, s34
    v_accvgpr_write_b32 a235, v97
    v_perm_b32 v96, v73, v72, s35
    v_accvgpr_write_b32 a236, v96
    v_perm_b32 v97, v75, v74, s35
    v_accvgpr_write_b32 a237, v97
    v_perm_b32 v96, v77, v76, s35
    v_accvgpr_write_b32 a238, v96
    v_perm_b32 v97, v79, v78, s35
    v_accvgpr_write_b32 a239, v97
    v_perm_b32 v96, v81, v80, s34
    v_accvgpr_write_b32 a240, v96
    v_perm_b32 v97, v83, v82, s34
    v_accvgpr_write_b32 a241, v97
    v_perm_b32 v96, v85, v84, s34
    v_accvgpr_write_b32 a242, v96
    v_perm_b32 v97, v87, v86, s34
    v_accvgpr_write_b32 a243, v97
    v_perm_b32 v96, v81, v80, s35
    v_accvgpr_write_b32 a244, v96
    v_perm_b32 v97, v83, v82, s35
    v_accvgpr_write_b32 a245, v97
    v_perm_b32 v96, v85, v84, s35
    v_accvgpr_write_b32 a246, v96
    v_perm_b32 v97, v87, v86, s35
    v_accvgpr_write_b32 a247, v97
    v_perm_b32 v96, v89, v88, s34
    v_accvgpr_write_b32 a248, v96
    v_perm_b32 v97, v91, v90, s34
    v_accvgpr_write_b32 a249, v97
    v_perm_b32 v96, v93, v92, s34
    v_accvgpr_write_b32 a250, v96
    v_perm_b32 v97, v95, v94, s34
    v_accvgpr_write_b32 a251, v97
    v_perm_b32 v96, v89, v88, s35
    v_accvgpr_write_b32 a252, v96
    v_perm_b32 v97, v91, v90, s35
    v_accvgpr_write_b32 a253, v97
    v_perm_b32 v96, v93, v92, s35
    v_accvgpr_write_b32 a254, v96
    v_perm_b32 v97, v95, v94, s35
    v_accvgpr_write_b32 a255, v97
    v_lshlrev_b32 v5, 4, v1
    s_mov_b32 s27, s21
    s_lshl_b32 s26, s23, 10
    s_add_u32 s26, s26, 62914560
    s_mov_b32 s28, 0
    s_lshl_b32 s29, s22, 11
    v_lshlrev_b32 v6, 4, v3
    v_add_u32 v6, s24, v6
    v_lshlrev_b32 v7, 1, v6
    s_mov_b32 s31, 5120
    buffer_load_dwordx4 v[8:11], v7, s[12:15], s31 offen sc1
    buffer_load_dwordx4 v[12:15], v7, s[12:15], s31 offen offset:16 sc1
    s_mov_b32 s31, 1280
    v_mul_lo_u32 v7, v2, s31
    v_add_u32 v6, v6, v7
L_mwo_loop:
    s_mul_i32 s38, s27, 20480
    s_cmp_eq_u32 s22, 0
    s_cbranch_scc0 L_mwo_nores
    buffer_load_dwordx4 v[160:163], v6, s[8:11], s38 offen
L_mwo_nores:
    s_lshl_b32 s40, s27, 2
    s_lshl_b32 s41, s20, 9
    s_add_u32 s41, s41, s40
    s_add_u32 s41, s41, 116523008
    s_cmp_eq_u32 s22, 1
    s_cbranch_scc0 L_wgw_46
    s_mov_b32 s98, 0
    v_mov_b32 v250, 0
L_wait_47:
    buffer_load_dword v251, v250, s[12:15], s41 offen sc1
    s_waitcnt vmcnt(0)
    v_readfirstlane_b32 s99, v251
    s_cmp_ge_u32 s99, 8
    s_cbranch_scc1 L_ok_48
    s_sleep 1
    s_add_u32 s98, s98, 1
    s_cmp_lt_u32 s98, 1048576
    s_cbranch_scc1 L_wait_47
    s_branch L_mega_done
L_ok_48:
L_wgw_46:
    s_barrier
    s_lshl_b32 s36, s27, 17
    s_add_u32 s36, s36, s26
    buffer_load_dwordx4 v[32:35], v5, s[12:15], s36 offen offset:0 sc1
    buffer_load_dwordx4 v[36:39], v5, s[12:15], s36 offen offset:1024 sc1
    buffer_load_dwordx4 v[40:43], v5, s[12:15], s36 offen offset:2048 sc1
    buffer_load_dwordx4 v[44:47], v5, s[12:15], s36 offen offset:3072 sc1
    s_add_u32 s36, s36, 4096
    buffer_load_dwordx4 v[48:51], v5, s[12:15], s36 offen offset:0 sc1
    buffer_load_dwordx4 v[52:55], v5, s[12:15], s36 offen offset:1024 sc1
    buffer_load_dwordx4 v[56:59], v5, s[12:15], s36 offen offset:2048 sc1
    buffer_load_dwordx4 v[60:63], v5, s[12:15], s36 offen offset:3072 sc1
    s_add_u32 s36, s36, 4096
    buffer_load_dwordx4 v[64:67], v5, s[12:15], s36 offen offset:0 sc1
    buffer_load_dwordx4 v[68:71], v5, s[12:15], s36 offen offset:1024 sc1
    buffer_load_dwordx4 v[72:75], v5, s[12:15], s36 offen offset:2048 sc1
    buffer_load_dwordx4 v[76:79], v5, s[12:15], s36 offen offset:3072 sc1
    s_add_u32 s36, s36, 4096
    buffer_load_dwordx4 v[80:83], v5, s[12:15], s36 offen offset:0 sc1
    buffer_load_dwordx4 v[84:87], v5, s[12:15], s36 offen offset:1024 sc1
    buffer_load_dwordx4 v[88:91], v5, s[12:15], s36 offen offset:2048 sc1
    buffer_load_dwordx4 v[92:95], v5, s[12:15], s36 offen offset:3072 sc1
    s_add_u32 s36, s36, 4096
    buffer_load_dwordx4 v[96:99], v5, s[12:15], s36 offen offset:0 sc1
    buffer_load_dwordx4 v[100:103], v5, s[12:15], s36 offen offset:1024 sc1
    buffer_load_dwordx4 v[104:107], v5, s[12:15], s36 offen offset:2048 sc1
    buffer_load_dwordx4 v[108:111], v5, s[12:15], s36 offen offset:3072 sc1
    s_add_u32 s36, s36, 4096
    buffer_load_dwordx4 v[112:115], v5, s[12:15], s36 offen offset:0 sc1
    buffer_load_dwordx4 v[116:119], v5, s[12:15], s36 offen offset:1024 sc1
    buffer_load_dwordx4 v[120:123], v5, s[12:15], s36 offen offset:2048 sc1
    buffer_load_dwordx4 v[124:127], v5, s[12:15], s36 offen offset:3072 sc1
    s_add_u32 s36, s36, 4096
    buffer_load_dwordx4 v[128:131], v5, s[12:15], s36 offen offset:0 sc1
    buffer_load_dwordx4 v[132:135], v5, s[12:15], s36 offen offset:1024 sc1
    buffer_load_dwordx4 v[136:139], v5, s[12:15], s36 offen offset:2048 sc1
    buffer_load_dwordx4 v[140:143], v5, s[12:15], s36 offen offset:3072 sc1
    s_add_u32 s36, s36, 4096
    buffer_load_dwordx4 v[144:147], v5, s[12:15], s36 offen offset:0 sc1
    buffer_load_dwordx4 v[148:151], v5, s[12:15], s36 offen offset:1024 sc1
    buffer_load_dwordx4 v[152:155], v5, s[12:15], s36 offen offset:2048 sc1
    buffer_load_dwordx4 v[156:159], v5, s[12:15], s36 offen offset:3072 sc1
    s_waitcnt vmcnt(31)
    v_mfma_f32_16x16x32_bf16 v[16:19], a[0:3], v[32:35], 0
    v_mfma_f32_16x16x32_bf16 v[20:23], a[4:7], v[32:35], 0
    s_waitcnt vmcnt(30)
    v_mfma_f32_16x16x32_bf16 v[16:19], a[8:11], v[36:39], v[16:19]
    v_mfma_f32_16x16x32_bf16 v[20:23], a[12:15], v[36:39], v[20:23]
    s_waitcnt vmcnt(29)
    v_mfma_f32_16x16x32_bf16 v[16:19], a[16:19], v[40:43], v[16:19]
    v_mfma_f32_16x16x32_bf16 v[20:23], a[20:23], v[40:43], v[20:23]
    s_waitcnt vmcnt(28)
    v_mfma_f32_16x16x32_bf16 v[16:19], a[24:27], v[44:47], v[16:19]
    v_mfma_f32_16x16x32_bf16 v[20:23], a[28:31], v[44:47], v[20:23]
    s_waitcnt vmcnt(27)
    v_mfma_f32_16x16x32_bf16 v[16:19], a[32:35], v[48:51], v[16:19]
    v_mfma_f32_16x16x32_bf16 v[20:23], a[36:39], v[48:51], v[20:23]
    s_waitcnt vmcnt(26)
    v_mfma_f32_16x16x32_bf16 v[16:19], a[40:43], v[52:55], v[16:19]
    v_mfma_f32_16x16x32_bf16 v[20:23], a[44:47], v[52:55], v[20:23]
    s_waitcnt vmcnt(25)
    v_mfma_f32_16x16x32_bf16 v[16:19], a[48:51], v[56:59], v[16:19]
    v_mfma_f32_16x16x32_bf16 v[20:23], a[52:55], v[56:59], v[20:23]
    s_waitcnt vmcnt(24)
    v_mfma_f32_16x16x32_bf16 v[16:19], a[56:59], v[60:63], v[16:19]
    v_mfma_f32_16x16x32_bf16 v[20:23], a[60:63], v[60:63], v[20:23]
    s_waitcnt vmcnt(23)
    v_mfma_f32_16x16x32_bf16 v[16:19], a[64:67], v[64:67], v[16:19]
    v_mfma_f32_16x16x32_bf16 v[20:23], a[68:71], v[64:67], v[20:23]
    s_waitcnt vmcnt(22)
    v_mfma_f32_16x16x32_bf16 v[16:19], a[72:75], v[68:71], v[16:19]
    v_mfma_f32_16x16x32_bf16 v[20:23], a[76:79], v[68:71], v[20:23]
    s_waitcnt vmcnt(21)
    v_mfma_f32_16x16x32_bf16 v[16:19], a[80:83], v[72:75], v[16:19]
    v_mfma_f32_16x16x32_bf16 v[20:23], a[84:87], v[72:75], v[20:23]
    s_waitcnt vmcnt(20)
    v_mfma_f32_16x16x32_bf16 v[16:19], a[88:91], v[76:79], v[16:19]
    v_mfma_f32_16x16x32_bf16 v[20:23], a[92:95], v[76:79], v[20:23]
    s_waitcnt vmcnt(19)
    v_mfma_f32_16x16x32_bf16 v[16:19], a[96:99], v[80:83], v[16:19]
    v_mfma_f32_16x16x32_bf16 v[20:23], a[100:103], v[80:83], v[20:23]
    s_waitcnt vmcnt(18)
    v_mfma_f32_16x16x32_bf16 v[16:19], a[104:107], v[84:87], v[16:19]
    v_mfma_f32_16x16x32_bf16 v[20:23], a[108:111], v[84:87], v[20:23]
    s_waitcnt vmcnt(17)
    v_mfma_f32_16x16x32_bf16 v[16:19], a[112:115], v[88:91], v[16:19]
    v_mfma_f32_16x16x32_bf16 v[20:23], a[116:119], v[88:91], v[20:23]
    s_waitcnt vmcnt(16)
    v_mfma_f32_16x16x32_bf16 v[16:19], a[120:123], v[92:95], v[16:19]
    v_mfma_f32_16x16x32_bf16 v[20:23], a[124:127], v[92:95], v[20:23]
    s_waitcnt vmcnt(15)
    v_mfma_f32_16x16x32_bf16 v[16:19], a[128:131], v[96:99], v[16:19]
    v_mfma_f32_16x16x32_bf16 v[20:23], a[132:135], v[96:99], v[20:23]
    s_waitcnt vmcnt(14)
    v_mfma_f32_16x16x32_bf16 v[16:19], a[136:139], v[100:103], v[16:19]
    v_mfma_f32_16x16x32_bf16 v[20:23], a[140:143], v[100:103], v[20:23]
    s_waitcnt vmcnt(13)
    v_mfma_f32_16x16x32_bf16 v[16:19], a[144:147], v[104:107], v[16:19]
    v_mfma_f32_16x16x32_bf16 v[20:23], a[148:151], v[104:107], v[20:23]
    s_waitcnt vmcnt(12)
    v_mfma_f32_16x16x32_bf16 v[16:19], a[152:155], v[108:111], v[16:19]
    v_mfma_f32_16x16x32_bf16 v[20:23], a[156:159], v[108:111], v[20:23]
    s_waitcnt vmcnt(11)
    v_mfma_f32_16x16x32_bf16 v[16:19], a[160:163], v[112:115], v[16:19]
    v_mfma_f32_16x16x32_bf16 v[20:23], a[164:167], v[112:115], v[20:23]
    s_waitcnt vmcnt(10)
    v_mfma_f32_16x16x32_bf16 v[16:19], a[168:171], v[116:119], v[16:19]
    v_mfma_f32_16x16x32_bf16 v[20:23], a[172:175], v[116:119], v[20:23]
    s_waitcnt vmcnt(9)
    v_mfma_f32_16x16x32_bf16 v[16:19], a[176:179], v[120:123], v[16:19]
    v_mfma_f32_16x16x32_bf16 v[20:23], a[180:183], v[120:123], v[20:23]
    s_waitcnt vmcnt(8)
    v_mfma_f32_16x16x32_bf16 v[16:19], a[184:187], v[124:127], v[16:19]
    v_mfma_f32_16x16x32_bf16 v[20:23], a[188:191], v[124:127], v[20:23]
    s_waitcnt vmcnt(7)
    v_mfma_f32_16x16x32_bf16 v[16:19], a[192:195], v[128:131], v[16:19]
    v_mfma_f32_16x16x32_bf16 v[20:23], a[196:199], v[128:131], v[20:23]
    s_waitcnt vmcnt(6)
    v_mfma_f32_16x16x32_bf16 v[16:19], a[200:203], v[132:135], v[16:19]
    v_mfma_f32_16x16x32_bf16 v[20:23], a[204:207], v[132:135], v[20:23]
    s_waitcnt vmcnt(5)
    v_mfma_f32_16x16x32_bf16 v[16:19], a[208:211], v[136:139], v[16:19]
    v_mfma_f32_16x16x32_bf16 v[20:23], a[212:215], v[136:139], v[20:23]
    s_waitcnt vmcnt(4)
    v_mfma_f32_16x16x32_bf16 v[16:19], a[216:219], v[140:143], v[16:19]
    v_mfma_f32_16x16x32_bf16 v[20:23], a[220:223], v[140:143], v[20:23]
    s_waitcnt vmcnt(3)
    v_mfma_f32_16x16x32_bf16 v[16:19], a[224:227], v[144:147], v[16:19]
    v_mfma_f32_16x16x32_bf16 v[20:23], a[228:231], v[144:147], v[20:23]
    s_waitcnt vmcnt(2)
    v_mfma_f32_16x16x32_bf16 v[16:19], a[232:235], v[148:151], v[16:19]
    v_mfma_f32_16x16x32_bf16 v[20:23], a[236:239], v[148:151], v[20:23]
    s_waitcnt vmcnt(1)
    v_mfma_f32_16x16x32_bf16 v[16:19], a[240:243], v[152:155], v[16:19]
    v_mfma_f32_16x16x32_bf16 v[20:23], a[244:247], v[152:155], v[20:23]
    s_waitcnt vmcnt(0)
    v_mfma_f32_16x16x32_bf16 v[16:19], a[248:251], v[156:159], v[16:19]
    v_mfma_f32_16x16x32_bf16 v[20:23], a[252:255], v[156:159], v[20:23]
    s_add_u32 s31, s28, s29
    v_add_u32 v7, s31, v5
    s_nop 1
    ds_write_b128 v7, v[16:19]
    s_nop 2
    ds_write_b128 v7, v[20:23] offset:1024
    s_waitcnt lgkmcnt(0)
    s_barrier
    s_cmp_eq_u32 s22, 0
    s_cbranch_scc0 L_mwo_next
    v_add_u32 v7, s28, v5
    ds_read_b128 v[32:35], v7 offset:0
    ds_read_b128 v[36:39], v7 offset:1024
    ds_read_b128 v[40:43], v7 offset:2048
    ds_read_b128 v[44:47], v7 offset:3072
    ds_read_b128 v[48:51], v7 offset:4096
    ds_read_b128 v[52:55], v7 offset:5120
    ds_read_b128 v[56:59], v7 offset:6144
    ds_read_b128 v[60:63], v7 offset:7168
    s_waitcnt lgkmcnt(0)
    v_add_f32 v32, v32, v40
    v_add_f32 v33, v33, v41
    v_add_f32 v34, v34, v42
    v_add_f32 v35, v35, v43
    v_add_f32 v36, v36, v44
    v_add_f32 v37, v37, v45
    v_add_f32 v38, v38, v46
    v_add_f32 v39, v39, v47
    v_add_f32 v32, v32, v48
    v_add_f32 v33, v33, v49
    v_add_f32 v34, v34, v50
    v_add_f32 v35, v35, v51
    v_add_f32 v36, v36, v52
    v_add_f32 v37, v37, v53
    v_add_f32 v38, v38, v54
    v_add_f32 v39, v39, v55
    v_add_f32 v32, v32, v56
    v_add_f32 v33, v33, v57
    v_add_f32 v34, v34, v58
    v_add_f32 v35, v35, v59
    v_add_f32 v36, v36, v60
    v_add_f32 v37, v37, v61
    v_add_f32 v38, v38, v62
    v_add_f32 v39, v39, v63
    v_cvt_pk_bf16_f32 v64, v32, v36
    v_lshlrev_b32 v32, 16, v64
    v_and_b32 v36, 0xffff0000, v64
    v_mul_f32 v32, v32, v8
    v_mul_f32 v36, v36, v9
    v_cvt_pk_bf16_f32 v64, v32, v36
    v_lshlrev_b32 v32, 16, v64
    v_and_b32 v36, 0xffff0000, v64
    v_lshlrev_b32 v64, 16, v160
    v_and_b32 v65, 0xffff0000, v160
    v_add_f32 v32, v32, v64
    v_add_f32 v36, v36, v65
    v_cvt_pk_bf16_f32 v68, v32, v36
    v_cvt_pk_bf16_f32 v64, v33, v37
    v_lshlrev_b32 v33, 16, v64
    v_and_b32 v37, 0xffff0000, v64
    v_mul_f32 v33, v33, v10
    v_mul_f32 v37, v37, v11
    v_cvt_pk_bf16_f32 v64, v33, v37
    v_lshlrev_b32 v33, 16, v64
    v_and_b32 v37, 0xffff0000, v64
    v_lshlrev_b32 v64, 16, v161
    v_and_b32 v65, 0xffff0000, v161
    v_add_f32 v33, v33, v64
    v_add_f32 v37, v37, v65
    v_cvt_pk_bf16_f32 v69, v33, v37
    v_cvt_pk_bf16_f32 v64, v34, v38
    v_lshlrev_b32 v34, 16, v64
    v_and_b32 v38, 0xffff0000, v64
    v_mul_f32 v34, v34, v12
    v_mul_f32 v38, v38, v13
    v_cvt_pk_bf16_f32 v64, v34, v38
    v_lshlrev_b32 v34, 16, v64
    v_and_b32 v38, 0xffff0000, v64
    v_lshlrev_b32 v64, 16, v162
    v_and_b32 v65, 0xffff0000, v162
    v_add_f32 v34, v34, v64
    v_add_f32 v38, v38, v65
    v_cvt_pk_bf16_f32 v70, v34, v38
    v_cvt_pk_bf16_f32 v64, v35, v39
    v_lshlrev_b32 v35, 16, v64
    v_and_b32 v39, 0xffff0000, v64
    v_mul_f32 v35, v35, v14
    v_mul_f32 v39, v39, v15
    v_cvt_pk_bf16_f32 v64, v35, v39
    v_lshlrev_b32 v35, 16, v64
    v_and_b32 v39, 0xffff0000, v64
    v_lshlrev_b32 v64, 16, v163
    v_and_b32 v65, 0xffff0000, v163
    v_add_f32 v35, v35, v64
    v_add_f32 v39, v39, v65
    v_cvt_pk_bf16_f32 v71, v35, v39
    s_add_u32 s39, s38, 79691776
    buffer_store_dwordx4 v[68:71], v6, s[12:15], s39 offen sc1
    s_add_u32 s41, s40, 116533248
    v_lshlrev_b32 v250, 9, v1
    v_mov_b32 v251, 1
    s_mov_b32 exec_lo, 16383
    s_mov_b32 exec_hi, 0
    s_waitcnt vmcnt(0)
    buffer_atomic_add v251, v250, s[12:15], s41 offen sc1
    s_mov_b64 exec, -1
L_mwo_next:
    s_xor_b32 s28, s28, 8192
    s_cmp_lt_u32 s27, 24
    s_cselect_b32 s25, 3, 4
    s_add_u32 s27, s27, s25
    s_cmp_lt_u32 s27, 128
    s_cbranch_scc1 L_mwo_loop
    s_branch L_mega_done
L_mega_up:
    s_sub_u32 s24, s2, 124
    s_mov_b32 s20, 306783379
    s_mul_hi_u32 s21, s24, s20
    s_mul_i32 s20, s21, 14
    s_sub_u32 s20, s24, s20
L_mega_up2:
    s_load_dwordx2 s[4:5], s[0:1], 64
    s_load_dwordx2 s[8:9], s[0:1], 72
    s_lshl_b32 s23, s20, 2
    s_add_u32 s23, s23, s25
    s_min_u32 s23, s23, 53
    s_waitcnt lgkmcnt(0)
    s_mov_b32 s6, 2211840
    s_mov_b32 s7, 0x00020000
    s_mov_b32 s10, 2211840
    s_mov_b32 s11, 0x00020000
    s_mov_b32 s24, 27648
    v_mul_lo_u32 v4, v3, s24
    v_lshl_add_u32 v4, v2, 2, v4
    s_lshl_b32 s24, s23, 6
    v_add_u32 v4, s24, v4
    v_lshlrev_b32 v5, 4, v1
    s_mov_b32 s32, 0
    s_mov_b32 s34, 0x05040100
    s_mov_b32 s35, 0x07060302
    buffer_load_dword v32, v4, s[4:7], s32 offen
    s_add_u32 s32, s32, 3456
    buffer_load_dword v33, v4, s[4:7], s32 offen
    s_add_u32 s32, s32, 3456
    buffer_load_dword v34, v4, s[4:7], s32 offen
    s_add_u32 s32, s32, 3456
    buffer_load_dword v35, v4, s[4:7], s32 offen
    s_add_u32 s32, s32, 3456
    buffer_load_dword v36, v4, s[4:7], s32 offen
    s_add_u32 s32, s32, 3456
    buffer_load_dword v37, v4, s[4:7], s32 offen
    s_add_u32 s32, s32, 3456
    buffer_load_dword v38, v4, s[4:7], s32 offen
    s_add_u32 s32, s32, 3456
    buffer_load_dword v39, v4, s[4:7], s32 offen
    s_add_u32 s32, s32, 86400
    buffer_load_dword v40, v4, s[4:7], s32 offen
    s_add_u32 s32, s32, 3456
    buffer_load_dword v41, v4, s[4:7], s32 offen
    s_add_u32 s32, s32, 3456
    buffer_load_dword v42, v4, s[4:7], s32 offen
    s_add_u32 s32, s32, 3456
    buffer_load_dword v43, v4, s[4:7], s32 offen
    s_add_u32 s32, s32, 3456
    buffer_load_dword v44, v4, s[4:7], s32 offen
    s_add_u32 s32, s32, 3456
    buffer_load_dword v45, v4, s[4:7], s32 offen
    s_add_u32 s32, s32, 3456
    buffer_load_dword v46, v4, s[4:7], s32 offen
    s_add_u32 s32, s32, 3456
    buffer_load_dword v47, v4, s[4:7], s32 offen
    s_add_u32 s32, s32, 86400
    buffer_load_dword v48, v4, s[4:7], s32 offen
    s_add_u32 s32, s32, 3456
    buffer_load_dword v49, v4, s[4:7], s32 offen
    s_add_u32 s32, s32, 3456
    buffer_load_dword v50, v4, s[4:7], s32 offen
    s_add_u32 s32, s32, 3456
    buffer_load_dword v51, v4, s[4:7], s32 offen
    s_add_u32 s32, s32, 3456
    buffer_load_dword v52, v4, s[4:7], s32 offen
    s_add_u32 s32, s32, 3456
    buffer_load_dword v53, v4, s[4:7], s32 offen
    s_add_u32 s32, s32, 3456
    buffer_load_dword v54, v4, s[4:7], s32 offen
    s_add_u32 s32, s32, 3456
    buffer_load_dword v55, v4, s[4:7], s32 offen
    s_add_u32 s32, s32, 86400
    buffer_load_dword v56, v4, s[4:7], s32 offen
    s_add_u32 s32, s32, 3456
    buffer_load_dword v57, v4, s[4:7], s32 offen
    s_add_u32 s32, s32, 3456
    buffer_load_dword v58, v4, s[4:7], s32 offen
    s_add_u32 s32, s32, 3456
    buffer_load_dword v59, v4, s[4:7], s32 offen
    s_add_u32 s32, s32, 3456
    buffer_load_dword v60, v4, s[4:7], s32 offen
    s_add_u32 s32, s32, 3456
    buffer_load_dword v61, v4, s[4:7], s32 offen
    s_add_u32 s32, s32, 3456
    buffer_load_dword v62, v4, s[4:7], s32 offen
    s_add_u32 s32, s32, 3456
    buffer_load_dword v63, v4, s[4:7], s32 offen
    s_add_u32 s32, s32, 86400
    buffer_load_dword v64, v4, s[4:7], s32 offen
    s_add_u32 s32, s32, 3456
    buffer_load_dword v65, v4, s[4:7], s32 offen
    s_add_u32 s32, s32, 3456
    buffer_load_dword v66, v4, s[4:7], s32 offen
    s_add_u32 s32, s32, 3456
    buffer_load_dword v67, v4, s[4:7], s32 offen
    s_add_u32 s32, s32, 3456
    buffer_load_dword v68, v4, s[4:7], s32 offen
    s_add_u32 s32, s32, 3456
    buffer_load_dword v69, v4, s[4:7], s32 offen
    s_add_u32 s32, s32, 3456
    buffer_load_dword v70, v4, s[4:7], s32 offen
    s_add_u32 s32, s32, 3456
    buffer_load_dword v71, v4, s[4:7], s32 offen
    s_add_u32 s32, s32, 86400
    buffer_load_dword v72, v4, s[4:7], s32 offen
    s_add_u32 s32, s32, 3456
    buffer_load_dword v73, v4, s[4:7], s32 offen
    s_add_u32 s32, s32, 3456
    buffer_load_dword v74, v4, s[4:7], s32 offen
    s_add_u32 s32, s32, 3456
    buffer_load_dword v75, v4, s[4:7], s32 offen
    s_add_u32 s32, s32, 3456
    buffer_load_dword v76, v4, s[4:7], s32 offen
    s_add_u32 s32, s32, 3456
    buffer_load_dword v77, v4, s[4:7], s32 offen
    s_add_u32 s32, s32, 3456
    buffer_load_dword v78, v4, s[4:7], s32 offen
    s_add_u32 s32, s32, 3456
    buffer_load_dword v79, v4, s[4:7], s32 offen
    s_add_u32 s32, s32, 86400
    buffer_load_dword v80, v4, s[4:7], s32 offen
    s_add_u32 s32, s32, 3456
    buffer_load_dword v81, v4, s[4:7], s32 offen
    s_add_u32 s32, s32, 3456
    buffer_load_dword v82, v4, s[4:7], s32 offen
    s_add_u32 s32, s32, 3456
    buffer_load_dword v83, v4, s[4:7], s32 offen
    s_add_u32 s32, s32, 3456
    buffer_load_dword v84, v4, s[4:7], s32 offen
    s_add_u32 s32, s32, 3456
    buffer_load_dword v85, v4, s[4:7], s32 offen
    s_add_u32 s32, s32, 3456
    buffer_load_dword v86, v4, s[4:7], s32 offen
    s_add_u32 s32, s32, 3456
    buffer_load_dword v87, v4, s[4:7], s32 offen
    s_add_u32 s32, s32, 86400
    buffer_load_dword v88, v4, s[4:7], s32 offen
    s_add_u32 s32, s32, 3456
    buffer_load_dword v89, v4, s[4:7], s32 offen
    s_add_u32 s32, s32, 3456
    buffer_load_dword v90, v4, s[4:7], s32 offen
    s_add_u32 s32, s32, 3456
    buffer_load_dword v91, v4, s[4:7], s32 offen
    s_add_u32 s32, s32, 3456
    buffer_load_dword v92, v4, s[4:7], s32 offen
    s_add_u32 s32, s32, 3456
    buffer_load_dword v93, v4, s[4:7], s32 offen
    s_add_u32 s32, s32, 3456
    buffer_load_dword v94, v4, s[4:7], s32 offen
    s_add_u32 s32, s32, 3456
    buffer_load_dword v95, v4, s[4:7], s32 offen
    s_add_u32 s32, s32, 86400
    s_waitcnt vmcnt(32)
    v_perm_b32 v96, v33, v32, s34
    v_accvgpr_write_b32 a0, v96
    v_perm_b32 v97, v35, v34, s34
    v_accvgpr_write_b32 a1, v97
    v_perm_b32 v96, v37, v36, s34
    v_accvgpr_write_b32 a2, v96
    v_perm_b32 v97, v39, v38, s34
    v_accvgpr_write_b32 a3, v97
    v_perm_b32 v96, v33, v32, s35
    v_accvgpr_write_b32 a4, v96
    v_perm_b32 v97, v35, v34, s35
    v_accvgpr_write_b32 a5, v97
    v_perm_b32 v96, v37, v36, s35
    v_accvgpr_write_b32 a6, v96
    v_perm_b32 v97, v39, v38, s35
    v_accvgpr_write_b32 a7, v97
    v_perm_b32 v96, v41, v40, s34
    v_accvgpr_write_b32 a16, v96
    v_perm_b32 v97, v43, v42, s34
    v_accvgpr_write_b32 a17, v97
    v_perm_b32 v96, v45, v44, s34
    v_accvgpr_write_b32 a18, v96
    v_perm_b32 v97, v47, v46, s34
    v_accvgpr_write_b32 a19, v97
    v_perm_b32 v96, v41, v40, s35
    v_accvgpr_write_b32 a20, v96
    v_perm_b32 v97, v43, v42, s35
    v_accvgpr_write_b32 a21, v97
    v_perm_b32 v96, v45, v44, s35
    v_accvgpr_write_b32 a22, v96
    v_perm_b32 v97, v47, v46, s35
    v_accvgpr_write_b32 a23, v97
    v_perm_b32 v96, v49, v48, s34
    v_accvgpr_write_b32 a32, v96
    v_perm_b32 v97, v51, v50, s34
    v_accvgpr_write_b32 a33, v97
    v_perm_b32 v96, v53, v52, s34
    v_accvgpr_write_b32 a34, v96
    v_perm_b32 v97, v55, v54, s34
    v_accvgpr_write_b32 a35, v97
    v_perm_b32 v96, v49, v48, s35
    v_accvgpr_write_b32 a36, v96
    v_perm_b32 v97, v51, v50, s35
    v_accvgpr_write_b32 a37, v97
    v_perm_b32 v96, v53, v52, s35
    v_accvgpr_write_b32 a38, v96
    v_perm_b32 v97, v55, v54, s35
    v_accvgpr_write_b32 a39, v97
    v_perm_b32 v96, v57, v56, s34
    v_accvgpr_write_b32 a48, v96
    v_perm_b32 v97, v59, v58, s34
    v_accvgpr_write_b32 a49, v97
    v_perm_b32 v96, v61, v60, s34
    v_accvgpr_write_b32 a50, v96
    v_perm_b32 v97, v63, v62, s34
    v_accvgpr_write_b32 a51, v97
    v_perm_b32 v96, v57, v56, s35
    v_accvgpr_write_b32 a52, v96
    v_perm_b32 v97, v59, v58, s35
    v_accvgpr_write_b32 a53, v97
    v_perm_b32 v96, v61, v60, s35
    v_accvgpr_write_b32 a54, v96
    v_perm_b32 v97, v63, v62, s35
    v_accvgpr_write_b32 a55, v97
    buffer_load_dword v32, v4, s[4:7], s32 offen
    s_add_u32 s32, s32, 3456
    buffer_load_dword v33, v4, s[4:7], s32 offen
    s_add_u32 s32, s32, 3456
    buffer_load_dword v34, v4, s[4:7], s32 offen
    s_add_u32 s32, s32, 3456
    buffer_load_dword v35, v4, s[4:7], s32 offen
    s_add_u32 s32, s32, 3456
    buffer_load_dword v36, v4, s[4:7], s32 offen
    s_add_u32 s32, s32, 3456
    buffer_load_dword v37, v4, s[4:7], s32 offen
    s_add_u32 s32, s32, 3456
    buffer_load_dword v38, v4, s[4:7], s32 offen
    s_add_u32 s32, s32, 3456
    buffer_load_dword v39, v4, s[4:7], s32 offen
    s_add_u32 s32, s32, 86400
    buffer_load_dword v40, v4, s[4:7], s32 offen
    s_add_u32 s32, s32, 3456
    buffer_load_dword v41, v4, s[4:7], s32 offen
    s_add_u32 s32, s32, 3456
    buffer_load_dword v42, v4, s[4:7], s32 offen
    s_add_u32 s32, s32, 3456
    buffer_load_dword v43, v4, s[4:7], s32 offen
    s_add_u32 s32, s32, 3456
    buffer_load_dword v44, v4, s[4:7], s32 offen
    s_add_u32 s32, s32, 3456
    buffer_load_dword v45, v4, s[4:7], s32 offen
    s_add_u32 s32, s32, 3456
    buffer_load_dword v46, v4, s[4:7], s32 offen
    s_add_u32 s32, s32, 3456
    buffer_load_dword v47, v4, s[4:7], s32 offen
    s_add_u32 s32, s32, 86400
    buffer_load_dword v48, v4, s[4:7], s32 offen
    s_add_u32 s32, s32, 3456
    buffer_load_dword v49, v4, s[4:7], s32 offen
    s_add_u32 s32, s32, 3456
    buffer_load_dword v50, v4, s[4:7], s32 offen
    s_add_u32 s32, s32, 3456
    buffer_load_dword v51, v4, s[4:7], s32 offen
    s_add_u32 s32, s32, 3456
    buffer_load_dword v52, v4, s[4:7], s32 offen
    s_add_u32 s32, s32, 3456
    buffer_load_dword v53, v4, s[4:7], s32 offen
    s_add_u32 s32, s32, 3456
    buffer_load_dword v54, v4, s[4:7], s32 offen
    s_add_u32 s32, s32, 3456
    buffer_load_dword v55, v4, s[4:7], s32 offen
    s_add_u32 s32, s32, 86400
    buffer_load_dword v56, v4, s[4:7], s32 offen
    s_add_u32 s32, s32, 3456
    buffer_load_dword v57, v4, s[4:7], s32 offen
    s_add_u32 s32, s32, 3456
    buffer_load_dword v58, v4, s[4:7], s32 offen
    s_add_u32 s32, s32, 3456
    buffer_load_dword v59, v4, s[4:7], s32 offen
    s_add_u32 s32, s32, 3456
    buffer_load_dword v60, v4, s[4:7], s32 offen
    s_add_u32 s32, s32, 3456
    buffer_load_dword v61, v4, s[4:7], s32 offen
    s_add_u32 s32, s32, 3456
    buffer_load_dword v62, v4, s[4:7], s32 offen
    s_add_u32 s32, s32, 3456
    buffer_load_dword v63, v4, s[4:7], s32 offen
    s_add_u32 s32, s32, 86400
    s_waitcnt vmcnt(32)
    v_perm_b32 v96, v65, v64, s34
    v_accvgpr_write_b32 a64, v96
    v_perm_b32 v97, v67, v66, s34
    v_accvgpr_write_b32 a65, v97
    v_perm_b32 v96, v69, v68, s34
    v_accvgpr_write_b32 a66, v96
    v_perm_b32 v97, v71, v70, s34
    v_accvgpr_write_b32 a67, v97
    v_perm_b32 v96, v65, v64, s35
    v_accvgpr_write_b32 a68, v96
    v_perm_b32 v97, v67, v66, s35
    v_accvgpr_write_b32 a69, v97
    v_perm_b32 v96, v69, v68, s35
    v_accvgpr_write_b32 a70, v96
    v_perm_b32 v97, v71, v70, s35
    v_accvgpr_write_b32 a71, v97
    v_perm_b32 v96, v73, v72, s34
    v_accvgpr_write_b32 a80, v96
    v_perm_b32 v97, v75, v74, s34
    v_accvgpr_write_b32 a81, v97
    v_perm_b32 v96, v77, v76, s34
    v_accvgpr_write_b32 a82, v96
    v_perm_b32 v97, v79, v78, s34
    v_accvgpr_write_b32 a83, v97
    v_perm_b32 v96, v73, v72, s35
    v_accvgpr_write_b32 a84, v96
    v_perm_b32 v97, v75, v74, s35
    v_accvgpr_write_b32 a85, v97
    v_perm_b32 v96, v77, v76, s35
    v_accvgpr_write_b32 a86, v96
    v_perm_b32 v97, v79, v78, s35
    v_accvgpr_write_b32 a87, v97
    v_perm_b32 v96, v81, v80, s34
    v_accvgpr_write_b32 a96, v96
    v_perm_b32 v97, v83, v82, s34
    v_accvgpr_write_b32 a97, v97
    v_perm_b32 v96, v85, v84, s34
    v_accvgpr_write_b32 a98, v96
    v_perm_b32 v97, v87, v86, s34
    v_accvgpr_write_b32 a99, v97
    v_perm_b32 v96, v81, v80, s35
    v_accvgpr_write_b32 a100, v96
    v_perm_b32 v97, v83, v82, s35
    v_accvgpr_write_b32 a101, v97
    v_perm_b32 v96, v85, v84, s35
    v_accvgpr_write_b32 a102, v96
    v_perm_b32 v97, v87, v86, s35
    v_accvgpr_write_b32 a103, v97
    v_perm_b32 v96, v89, v88, s34
    v_accvgpr_write_b32 a112, v96
    v_perm_b32 v97, v91, v90, s34
    v_accvgpr_write_b32 a113, v97
    v_perm_b32 v96, v93, v92, s34
    v_accvgpr_write_b32 a114, v96
    v_perm_b32 v97, v95, v94, s34
    v_accvgpr_write_b32 a115, v97
    v_perm_b32 v96, v89, v88, s35
    v_accvgpr_write_b32 a116, v96
    v_perm_b32 v97, v91, v90, s35
    v_accvgpr_write_b32 a117, v97
    v_perm_b32 v96, v93, v92, s35
    v_accvgpr_write_b32 a118, v96
    v_perm_b32 v97, v95, v94, s35
    v_accvgpr_write_b32 a119, v97
    buffer_load_dword v64, v4, s[4:7], s32 offen
    s_add_u32 s32, s32, 3456
    buffer_load_dword v65, v4, s[4:7], s32 offen
    s_add_u32 s32, s32, 3456
    buffer_load_dword v66, v4, s[4:7], s32 offen
    s_add_u32 s32, s32, 3456
    buffer_load_dword v67, v4, s[4:7], s32 offen
    s_add_u32 s32, s32, 3456
    buffer_load_dword v68, v4, s[4:7], s32 offen
    s_add_u32 s32, s32, 3456
    buffer_load_dword v69, v4, s[4:7], s32 offen
    s_add_u32 s32, s32, 3456
    buffer_load_dword v70, v4, s[4:7], s32 offen
    s_add_u32 s32, s32, 3456
    buffer_load_dword v71, v4, s[4:7], s32 offen
    s_add_u32 s32, s32, 86400
    buffer_load_dword v72, v4, s[4:7], s32 offen
    s_add_u32 s32, s32, 3456
    buffer_load_dword v73, v4, s[4:7], s32 offen
    s_add_u32 s32, s32, 3456
    buffer_load_dword v74, v4, s[4:7], s32 offen
    s_add_u32 s32, s32, 3456
    buffer_load_dword v75, v4, s[4:7], s32 offen
    s_add_u32 s32, s32, 3456
    buffer_load_dword v76, v4, s[4:7], s32 offen
    s_add_u32 s32, s32, 3456
    buffer_load_dword v77, v4, s[4:7], s32 offen
    s_add_u32 s32, s32, 3456
    buffer_load_dword v78, v4, s[4:7], s32 offen
    s_add_u32 s32, s32, 3456
    buffer_load_dword v79, v4, s[4:7], s32 offen
    s_add_u32 s32, s32, 86400
    buffer_load_dword v80, v4, s[4:7], s32 offen
    s_add_u32 s32, s32, 3456
    buffer_load_dword v81, v4, s[4:7], s32 offen
    s_add_u32 s32, s32, 3456
    buffer_load_dword v82, v4, s[4:7], s32 offen
    s_add_u32 s32, s32, 3456
    buffer_load_dword v83, v4, s[4:7], s32 offen
    s_add_u32 s32, s32, 3456
    buffer_load_dword v84, v4, s[4:7], s32 offen
    s_add_u32 s32, s32, 3456
    buffer_load_dword v85, v4, s[4:7], s32 offen
    s_add_u32 s32, s32, 3456
    buffer_load_dword v86, v4, s[4:7], s32 offen
    s_add_u32 s32, s32, 3456
    buffer_load_dword v87, v4, s[4:7], s32 offen
    s_add_u32 s32, s32, 86400
    buffer_load_dword v88, v4, s[4:7], s32 offen
    s_add_u32 s32, s32, 3456
    buffer_load_dword v89, v4, s[4:7], s32 offen
    s_add_u32 s32, s32, 3456
    buffer_load_dword v90, v4, s[4:7], s32 offen
    s_add_u32 s32, s32, 3456
    buffer_load_dword v91, v4, s[4:7], s32 offen
    s_add_u32 s32, s32, 3456
    buffer_load_dword v92, v4, s[4:7], s32 offen
    s_add_u32 s32, s32, 3456
    buffer_load_dword v93, v4, s[4:7], s32 offen
    s_add_u32 s32, s32, 3456
    buffer_load_dword v94, v4, s[4:7], s32 offen
    s_add_u32 s32, s32, 3456
    buffer_load_dword v95, v4, s[4:7], s32 offen
    s_add_u32 s32, s32, 86400
    s_waitcnt vmcnt(32)
    v_perm_b32 v96, v33, v32, s34
    v_accvgpr_write_b32 a128, v96
    v_perm_b32 v97, v35, v34, s34
    v_accvgpr_write_b32 a129, v97
    v_perm_b32 v96, v37, v36, s34
    v_accvgpr_write_b32 a130, v96
    v_perm_b32 v97, v39, v38, s34
    v_accvgpr_write_b32 a131, v97
    v_perm_b32 v96, v33, v32, s35
    v_accvgpr_write_b32 a132, v96
    v_perm_b32 v97, v35, v34, s35
    v_accvgpr_write_b32 a133, v97
    v_perm_b32 v96, v37, v36, s35
    v_accvgpr_write_b32 a134, v96
    v_perm_b32 v97, v39, v38, s35
    v_accvgpr_write_b32 a135, v97
    v_perm_b32 v96, v41, v40, s34
    v_accvgpr_write_b32 a144, v96
    v_perm_b32 v97, v43, v42, s34
    v_accvgpr_write_b32 a145, v97
    v_perm_b32 v96, v45, v44, s34
    v_accvgpr_write_b32 a146, v96
    v_perm_b32 v97, v47, v46, s34
    v_accvgpr_write_b32 a147, v97
    v_perm_b32 v96, v41, v40, s35
    v_accvgpr_write_b32 a148, v96
    v_perm_b32 v97, v43, v42, s35
    v_accvgpr_write_b32 a149, v97
    v_perm_b32 v96, v45, v44, s35
    v_accvgpr_write_b32 a150, v96
    v_perm_b32 v97, v47, v46, s35
    v_accvgpr_write_b32 a151, v97
    v_perm_b32 v96, v49, v48, s34
    v_accvgpr_write_b32 a160, v96
    v_perm_b32 v97, v51, v50, s34
    v_accvgpr_write_b32 a161, v97
    v_perm_b32 v96, v53, v52, s34
    v_accvgpr_write_b32 a162, v96
    v_perm_b32 v97, v55, v54, s34
    v_accvgpr_write_b32 a163, v97
    v_perm_b32 v96, v49, v48, s35
    v_accvgpr_write_b32 a164, v96
    v_perm_b32 v97, v51, v50, s35
    v_accvgpr_write_b32 a165, v97
    v_perm_b32 v96, v53, v52, s35
    v_accvgpr_write_b32 a166, v96
    v_perm_b32 v97, v55, v54, s35
    v_accvgpr_write_b32 a167, v97
    v_perm_b32 v96, v57, v56, s34
    v_accvgpr_write_b32 a176, v96
    v_perm_b32 v97, v59, v58, s34
    v_accvgpr_write_b32 a177, v97
    v_perm_b32 v96, v61, v60, s34
    v_accvgpr_write_b32 a178, v96
    v_perm_b32 v97, v63, v62, s34
    v_accvgpr_write_b32 a179, v97
    v_perm_b32 v96, v57, v56, s35
    v_accvgpr_write_b32 a180, v96
    v_perm_b32 v97, v59, v58, s35
    v_accvgpr_write_b32 a181, v97
    v_perm_b32 v96, v61, v60, s35
    v_accvgpr_write_b32 a182, v96
    v_perm_b32 v97, v63, v62, s35
    v_accvgpr_write_b32 a183, v97
    buffer_load_dword v32, v4, s[4:7], s32 offen
    s_add_u32 s32, s32, 3456
    buffer_load_dword v33, v4, s[4:7], s32 offen
    s_add_u32 s32, s32, 3456
    buffer_load_dword v34, v4, s[4:7], s32 offen
    s_add_u32 s32, s32, 3456
    buffer_load_dword v35, v4, s[4:7], s32 offen
    s_add_u32 s32, s32, 3456
    buffer_load_dword v36, v4, s[4:7], s32 offen
    s_add_u32 s32, s32, 3456
    buffer_load_dword v37, v4, s[4:7], s32 offen
    s_add_u32 s32, s32, 3456
    buffer_load_dword v38, v4, s[4:7], s32 offen
    s_add_u32 s32, s32, 3456
    buffer_load_dword v39, v4, s[4:7], s32 offen
    s_add_u32 s32, s32, 86400
    buffer_load_dword v40, v4, s[4:7], s32 offen
    s_add_u32 s32, s32, 3456
    buffer_load_dword v41, v4, s[4:7], s32 offen
    s_add_u32 s32, s32, 3456
    buffer_load_dword v42, v4, s[4:7], s32 offen
    s_add_u32 s32, s32, 3456
    buffer_load_dword v43, v4, s[4:7], s32 offen
    s_add_u32 s32, s32, 3456
    buffer_load_dword v44, v4, s[4:7], s32 offen
    s_add_u32 s32, s32, 3456
    buffer_load_dword v45, v4, s[4:7], s32 offen
    s_add_u32 s32, s32, 3456
    buffer_load_dword v46, v4, s[4:7], s32 offen
    s_add_u32 s32, s32, 3456
    buffer_load_dword v47, v4, s[4:7], s32 offen
    s_add_u32 s32, s32, 86400
    buffer_load_dword v48, v4, s[4:7], s32 offen
    s_add_u32 s32, s32, 3456
    buffer_load_dword v49, v4, s[4:7], s32 offen
    s_add_u32 s32, s32, 3456
    buffer_load_dword v50, v4, s[4:7], s32 offen
    s_add_u32 s32, s32, 3456
    buffer_load_dword v51, v4, s[4:7], s32 offen
    s_add_u32 s32, s32, 3456
    buffer_load_dword v52, v4, s[4:7], s32 offen
    s_add_u32 s32, s32, 3456
    buffer_load_dword v53, v4, s[4:7], s32 offen
    s_add_u32 s32, s32, 3456
    buffer_load_dword v54, v4, s[4:7], s32 offen
    s_add_u32 s32, s32, 3456
    buffer_load_dword v55, v4, s[4:7], s32 offen
    s_add_u32 s32, s32, 86400
    buffer_load_dword v56, v4, s[4:7], s32 offen
    s_add_u32 s32, s32, 3456
    buffer_load_dword v57, v4, s[4:7], s32 offen
    s_add_u32 s32, s32, 3456
    buffer_load_dword v58, v4, s[4:7], s32 offen
    s_add_u32 s32, s32, 3456
    buffer_load_dword v59, v4, s[4:7], s32 offen
    s_add_u32 s32, s32, 3456
    buffer_load_dword v60, v4, s[4:7], s32 offen
    s_add_u32 s32, s32, 3456
    buffer_load_dword v61, v4, s[4:7], s32 offen
    s_add_u32 s32, s32, 3456
    buffer_load_dword v62, v4, s[4:7], s32 offen
    s_add_u32 s32, s32, 3456
    buffer_load_dword v63, v4, s[4:7], s32 offen
    s_add_u32 s32, s32, 86400
    s_waitcnt vmcnt(32)
    v_perm_b32 v96, v65, v64, s34
    v_accvgpr_write_b32 a192, v96
    v_perm_b32 v97, v67, v66, s34
    v_accvgpr_write_b32 a193, v97
    v_perm_b32 v96, v69, v68, s34
    v_accvgpr_write_b32 a194, v96
    v_perm_b32 v97, v71, v70, s34
    v_accvgpr_write_b32 a195, v97
    v_perm_b32 v96, v65, v64, s35
    v_accvgpr_write_b32 a196, v96
    v_perm_b32 v97, v67, v66, s35
    v_accvgpr_write_b32 a197, v97
    v_perm_b32 v96, v69, v68, s35
    v_accvgpr_write_b32 a198, v96
    v_perm_b32 v97, v71, v70, s35
    v_accvgpr_write_b32 a199, v97
    v_perm_b32 v96, v73, v72, s34
    v_accvgpr_write_b32 a208, v96
    v_perm_b32 v97, v75, v74, s34
    v_accvgpr_write_b32 a209, v97
    v_perm_b32 v96, v77, v76, s34
    v_accvgpr_write_b32 a210, v96
    v_perm_b32 v97, v79, v78, s34
    v_accvgpr_write_b32 a211, v97
    v_perm_b32 v96, v73, v72, s35
    v_accvgpr_write_b32 a212, v96
    v_perm_b32 v97, v75, v74, s35
    v_accvgpr_write_b32 a213, v97
    v_perm_b32 v96, v77, v76, s35
    v_accvgpr_write_b32 a214, v96
    v_perm_b32 v97, v79, v78, s35
    v_accvgpr_write_b32 a215, v97
    v_perm_b32 v96, v81, v80, s34
    v_accvgpr_write_b32 a224, v96
    v_perm_b32 v97, v83, v82, s34
    v_accvgpr_write_b32 a225, v97
    v_perm_b32 v96, v85, v84, s34
    v_accvgpr_write_b32 a226, v96
    v_perm_b32 v97, v87, v86, s34
    v_accvgpr_write_b32 a227, v97
    v_perm_b32 v96, v81, v80, s35
    v_accvgpr_write_b32 a228, v96
    v_perm_b32 v97, v83, v82, s35
    v_accvgpr_write_b32 a229, v97
    v_perm_b32 v96, v85, v84, s35
    v_accvgpr_write_b32 a230, v96
    v_perm_b32 v97, v87, v86, s35
    v_accvgpr_write_b32 a231, v97
    v_perm_b32 v96, v89, v88, s34
    v_accvgpr_write_b32 a240, v96
    v_perm_b32 v97, v91, v90, s34
    v_accvgpr_write_b32 a241, v97
    v_perm_b32 v96, v93, v92, s34
    v_accvgpr_write_b32 a242, v96
    v_perm_b32 v97, v95, v94, s34
    v_accvgpr_write_b32 a243, v97
    v_perm_b32 v96, v89, v88, s35
    v_accvgpr_write_b32 a244, v96
    v_perm_b32 v97, v91, v90, s35
    v_accvgpr_write_b32 a245, v97
    v_perm_b32 v96, v93, v92, s35
    v_accvgpr_write_b32 a246, v96
    v_perm_b32 v97, v95, v94, s35
    v_accvgpr_write_b32 a247, v97
    s_waitcnt vmcnt(0)
    v_perm_b32 v192, v33, v32, s34
    v_perm_b32 v193, v35, v34, s34
    v_perm_b32 v194, v37, v36, s34
    v_perm_b32 v195, v39, v38, s34
    v_perm_b32 v196, v33, v32, s35
    v_perm_b32 v197, v35, v34, s35
    v_perm_b32 v198, v37, v36, s35
    v_perm_b32 v199, v39, v38, s35
    v_perm_b32 v208, v41, v40, s34
    v_perm_b32 v209, v43, v42, s34
    v_perm_b32 v210, v45, v44, s34
    v_perm_b32 v211, v47, v46, s34
    v_perm_b32 v212, v41, v40, s35
    v_perm_b32 v213, v43, v42, s35
    v_perm_b32 v214, v45, v44, s35
    v_perm_b32 v215, v47, v46, s35
    v_perm_b32 v224, v49, v48, s34
    v_perm_b32 v225, v51, v50, s34
    v_perm_b32 v226, v53, v52, s34
    v_perm_b32 v227, v55, v54, s34
    v_perm_b32 v228, v49, v48, s35
    v_perm_b32 v229, v51, v50, s35
    v_perm_b32 v230, v53, v52, s35
    v_perm_b32 v231, v55, v54, s35
    v_perm_b32 v240, v57, v56, s34
    v_perm_b32 v241, v59, v58, s34
    v_perm_b32 v242, v61, v60, s34
    v_perm_b32 v243, v63, v62, s34
    v_perm_b32 v244, v57, v56, s35
    v_perm_b32 v245, v59, v58, s35
    v_perm_b32 v246, v61, v60, s35
    v_perm_b32 v247, v63, v62, s35
    s_mov_b32 s32, 0
    s_mov_b32 s34, 0x05040100
    s_mov_b32 s35, 0x07060302
    buffer_load_dword v32, v4, s[8:11], s32 offen
    s_add_u32 s32, s32, 3456
    buffer_load_dword v33, v4, s[8:11], s32 offen
    s_add_u32 s32, s32, 3456
    buffer_load_dword v34, v4, s[8:11], s32 offen
    s_add_u32 s32, s32, 3456
    buffer_load_dword v35, v4, s[8:11], s32 offen
    s_add_u32 s32, s32, 3456
    buffer_load_dword v36, v4, s[8:11], s32 offen
    s_add_u32 s32, s32, 3456
    buffer_load_dword v37, v4, s[8:11], s32 offen
    s_add_u32 s32, s32, 3456
    buffer_load_dword v38, v4, s[8:11], s32 offen
    s_add_u32 s32, s32, 3456
    buffer_load_dword v39, v4, s[8:11], s32 offen
    s_add_u32 s32, s32, 86400
    buffer_load_dword v40, v4, s[8:11], s32 offen
    s_add_u32 s32, s32, 3456
    buffer_load_dword v41, v4, s[8:11], s32 offen
    s_add_u32 s32, s32, 3456
    buffer_load_dword v42, v4, s[8:11], s32 offen
    s_add_u32 s32, s32, 3456
    buffer_load_dword v43, v4, s[8:11], s32 offen
    s_add_u32 s32, s32, 3456
    buffer_load_dword v44, v4, s[8:11], s32 offen
    s_add_u32 s32, s32, 3456
    buffer_load_dword v45, v4, s[8:11], s32 offen
    s_add_u32 s32, s32, 3456
    buffer_load_dword v46, v4, s[8:11], s32 offen
    s_add_u32 s32, s32, 3456
    buffer_load_dword v47, v4, s[8:11], s32 offen
    s_add_u32 s32, s32, 86400
    buffer_load_dword v48, v4, s[8:11], s32 offen
    s_add_u32 s32, s32, 3456
    buffer_load_dword v49, v4, s[8:11], s32 offen
    s_add_u32 s32, s32, 3456
    buffer_load_dword v50, v4, s[8:11], s32 offen
    s_add_u32 s32, s32, 3456
    buffer_load_dword v51, v4, s[8:11], s32 offen
    s_add_u32 s32, s32, 3456
    buffer_load_dword v52, v4, s[8:11], s32 offen
    s_add_u32 s32, s32, 3456
    buffer_load_dword v53, v4, s[8:11], s32 offen
    s_add_u32 s32, s32, 3456
    buffer_load_dword v54, v4, s[8:11], s32 offen
    s_add_u32 s32, s32, 3456
    buffer_load_dword v55, v4, s[8:11], s32 offen
    s_add_u32 s32, s32, 86400
    buffer_load_dword v56, v4, s[8:11], s32 offen
    s_add_u32 s32, s32, 3456
    buffer_load_dword v57, v4, s[8:11], s32 offen
    s_add_u32 s32, s32, 3456
    buffer_load_dword v58, v4, s[8:11], s32 offen
    s_add_u32 s32, s32, 3456
    buffer_load_dword v59, v4, s[8:11], s32 offen
    s_add_u32 s32, s32, 3456
    buffer_load_dword v60, v4, s[8:11], s32 offen
    s_add_u32 s32, s32, 3456
    buffer_load_dword v61, v4, s[8:11], s32 offen
    s_add_u32 s32, s32, 3456
    buffer_load_dword v62, v4, s[8:11], s32 offen
    s_add_u32 s32, s32, 3456
    buffer_load_dword v63, v4, s[8:11], s32 offen
    s_add_u32 s32, s32, 86400
    buffer_load_dword v64, v4, s[8:11], s32 offen
    s_add_u32 s32, s32, 3456
    buffer_load_dword v65, v4, s[8:11], s32 offen
    s_add_u32 s32, s32, 3456
    buffer_load_dword v66, v4, s[8:11], s32 offen
    s_add_u32 s32, s32, 3456
    buffer_load_dword v67, v4, s[8:11], s32 offen
    s_add_u32 s32, s32, 3456
    buffer_load_dword v68, v4, s[8:11], s32 offen
    s_add_u32 s32, s32, 3456
    buffer_load_dword v69, v4, s[8:11], s32 offen
    s_add_u32 s32, s32, 3456
    buffer_load_dword v70, v4, s[8:11], s32 offen
    s_add_u32 s32, s32, 3456
    buffer_load_dword v71, v4, s[8:11], s32 offen
    s_add_u32 s32, s32, 86400
    buffer_load_dword v72, v4, s[8:11], s32 offen
    s_add_u32 s32, s32, 3456
    buffer_load_dword v73, v4, s[8:11], s32 offen
    s_add_u32 s32, s32, 3456
    buffer_load_dword v74, v4, s[8:11], s32 offen
    s_add_u32 s32, s32, 3456
    buffer_load_dword v75, v4, s[8:11], s32 offen
    s_add_u32 s32, s32, 3456
    buffer_load_dword v76, v4, s[8:11], s32 offen
    s_add_u32 s32, s32, 3456
    buffer_load_dword v77, v4, s[8:11], s32 offen
    s_add_u32 s32, s32, 3456
    buffer_load_dword v78, v4, s[8:11], s32 offen
    s_add_u32 s32, s32, 3456
    buffer_load_dword v79, v4, s[8:11], s32 offen
    s_add_u32 s32, s32, 86400
    buffer_load_dword v80, v4, s[8:11], s32 offen
    s_add_u32 s32, s32, 3456
    buffer_load_dword v81, v4, s[8:11], s32 offen
    s_add_u32 s32, s32, 3456
    buffer_load_dword v82, v4, s[8:11], s32 offen
    s_add_u32 s32, s32, 3456
    buffer_load_dword v83, v4, s[8:11], s32 offen
    s_add_u32 s32, s32, 3456
    buffer_load_dword v84, v4, s[8:11], s32 offen
    s_add_u32 s32, s32, 3456
    buffer_load_dword v85, v4, s[8:11], s32 offen
    s_add_u32 s32, s32, 3456
    buffer_load_dword v86, v4, s[8:11], s32 offen
    s_add_u32 s32, s32, 3456
    buffer_load_dword v87, v4, s[8:11], s32 offen
    s_add_u32 s32, s32, 86400
    buffer_load_dword v88, v4, s[8:11], s32 offen
    s_add_u32 s32, s32, 3456
    buffer_load_dword v89, v4, s[8:11], s32 offen
    s_add_u32 s32, s32, 3456
    buffer_load_dword v90, v4, s[8:11], s32 offen
    s_add_u32 s32, s32, 3456
    buffer_load_dword v91, v4, s[8:11], s32 offen
    s_add_u32 s32, s32, 3456
    buffer_load_dword v92, v4, s[8:11], s32 offen
    s_add_u32 s32, s32, 3456
    buffer_load_dword v93, v4, s[8:11], s32 offen
    s_add_u32 s32, s32, 3456
    buffer_load_dword v94, v4, s[8:11], s32 offen
    s_add_u32 s32, s32, 3456
    buffer_load_dword v95, v4, s[8:11], s32 offen
    s_add_u32 s32, s32, 86400
    s_waitcnt vmcnt(32)
    v_perm_b32 v96, v33, v32, s34
    v_accvgpr_write_b32 a8, v96
    v_perm_b32 v97, v35, v34, s34
    v_accvgpr_write_b32 a9, v97
    v_perm_b32 v96, v37, v36, s34
    v_accvgpr_write_b32 a10, v96
    v_perm_b32 v97, v39, v38, s34
    v_accvgpr_write_b32 a11, v97
    v_perm_b32 v96, v33, v32, s35
    v_accvgpr_write_b32 a12, v96
    v_perm_b32 v97, v35, v34, s35
    v_accvgpr_write_b32 a13, v97
    v_perm_b32 v96, v37, v36, s35
    v_accvgpr_write_b32 a14, v96
    v_perm_b32 v97, v39, v38, s35
    v_accvgpr_write_b32 a15, v97
    v_perm_b32 v96, v41, v40, s34
    v_accvgpr_write_b32 a24, v96
    v_perm_b32 v97, v43, v42, s34
    v_accvgpr_write_b32 a25, v97
    v_perm_b32 v96, v45, v44, s34
    v_accvgpr_write_b32 a26, v96
    v_perm_b32 v97, v47, v46, s34
    v_accvgpr_write_b32 a27, v97
    v_perm_b32 v96, v41, v40, s35
    v_accvgpr_write_b32 a28, v96
    v_perm_b32 v97, v43, v42, s35
    v_accvgpr_write_b32 a29, v97
    v_perm_b32 v96, v45, v44, s35
    v_accvgpr_write_b32 a30, v96
    v_perm_b32 v97, v47, v46, s35
    v_accvgpr_write_b32 a31, v97
    v_perm_b32 v96, v49, v48, s34
    v_accvgpr_write_b32 a40, v96
    v_perm_b32 v97, v51, v50, s34
    v_accvgpr_write_b32 a41, v97
    v_perm_b32 v96, v53, v52, s34
    v_accvgpr_write_b32 a42, v96
    v_perm_b32 v97, v55, v54, s34
    v_accvgpr_write_b32 a43, v97
    v_perm_b32 v96, v49, v48, s35
    v_accvgpr_write_b32 a44, v96
    v_perm_b32 v97, v51, v50, s35
    v_accvgpr_write_b32 a45, v97
    v_perm_b32 v96, v53, v52, s35
    v_accvgpr_write_b32 a46, v96
    v_perm_b32 v97, v55, v54, s35
    v_accvgpr_write_b32 a47, v97
    v_perm_b32 v96, v57, v56, s34
    v_accvgpr_write_b32 a56, v96
    v_perm_b32 v97, v59, v58, s34
    v_accvgpr_write_b32 a57, v97
    v_perm_b32 v96, v61, v60, s34
    v_accvgpr_write_b32 a58, v96
    v_perm_b32 v97, v63, v62, s34
    v_accvgpr_write_b32 a59, v97
    v_perm_b32 v96, v57, v56, s35
    v_accvgpr_write_b32 a60, v96
    v_perm_b32 v97, v59, v58, s35
    v_accvgpr_write_b32 a61, v97
    v_perm_b32 v96, v61, v60, s35
    v_accvgpr_write_b32 a62, v96
    v_perm_b32 v97, v63, v62, s35
    v_accvgpr_write_b32 a63, v97
    buffer_load_dword v32, v4, s[8:11], s32 offen
    s_add_u32 s32, s32, 3456
    buffer_load_dword v33, v4, s[8:11], s32 offen
    s_add_u32 s32, s32, 3456
    buffer_load_dword v34, v4, s[8:11], s32 offen
    s_add_u32 s32, s32, 3456
    buffer_load_dword v35, v4, s[8:11], s32 offen
    s_add_u32 s32, s32, 3456
    buffer_load_dword v36, v4, s[8:11], s32 offen
    s_add_u32 s32, s32, 3456
    buffer_load_dword v37, v4, s[8:11], s32 offen
    s_add_u32 s32, s32, 3456
    buffer_load_dword v38, v4, s[8:11], s32 offen
    s_add_u32 s32, s32, 3456
    buffer_load_dword v39, v4, s[8:11], s32 offen
    s_add_u32 s32, s32, 86400
    buffer_load_dword v40, v4, s[8:11], s32 offen
    s_add_u32 s32, s32, 3456
    buffer_load_dword v41, v4, s[8:11], s32 offen
    s_add_u32 s32, s32, 3456
    buffer_load_dword v42, v4, s[8:11], s32 offen
    s_add_u32 s32, s32, 3456
    buffer_load_dword v43, v4, s[8:11], s32 offen
    s_add_u32 s32, s32, 3456
    buffer_load_dword v44, v4, s[8:11], s32 offen
    s_add_u32 s32, s32, 3456
    buffer_load_dword v45, v4, s[8:11], s32 offen
    s_add_u32 s32, s32, 3456
    buffer_load_dword v46, v4, s[8:11], s32 offen
    s_add_u32 s32, s32, 3456
    buffer_load_dword v47, v4, s[8:11], s32 offen
    s_add_u32 s32, s32, 86400
    buffer_load_dword v48, v4, s[8:11], s32 offen
    s_add_u32 s32, s32, 3456
    buffer_load_dword v49, v4, s[8:11], s32 offen
    s_add_u32 s32, s32, 3456
    buffer_load_dword v50, v4, s[8:11], s32 offen
    s_add_u32 s32, s32, 3456
    buffer_load_dword v51, v4, s[8:11], s32 offen
    s_add_u32 s32, s32, 3456
    buffer_load_dword v52, v4, s[8:11], s32 offen
    s_add_u32 s32, s32, 3456
    buffer_load_dword v53, v4, s[8:11], s32 offen
    s_add_u32 s32, s32, 3456
    buffer_load_dword v54, v4, s[8:11], s32 offen
    s_add_u32 s32, s32, 3456
    buffer_load_dword v55, v4, s[8:11], s32 offen
    s_add_u32 s32, s32, 86400
    buffer_load_dword v56, v4, s[8:11], s32 offen
    s_add_u32 s32, s32, 3456
    buffer_load_dword v57, v4, s[8:11], s32 offen
    s_add_u32 s32, s32, 3456
    buffer_load_dword v58, v4, s[8:11], s32 offen
    s_add_u32 s32, s32, 3456
    buffer_load_dword v59, v4, s[8:11], s32 offen
    s_add_u32 s32, s32, 3456
    buffer_load_dword v60, v4, s[8:11], s32 offen
    s_add_u32 s32, s32, 3456
    buffer_load_dword v61, v4, s[8:11], s32 offen
    s_add_u32 s32, s32, 3456
    buffer_load_dword v62, v4, s[8:11], s32 offen
    s_add_u32 s32, s32, 3456
    buffer_load_dword v63, v4, s[8:11], s32 offen
    s_add_u32 s32, s32, 86400
    s_waitcnt vmcnt(32)
    v_perm_b32 v96, v65, v64, s34
    v_accvgpr_write_b32 a72, v96
    v_perm_b32 v97, v67, v66, s34
    v_accvgpr_write_b32 a73, v97
    v_perm_b32 v96, v69, v68, s34
    v_accvgpr_write_b32 a74, v96
    v_perm_b32 v97, v71, v70, s34
    v_accvgpr_write_b32 a75, v97
    v_perm_b32 v96, v65, v64, s35
    v_accvgpr_write_b32 a76, v96
    v_perm_b32 v97, v67, v66, s35
    v_accvgpr_write_b32 a77, v97
    v_perm_b32 v96, v69, v68, s35
    v_accvgpr_write_b32 a78, v96
    v_perm_b32 v97, v71, v70, s35
    v_accvgpr_write_b32 a79, v97
    v_perm_b32 v96, v73, v72, s34
    v_accvgpr_write_b32 a88, v96
    v_perm_b32 v97, v75, v74, s34
    v_accvgpr_write_b32 a89, v97
    v_perm_b32 v96, v77, v76, s34
    v_accvgpr_write_b32 a90, v96
    v_perm_b32 v97, v79, v78, s34
    v_accvgpr_write_b32 a91, v97
    v_perm_b32 v96, v73, v72, s35
    v_accvgpr_write_b32 a92, v96
    v_perm_b32 v97, v75, v74, s35
    v_accvgpr_write_b32 a93, v97
    v_perm_b32 v96, v77, v76, s35
    v_accvgpr_write_b32 a94, v96
    v_perm_b32 v97, v79, v78, s35
    v_accvgpr_write_b32 a95, v97
    v_perm_b32 v96, v81, v80, s34
    v_accvgpr_write_b32 a104, v96
    v_perm_b32 v97, v83, v82, s34
    v_accvgpr_write_b32 a105, v97
    v_perm_b32 v96, v85, v84, s34
    v_accvgpr_write_b32 a106, v96
    v_perm_b32 v97, v87, v86, s34
    v_accvgpr_write_b32 a107, v97
    v_perm_b32 v96, v81, v80, s35
    v_accvgpr_write_b32 a108, v96
    v_perm_b32 v97, v83, v82, s35
    v_accvgpr_write_b32 a109, v97
    v_perm_b32 v96, v85, v84, s35
    v_accvgpr_write_b32 a110, v96
    v_perm_b32 v97, v87, v86, s35
    v_accvgpr_write_b32 a111, v97
    v_perm_b32 v96, v89, v88, s34
    v_accvgpr_write_b32 a120, v96
    v_perm_b32 v97, v91, v90, s34
    v_accvgpr_write_b32 a121, v97
    v_perm_b32 v96, v93, v92, s34
    v_accvgpr_write_b32 a122, v96
    v_perm_b32 v97, v95, v94, s34
    v_accvgpr_write_b32 a123, v97
    v_perm_b32 v96, v89, v88, s35
    v_accvgpr_write_b32 a124, v96
    v_perm_b32 v97, v91, v90, s35
    v_accvgpr_write_b32 a125, v97
    v_perm_b32 v96, v93, v92, s35
    v_accvgpr_write_b32 a126, v96
    v_perm_b32 v97, v95, v94, s35
    v_accvgpr_write_b32 a127, v97
    buffer_load_dword v64, v4, s[8:11], s32 offen
    s_add_u32 s32, s32, 3456
    buffer_load_dword v65, v4, s[8:11], s32 offen
    s_add_u32 s32, s32, 3456
    buffer_load_dword v66, v4, s[8:11], s32 offen
    s_add_u32 s32, s32, 3456
    buffer_load_dword v67, v4, s[8:11], s32 offen
    s_add_u32 s32, s32, 3456
    buffer_load_dword v68, v4, s[8:11], s32 offen
    s_add_u32 s32, s32, 3456
    buffer_load_dword v69, v4, s[8:11], s32 offen
    s_add_u32 s32, s32, 3456
    buffer_load_dword v70, v4, s[8:11], s32 offen
    s_add_u32 s32, s32, 3456
    buffer_load_dword v71, v4, s[8:11], s32 offen
    s_add_u32 s32, s32, 86400
    buffer_load_dword v72, v4, s[8:11], s32 offen
    s_add_u32 s32, s32, 3456
    buffer_load_dword v73, v4, s[8:11], s32 offen
    s_add_u32 s32, s32, 3456
    buffer_load_dword v74, v4, s[8:11], s32 offen
    s_add_u32 s32, s32, 3456
    buffer_load_dword v75, v4, s[8:11], s32 offen
    s_add_u32 s32, s32, 3456
    buffer_load_dword v76, v4, s[8:11], s32 offen
    s_add_u32 s32, s32, 3456
    buffer_load_dword v77, v4, s[8:11], s32 offen
    s_add_u32 s32, s32, 3456
    buffer_load_dword v78, v4, s[8:11], s32 offen
    s_add_u32 s32, s32, 3456
    buffer_load_dword v79, v4, s[8:11], s32 offen
    s_add_u32 s32, s32, 86400
    buffer_load_dword v80, v4, s[8:11], s32 offen
    s_add_u32 s32, s32, 3456
    buffer_load_dword v81, v4, s[8:11], s32 offen
    s_add_u32 s32, s32, 3456
    buffer_load_dword v82, v4, s[8:11], s32 offen
    s_add_u32 s32, s32, 3456
    buffer_load_dword v83, v4, s[8:11], s32 offen
    s_add_u32 s32, s32, 3456
    buffer_load_dword v84, v4, s[8:11], s32 offen
    s_add_u32 s32, s32, 3456
    buffer_load_dword v85, v4, s[8:11], s32 offen
    s_add_u32 s32, s32, 3456
    buffer_load_dword v86, v4, s[8:11], s32 offen
    s_add_u32 s32, s32, 3456
    buffer_load_dword v87, v4, s[8:11], s32 offen
    s_add_u32 s32, s32, 86400
    buffer_load_dword v88, v4, s[8:11], s32 offen
    s_add_u32 s32, s32, 3456
    buffer_load_dword v89, v4, s[8:11], s32 offen
    s_add_u32 s32, s32, 3456
    buffer_load_dword v90, v4, s[8:11], s32 offen
    s_add_u32 s32, s32, 3456
    buffer_load_dword v91, v4, s[8:11], s32 offen
    s_add_u32 s32, s32, 3456
    buffer_load_dword v92, v4, s[8:11], s32 offen
    s_add_u32 s32, s32, 3456
    buffer_load_dword v93, v4, s[8:11], s32 offen
    s_add_u32 s32, s32, 3456
    buffer_load_dword v94, v4, s[8:11], s32 offen
    s_add_u32 s32, s32, 3456
    buffer_load_dword v95, v4, s[8:11], s32 offen
    s_add_u32 s32, s32, 86400
    s_waitcnt vmcnt(32)
    v_perm_b32 v96, v33, v32, s34
    v_accvgpr_write_b32 a136, v96
    v_perm_b32 v97, v35, v34, s34
    v_accvgpr_write_b32 a137, v97
    v_perm_b32 v96, v37, v36, s34
    v_accvgpr_write_b32 a138, v96
    v_perm_b32 v97, v39, v38, s34
    v_accvgpr_write_b32 a139, v97
    v_perm_b32 v96, v33, v32, s35
    v_accvgpr_write_b32 a140, v96
    v_perm_b32 v97, v35, v34, s35
    v_accvgpr_write_b32 a141, v97
    v_perm_b32 v96, v37, v36, s35
    v_accvgpr_write_b32 a142, v96
    v_perm_b32 v97, v39, v38, s35
    v_accvgpr_write_b32 a143, v97
    v_perm_b32 v96, v41, v40, s34
    v_accvgpr_write_b32 a152, v96
    v_perm_b32 v97, v43, v42, s34
    v_accvgpr_write_b32 a153, v97
    v_perm_b32 v96, v45, v44, s34
    v_accvgpr_write_b32 a154, v96
    v_perm_b32 v97, v47, v46, s34
    v_accvgpr_write_b32 a155, v97
    v_perm_b32 v96, v41, v40, s35
    v_accvgpr_write_b32 a156, v96
    v_perm_b32 v97, v43, v42, s35
    v_accvgpr_write_b32 a157, v97
    v_perm_b32 v96, v45, v44, s35
    v_accvgpr_write_b32 a158, v96
    v_perm_b32 v97, v47, v46, s35
    v_accvgpr_write_b32 a159, v97
    v_perm_b32 v96, v49, v48, s34
    v_accvgpr_write_b32 a168, v96
    v_perm_b32 v97, v51, v50, s34
    v_accvgpr_write_b32 a169, v97
    v_perm_b32 v96, v53, v52, s34
    v_accvgpr_write_b32 a170, v96
    v_perm_b32 v97, v55, v54, s34
    v_accvgpr_write_b32 a171, v97
    v_perm_b32 v96, v49, v48, s35
    v_accvgpr_write_b32 a172, v96
    v_perm_b32 v97, v51, v50, s35
    v_accvgpr_write_b32 a173, v97
    v_perm_b32 v96, v53, v52, s35
    v_accvgpr_write_b32 a174, v96
    v_perm_b32 v97, v55, v54, s35
    v_accvgpr_write_b32 a175, v97
    v_perm_b32 v96, v57, v56, s34
    v_accvgpr_write_b32 a184, v96
    v_perm_b32 v97, v59, v58, s34
    v_accvgpr_write_b32 a185, v97
    v_perm_b32 v96, v61, v60, s34
    v_accvgpr_write_b32 a186, v96
    v_perm_b32 v97, v63, v62, s34
    v_accvgpr_write_b32 a187, v97
    v_perm_b32 v96, v57, v56, s35
    v_accvgpr_write_b32 a188, v96
    v_perm_b32 v97, v59, v58, s35
    v_accvgpr_write_b32 a189, v97
    v_perm_b32 v96, v61, v60, s35
    v_accvgpr_write_b32 a190, v96
    v_perm_b32 v97, v63, v62, s35
    v_accvgpr_write_b32 a191, v97
    buffer_load_dword v32, v4, s[8:11], s32 offen
    s_add_u32 s32, s32, 3456
    buffer_load_dword v33, v4, s[8:11], s32 offen
    s_add_u32 s32, s32, 3456
    buffer_load_dword v34, v4, s[8:11], s32 offen
    s_add_u32 s32, s32, 3456
    buffer_load_dword v35, v4, s[8:11], s32 offen
    s_add_u32 s32, s32, 3456
    buffer_load_dword v36, v4, s[8:11], s32 offen
    s_add_u32 s32, s32, 3456
    buffer_load_dword v37, v4, s[8:11], s32 offen
    s_add_u32 s32, s32, 3456
    buffer_load_dword v38, v4, s[8:11], s32 offen
    s_add_u32 s32, s32, 3456
    buffer_load_dword v39, v4, s[8:11], s32 offen
    s_add_u32 s32, s32, 86400
    buffer_load_dword v40, v4, s[8:11], s32 offen
    s_add_u32 s32, s32, 3456
    buffer_load_dword v41, v4, s[8:11], s32 offen
    s_add_u32 s32, s32, 3456
    buffer_load_dword v42, v4, s[8:11], s32 offen
    s_add_u32 s32, s32, 3456
    buffer_load_dword v43, v4, s[8:11], s32 offen
    s_add_u32 s32, s32, 3456
    buffer_load_dword v44, v4, s[8:11], s32 offen
    s_add_u32 s32, s32, 3456
    buffer_load_dword v45, v4, s[8:11], s32 offen
    s_add_u32 s32, s32, 3456
    buffer_load_dword v46, v4, s[8:11], s32 offen
    s_add_u32 s32, s32, 3456
    buffer_load_dword v47, v4, s[8:11], s32 offen
    s_add_u32 s32, s32, 86400
    buffer_load_dword v48, v4, s[8:11], s32 offen
    s_add_u32 s32, s32, 3456
    buffer_load_dword v49, v4, s[8:11], s32 offen
    s_add_u32 s32, s32, 3456
    buffer_load_dword v50, v4, s[8:11], s32 offen
    s_add_u32 s32, s32, 3456
    buffer_load_dword v51, v4, s[8:11], s32 offen
    s_add_u32 s32, s32, 3456
    buffer_load_dword v52, v4, s[8:11], s32 offen
    s_add_u32 s32, s32, 3456
    buffer_load_dword v53, v4, s[8:11], s32 offen
    s_add_u32 s32, s32, 3456
    buffer_load_dword v54, v4, s[8:11], s32 offen
    s_add_u32 s32, s32, 3456
    buffer_load_dword v55, v4, s[8:11], s32 offen
    s_add_u32 s32, s32, 86400
    buffer_load_dword v56, v4, s[8:11], s32 offen
    s_add_u32 s32, s32, 3456
    buffer_load_dword v57, v4, s[8:11], s32 offen
    s_add_u32 s32, s32, 3456
    buffer_load_dword v58, v4, s[8:11], s32 offen
    s_add_u32 s32, s32, 3456
    buffer_load_dword v59, v4, s[8:11], s32 offen
    s_add_u32 s32, s32, 3456
    buffer_load_dword v60, v4, s[8:11], s32 offen
    s_add_u32 s32, s32, 3456
    buffer_load_dword v61, v4, s[8:11], s32 offen
    s_add_u32 s32, s32, 3456
    buffer_load_dword v62, v4, s[8:11], s32 offen
    s_add_u32 s32, s32, 3456
    buffer_load_dword v63, v4, s[8:11], s32 offen
    s_add_u32 s32, s32, 86400
    s_waitcnt vmcnt(32)
    v_perm_b32 v96, v65, v64, s34
    v_accvgpr_write_b32 a200, v96
    v_perm_b32 v97, v67, v66, s34
    v_accvgpr_write_b32 a201, v97
    v_perm_b32 v96, v69, v68, s34
    v_accvgpr_write_b32 a202, v96
    v_perm_b32 v97, v71, v70, s34
    v_accvgpr_write_b32 a203, v97
    v_perm_b32 v96, v65, v64, s35
    v_accvgpr_write_b32 a204, v96
    v_perm_b32 v97, v67, v66, s35
    v_accvgpr_write_b32 a205, v97
    v_perm_b32 v96, v69, v68, s35
    v_accvgpr_write_b32 a206, v96
    v_perm_b32 v97, v71, v70, s35
    v_accvgpr_write_b32 a207, v97
    v_perm_b32 v96, v73, v72, s34
    v_accvgpr_write_b32 a216, v96
    v_perm_b32 v97, v75, v74, s34
    v_accvgpr_write_b32 a217, v97
    v_perm_b32 v96, v77, v76, s34
    v_accvgpr_write_b32 a218, v96
    v_perm_b32 v97, v79, v78, s34
    v_accvgpr_write_b32 a219, v97
    v_perm_b32 v96, v73, v72, s35
    v_accvgpr_write_b32 a220, v96
    v_perm_b32 v97, v75, v74, s35
    v_accvgpr_write_b32 a221, v97
    v_perm_b32 v96, v77, v76, s35
    v_accvgpr_write_b32 a222, v96
    v_perm_b32 v97, v79, v78, s35
    v_accvgpr_write_b32 a223, v97
    v_perm_b32 v96, v81, v80, s34
    v_accvgpr_write_b32 a232, v96
    v_perm_b32 v97, v83, v82, s34
    v_accvgpr_write_b32 a233, v97
    v_perm_b32 v96, v85, v84, s34
    v_accvgpr_write_b32 a234, v96
    v_perm_b32 v97, v87, v86, s34
    v_accvgpr_write_b32 a235, v97
    v_perm_b32 v96, v81, v80, s35
    v_accvgpr_write_b32 a236, v96
    v_perm_b32 v97, v83, v82, s35
    v_accvgpr_write_b32 a237, v97
    v_perm_b32 v96, v85, v84, s35
    v_accvgpr_write_b32 a238, v96
    v_perm_b32 v97, v87, v86, s35
    v_accvgpr_write_b32 a239, v97
    v_perm_b32 v96, v89, v88, s34
    v_accvgpr_write_b32 a248, v96
    v_perm_b32 v97, v91, v90, s34
    v_accvgpr_write_b32 a249, v97
    v_perm_b32 v96, v93, v92, s34
    v_accvgpr_write_b32 a250, v96
    v_perm_b32 v97, v95, v94, s34
    v_accvgpr_write_b32 a251, v97
    v_perm_b32 v96, v89, v88, s35
    v_accvgpr_write_b32 a252, v96
    v_perm_b32 v97, v91, v90, s35
    v_accvgpr_write_b32 a253, v97
    v_perm_b32 v96, v93, v92, s35
    v_accvgpr_write_b32 a254, v96
    v_perm_b32 v97, v95, v94, s35
    v_accvgpr_write_b32 a255, v97
    s_waitcnt vmcnt(0)
    v_perm_b32 v200, v33, v32, s34
    v_perm_b32 v201, v35, v34, s34
    v_perm_b32 v202, v37, v36, s34
    v_perm_b32 v203, v39, v38, s34
    v_perm_b32 v204, v33, v32, s35
    v_perm_b32 v205, v35, v34, s35
    v_perm_b32 v206, v37, v36, s35
    v_perm_b32 v207, v39, v38, s35
    v_perm_b32 v216, v41, v40, s34
    v_perm_b32 v217, v43, v42, s34
    v_perm_b32 v218, v45, v44, s34
    v_perm_b32 v219, v47, v46, s34
    v_perm_b32 v220, v41, v40, s35
    v_perm_b32 v221, v43, v42, s35
    v_perm_b32 v222, v45, v44, s35
    v_perm_b32 v223, v47, v46, s35
    v_perm_b32 v232, v49, v48, s34
    v_perm_b32 v233, v51, v50, s34
    v_perm_b32 v234, v53, v52, s34
    v_perm_b32 v235, v55, v54, s34
    v_perm_b32 v236, v49, v48, s35
    v_perm_b32 v237, v51, v50, s35
    v_perm_b32 v238, v53, v52, s35
    v_perm_b32 v239, v55, v54, s35
    v_perm_b32 v248, v57, v56, s34
    v_perm_b32 v249, v59, v58, s34
    v_perm_b32 v250, v61, v60, s34
    v_perm_b32 v251, v63, v62, s34
    v_perm_b32 v252, v57, v56, s35
    v_perm_b32 v253, v59, v58, s35
    v_perm_b32 v254, v61, v60, s35
    v_perm_b32 v255, v63, v62, s35
    s_lshl_b32 s39, s23, 10
    s_add_u32 s39, s39, 88080384
    s_mov_b32 s33, s21
    s_mov_b32 s44, 0
    s_mov_b32 s47, 0xbfb8aa3b
    v_and_b32 v3, 15, v1
    v_lshlrev_b32 v6, 5, v3
    s_mov_b32 s43, 10240
    buffer_load_dwordx4 v[16:19], v6, s[12:15], s43 offen offset:0 sc1
    buffer_load_dwordx4 v[20:23], v6, s[12:15], s43 offen offset:16 sc1
    buffer_load_dwordx4 v[24:27], v6, s[12:15], s43 offen offset:512 sc1
    buffer_load_dwordx4 v[28:31], v6, s[12:15], s43 offen offset:528 sc1
    buffer_load_dwordx4 v[32:35], v6, s[12:15], s43 offen offset:1024 sc1
    buffer_load_dwordx4 v[36:39], v6, s[12:15], s43 offen offset:1040 sc1
    buffer_load_dwordx4 v[40:43], v6, s[12:15], s43 offen offset:1536 sc1
    buffer_load_dwordx4 v[44:47], v6, s[12:15], s43 offen offset:1552 sc1
    buffer_load_dwordx4 v[48:51], v6, s[12:15], s43 offen offset:2048 sc1
    buffer_load_dwordx4 v[52:55], v6, s[12:15], s43 offen offset:2064 sc1
    s_mov_b32 s43, 7680
    buffer_load_dwordx4 v[56:59], v6, s[12:15], s43 offen offset:0 sc1
    buffer_load_dwordx4 v[60:63], v6, s[12:15], s43 offen offset:16 sc1
    buffer_load_dwordx4 v[64:67], v6, s[12:15], s43 offen offset:512 sc1
    buffer_load_dwordx4 v[68:71], v6, s[12:15], s43 offen offset:528 sc1
    buffer_load_dwordx4 v[72:75], v6, s[12:15], s43 offen offset:1024 sc1
    buffer_load_dwordx4 v[76:79], v6, s[12:15], s43 offen offset:1040 sc1
    buffer_load_dwordx4 v[80:83], v6, s[12:15], s43 offen offset:1536 sc1
    buffer_load_dwordx4 v[84:87], v6, s[12:15], s43 offen offset:1552 sc1
    buffer_load_dwordx4 v[88:91], v6, s[12:15], s43 offen offset:2048 sc1
    buffer_load_dwordx4 v[92:95], v6, s[12:15], s43 offen offset:2064 sc1
    s_waitcnt vmcnt(10)
    v_add_f32 v16, 1.0, v16
    v_add_f32 v17, 1.0, v17
    v_cvt_pk_bf16_f32 v10, v16, v17
    v_lshlrev_b32 v16, 16, v10
    v_and_b32 v17, 0xffff0000, v10
    v_add_f32 v18, 1.0, v18
    v_add_f32 v19, 1.0, v19
    v_cvt_pk_bf16_f32 v10, v18, v19
    v_lshlrev_b32 v18, 16, v10
    v_and_b32 v19, 0xffff0000, v10
    v_add_f32 v20, 1.0, v20
    v_add_f32 v21, 1.0, v21
    v_cvt_pk_bf16_f32 v10, v20, v21
    v_lshlrev_b32 v20, 16, v10
    v_and_b32 v21, 0xffff0000, v10
    v_add_f32 v22, 1.0, v22
    v_add_f32 v23, 1.0, v23
    v_cvt_pk_bf16_f32 v10, v22, v23
    v_lshlrev_b32 v22, 16, v10
    v_and_b32 v23, 0xffff0000, v10
    v_add_f32 v24, 1.0, v24
    v_add_f32 v25, 1.0, v25
    v_cvt_pk_bf16_f32 v10, v24, v25
    v_lshlrev_b32 v24, 16, v10
    v_and_b32 v25, 0xffff0000, v10
    v_add_f32 v26, 1.0, v26
    v_add_f32 v27, 1.0, v27
    v_cvt_pk_bf16_f32 v10, v26, v27
    v_lshlrev_b32 v26, 16, v10
    v_and_b32 v27, 0xffff0000, v10
    v_add_f32 v28, 1.0, v28
    v_add_f32 v29, 1.0, v29
    v_cvt_pk_bf16_f32 v10, v28, v29
    v_lshlrev_b32 v28, 16, v10
    v_and_b32 v29, 0xffff0000, v10
    v_add_f32 v30, 1.0, v30
    v_add_f32 v31, 1.0, v31
    v_cvt_pk_bf16_f32 v10, v30, v31
    v_lshlrev_b32 v30, 16, v10
    v_and_b32 v31, 0xffff0000, v10
    v_add_f32 v32, 1.0, v32
    v_add_f32 v33, 1.0, v33
    v_cvt_pk_bf16_f32 v10, v32, v33
    v_lshlrev_b32 v32, 16, v10
    v_and_b32 v33, 0xffff0000, v10
    v_add_f32 v34, 1.0, v34
    v_add_f32 v35, 1.0, v35
    v_cvt_pk_bf16_f32 v10, v34, v35
    v_lshlrev_b32 v34, 16, v10
    v_and_b32 v35, 0xffff0000, v10
    v_add_f32 v36, 1.0, v36
    v_add_f32 v37, 1.0, v37
    v_cvt_pk_bf16_f32 v10, v36, v37
    v_lshlrev_b32 v36, 16, v10
    v_and_b32 v37, 0xffff0000, v10
    v_add_f32 v38, 1.0, v38
    v_add_f32 v39, 1.0, v39
    v_cvt_pk_bf16_f32 v10, v38, v39
    v_lshlrev_b32 v38, 16, v10
    v_and_b32 v39, 0xffff0000, v10
    v_add_f32 v40, 1.0, v40
    v_add_f32 v41, 1.0, v41
    v_cvt_pk_bf16_f32 v10, v40, v41
    v_lshlrev_b32 v40, 16, v10
    v_and_b32 v41, 0xffff0000, v10
    v_add_f32 v42, 1.0, v42
    v_add_f32 v43, 1.0, v43
    v_cvt_pk_bf16_f32 v10, v42, v43
    v_lshlrev_b32 v42, 16, v10
    v_and_b32 v43, 0xffff0000, v10
    v_add_f32 v44, 1.0, v44
    v_add_f32 v45, 1.0, v45
    v_cvt_pk_bf16_f32 v10, v44, v45
    v_lshlrev_b32 v44, 16, v10
    v_and_b32 v45, 0xffff0000, v10
    v_add_f32 v46, 1.0, v46
    v_add_f32 v47, 1.0, v47
    v_cvt_pk_bf16_f32 v10, v46, v47
    v_lshlrev_b32 v46, 16, v10
    v_and_b32 v47, 0xffff0000, v10
    v_add_f32 v48, 1.0, v48
    v_add_f32 v49, 1.0, v49
    v_cvt_pk_bf16_f32 v10, v48, v49
    v_lshlrev_b32 v48, 16, v10
    v_and_b32 v49, 0xffff0000, v10
    v_add_f32 v50, 1.0, v50
    v_add_f32 v51, 1.0, v51
    v_cvt_pk_bf16_f32 v10, v50, v51
    v_lshlrev_b32 v50, 16, v10
    v_and_b32 v51, 0xffff0000, v10
    v_add_f32 v52, 1.0, v52
    v_add_f32 v53, 1.0, v53
    v_cvt_pk_bf16_f32 v10, v52, v53
    v_lshlrev_b32 v52, 16, v10
    v_and_b32 v53, 0xffff0000, v10
    v_add_f32 v54, 1.0, v54
    v_add_f32 v55, 1.0, v55
    v_cvt_pk_bf16_f32 v10, v54, v55
    v_lshlrev_b32 v54, 16, v10
    v_and_b32 v55, 0xffff0000, v10
    s_waitcnt vmcnt(0)
    v_lshrrev_b32 v2, 4, v1
    v_and_b32 v3, 15, v1
    s_lshl_b32 s50, s25, 2
    v_add_u32 v4, s50, v2
    s_mov_b32 s40, 1280
    v_mul_lo_u32 v176, v4, s40
    v_lshl_add_u32 v176, v3, 4, v176
    v_lshlrev_b32 v177, 4, v4
    v_lshl_add_u32 v177, v3, 8, v177
    v_mov_b32 v178, 0
    v_mov_b32 v179, 40960
    v_mov_b32 v9, v5
    s_mov_b32 s51, 0
    s_lshl_b32 s53, s20, 9
    s_add_u32 s53, s53, 116533248
L_mu_wait:
    s_lshl_b32 s48, s33, 2
    s_add_u32 s49, s48, s53
    s_cmp_eq_u32 s25, 0
    s_cbranch_scc0 L_wgw_49
    s_mov_b32 s98, 0
    v_mov_b32 v14, 0
L_wait_50:
    buffer_load_dword v15, v14, s[12:15], s49 offen sc1
    s_waitcnt vmcnt(0)
    v_readfirstlane_b32 s99, v15
    s_cmp_ge_u32 s99, 20
    s_cbranch_scc1 L_ok_51
    s_sleep 1
    s_add_u32 s98, s98, 1
    s_cmp_lt_u32 s98, 1048576
    s_cbranch_scc1 L_wait_50
    s_branch L_mega_done
L_ok_51:
L_wgw_49:
    s_barrier
    s_mul_i32 s41, s33, 20480
    s_add_u32 s41, s41, 79691776
    buffer_load_dwordx4 v[136:139], v176, s[12:15], s41 offen offset:0 sc1
    buffer_load_dwordx4 v[140:143], v176, s[12:15], s41 offen offset:256 sc1
    buffer_load_dwordx4 v[144:147], v176, s[12:15], s41 offen offset:512 sc1
    buffer_load_dwordx4 v[148:151], v176, s[12:15], s41 offen offset:768 sc1
    buffer_load_dwordx4 v[152:155], v176, s[12:15], s41 offen offset:1024 sc1
L_mu_loop:
    s_lshl_b32 s48, s33, 2
    s_mul_i32 s38, s33, 55296
    s_add_u32 s38, s38, s39
    s_cmp_lt_u32 s33, 24
    s_cselect_b32 s49, 3, 4
    s_add_u32 s33, s33, s49
    s_lshl_b32 s49, s33, 2
    s_add_u32 s49, s49, s53
    s_waitcnt vmcnt(0)
    s_cmp_eq_u32 s25, 0
    s_cbranch_scc0 L_mu_nf
    buffer_load_dword v180, v178, s[12:15], s49 offen sc1
L_mu_nf:
    v_lshlrev_b32 v96, 16, v136
    v_and_b32 v97, 0xffff0000, v136
    v_lshlrev_b32 v98, 16, v137
    v_and_b32 v99, 0xffff0000, v137
    v_lshlrev_b32 v100, 16, v138
    v_and_b32 v101, 0xffff0000, v138
    v_lshlrev_b32 v102, 16, v139
    v_and_b32 v103, 0xffff0000, v139
    v_lshlrev_b32 v104, 16, v140
    v_and_b32 v105, 0xffff0000, v140
    v_lshlrev_b32 v106, 16, v141
    v_and_b32 v107, 0xffff0000, v141
    v_lshlrev_b32 v108, 16, v142
    v_and_b32 v109, 0xffff0000, v142
    v_lshlrev_b32 v110, 16, v143
    v_and_b32 v111, 0xffff0000, v143
    v_lshlrev_b32 v112, 16, v144
    v_and_b32 v113, 0xffff0000, v144
    v_lshlrev_b32 v114, 16, v145
    v_and_b32 v115, 0xffff0000, v145
    v_lshlrev_b32 v116, 16, v146
    v_and_b32 v117, 0xffff0000, v146
    v_lshlrev_b32 v118, 16, v147
    v_and_b32 v119, 0xffff0000, v147
    v_lshlrev_b32 v120, 16, v148
    v_and_b32 v121, 0xffff0000, v148
    v_lshlrev_b32 v122, 16, v149
    v_and_b32 v123, 0xffff0000, v149
    v_lshlrev_b32 v124, 16, v150
    v_and_b32 v125, 0xffff0000, v150
    v_lshlrev_b32 v126, 16, v151
    v_and_b32 v127, 0xffff0000, v151
    v_lshlrev_b32 v128, 16, v152
    v_and_b32 v129, 0xffff0000, v152
    v_lshlrev_b32 v130, 16, v153
    v_and_b32 v131, 0xffff0000, v153
    v_lshlrev_b32 v132, 16, v154
    v_and_b32 v133, 0xffff0000, v154
    v_lshlrev_b32 v134, 16, v155
    v_and_b32 v135, 0xffff0000, v155
    v_pk_add_f32 v[8:9], v[96:97], v[98:99]
    v_pk_add_f32 v[10:11], v[100:101], v[102:103]
    v_pk_add_f32 v[8:9], v[8:9], v[104:105]
    v_pk_add_f32 v[10:11], v[10:11], v[106:107]
    v_pk_add_f32 v[8:9], v[8:9], v[108:109]
    v_pk_add_f32 v[10:11], v[10:11], v[110:111]
    v_pk_add_f32 v[8:9], v[8:9], v[112:113]
    v_pk_add_f32 v[10:11], v[10:11], v[114:115]
    v_pk_add_f32 v[8:9], v[8:9], v[116:117]
    v_pk_add_f32 v[10:11], v[10:11], v[118:119]
    v_pk_add_f32 v[8:9], v[8:9], v[120:121]
    v_pk_add_f32 v[10:11], v[10:11], v[122:123]
    v_pk_add_f32 v[8:9], v[8:9], v[124:125]
    v_pk_add_f32 v[10:11], v[10:11], v[126:127]
    v_pk_add_f32 v[8:9], v[8:9], v[128:129]
    v_pk_add_f32 v[10:11], v[10:11], v[130:131]
    v_pk_add_f32 v[8:9], v[8:9], v[132:133]
    v_pk_add_f32 v[10:11], v[10:11], v[134:135]
    v_pk_add_f32 v[8:9], v[8:9], v[10:11]
    v_add_f32 v8, v8, v9
    s_nop 1
    v_add_f32_dpp v8, v8, v8 row_ror:8 row_mask:0xf bank_mask:0xf
    s_nop 1
    v_add_f32_dpp v8, v8, v8 row_ror:4 row_mask:0xf bank_mask:0xf
    s_nop 1
    v_add_f32_dpp v8, v8, v8 row_ror:2 row_mask:0xf bank_mask:0xf
    s_nop 1
    v_add_f32_dpp v8, v8, v8 row_ror:1 row_mask:0xf bank_mask:0xf
    s_mov_b32 s42, 0x3acccccd
    v_mul_f32 v8, s42, v8
    v_pk_add_f32 v[12:13], v[96:97], v[8:9] op_sel_hi:[1,0] neg_lo:[0,1] neg_hi:[0,1]
    v_pk_mul_f32 v[10:11], v[12:13], v[12:13]
    v_pk_add_f32 v[12:13], v[98:99], v[8:9] op_sel_hi:[1,0] neg_lo:[0,1] neg_hi:[0,1]
    v_pk_fma_f32 v[10:11], v[12:13], v[12:13], v[10:11]
    v_pk_add_f32 v[12:13], v[100:101], v[8:9] op_sel_hi:[1,0] neg_lo:[0,1] neg_hi:[0,1]
    v_pk_fma_f32 v[10:11], v[12:13], v[12:13], v[10:11]
    v_pk_add_f32 v[12:13], v[102:103], v[8:9] op_sel_hi:[1,0] neg_lo:[0,1] neg_hi:[0,1]
    v_pk_fma_f32 v[10:11], v[12:13], v[12:13], v[10:11]
    v_pk_add_f32 v[12:13], v[104:105], v[8:9] op_sel_hi:[1,0] neg_lo:[0,1] neg_hi:[0,1]
    v_pk_fma_f32 v[10:11], v[12:13], v[12:13], v[10:11]
    v_pk_add_f32 v[12:13], v[106:107], v[8:9] op_sel_hi:[1,0] neg_lo:[0,1] neg_hi:[0,1]
    v_pk_fma_f32 v[10:11], v[12:13], v[12:13], v[10:11]
    v_pk_add_f32 v[12:13], v[108:109], v[8:9] op_sel_hi:[1,0] neg_lo:[0,1] neg_hi:[0,1]
    v_pk_fma_f32 v[10:11], v[12:13], v[12:13], v[10:11]
    v_pk_add_f32 v[12:13], v[110:111], v[8:9] op_sel_hi:[1,0] neg_lo:[0,1] neg_hi:[0,1]
    v_pk_fma_f32 v[10:11], v[12:13], v[12:13], v[10:11]
    v_pk_add_f32 v[12:13], v[112:113], v[8:9] op_sel_hi:[1,0] neg_lo:[0,1] neg_hi:[0,1]
    v_pk_fma_f32 v[10:11], v[12:13], v[12:13], v[10:11]
    v_pk_add_f32 v[12:13], v[114:115], v[8:9] op_sel_hi:[1,0] neg_lo:[0,1] neg_hi:[0,1]
    v_pk_fma_f32 v[10:11], v[12:13], v[12:13], v[10:11]
    v_pk_add_f32 v[12:13], v[116:117], v[8:9] op_sel_hi:[1,0] neg_lo:[0,1] neg_hi:[0,1]
    v_pk_fma_f32 v[10:11], v[12:13], v[12:13], v[10:11]
    v_pk_add_f32 v[12:13], v[118:119], v[8:9] op_sel_hi:[1,0] neg_lo:[0,1] neg_hi:[0,1]
    v_pk_fma_f32 v[10:11], v[12:13], v[12:13], v[10:11]
    v_pk_add_f32 v[12:13], v[120:121], v[8:9] op_sel_hi:[1,0] neg_lo:[0,1] neg_hi:[0,1]
    v_pk_fma_f32 v[10:11], v[12:13], v[12:13], v[10:11]
    v_pk_add_f32 v[12:13], v[122:123], v[8:9] op_sel_hi:[1,0] neg_lo:[0,1] neg_hi:[0,1]
    v_pk_fma_f32 v[10:11], v[12:13], v[12:13], v[10:11]
    v_pk_add_f32 v[12:13], v[124:125], v[8:9] op_sel_hi:[1,0] neg_lo:[0,1] neg_hi:[0,1]
    v_pk_fma_f32 v[10:11], v[12:13], v[12:13], v[10:11]
    v_pk_add_f32 v[12:13], v[126:127], v[8:9] op_sel_hi:[1,0] neg_lo:[0,1] neg_hi:[0,1]
    v_pk_fma_f32 v[10:11], v[12:13], v[12:13], v[10:11]
    v_pk_add_f32 v[12:13], v[128:129], v[8:9] op_sel_hi:[1,0] neg_lo:[0,1] neg_hi:[0,1]
    v_pk_fma_f32 v[10:11], v[12:13], v[12:13], v[10:11]
    v_pk_add_f32 v[12:13], v[130:131], v[8:9] op_sel_hi:[1,0] neg_lo:[0,1] neg_hi:[0,1]
    v_pk_fma_f32 v[10:11], v[12:13], v[12:13], v[10:11]
    v_pk_add_f32 v[12:13], v[132:133], v[8:9] op_sel_hi:[1,0] neg_lo:[0,1] neg_hi:[0,1]
    v_pk_fma_f32 v[10:11], v[12:13], v[12:13], v[10:11]
    v_pk_add_f32 v[12:13], v[134:135], v[8:9] op_sel_hi:[1,0] neg_lo:[0,1] neg_hi:[0,1]
    v_pk_fma_f32 v[10:11], v[12:13], v[12:13], v[10:11]
    v_add_f32 v9, v10, v11
    s_nop 1
    v_add_f32_dpp v9, v9, v9 row_ror:8 row_mask:0xf bank_mask:0xf
    s_nop 1
    v_add_f32_dpp v9, v9, v9 row_ror:4 row_mask:0xf bank_mask:0xf
    s_nop 1
    v_add_f32_dpp v9, v9, v9 row_ror:2 row_mask:0xf bank_mask:0xf
    s_nop 1
    v_add_f32_dpp v9, v9, v9 row_ror:1 row_mask:0xf bank_mask:0xf
    v_mul_f32 v9, s42, v9
    v_cvt_pk_bf16_f32 v10, v8, v9
    v_lshlrev_b32 v8, 16, v10
    v_and_b32 v9, 0xffff0000, v10
    v_add_f32 v9, 0x3727c5ac, v9
    v_cvt_pk_bf16_f32 v9, v9, v9
    v_lshlrev_b32 v9, 16, v9
    v_sqrt_f32 v9, v9
    s_nop 0
    v_cvt_pk_bf16_f32 v9, v9, v9
    v_lshlrev_b32 v9, 16, v9
    v_rcp_f32 v9, v9
    s_nop 0
    v_pk_add_f32 v[96:97], v[96:97], v[8:9] op_sel_hi:[1,0] neg_lo:[0,1] neg_hi:[0,1]
    v_cvt_pk_bf16_f32 v10, v96, v97
    v_lshlrev_b32 v96, 16, v10
    v_and_b32 v97, 0xffff0000, v10
    v_pk_mul_f32 v[96:97], v[96:97], v[8:9] op_sel:[0,1] op_sel_hi:[1,1]
    v_cvt_pk_bf16_f32 v12, v96, v97
    v_lshlrev_b32 v96, 16, v12
    v_and_b32 v97, 0xffff0000, v12
    v_pk_add_f32 v[98:99], v[98:99], v[8:9] op_sel_hi:[1,0] neg_lo:[0,1] neg_hi:[0,1]
    v_cvt_pk_bf16_f32 v11, v98, v99
    v_lshlrev_b32 v98, 16, v11
    v_and_b32 v99, 0xffff0000, v11
    v_pk_mul_f32 v[98:99], v[98:99], v[8:9] op_sel:[0,1] op_sel_hi:[1,1]
    v_cvt_pk_bf16_f32 v13, v98, v99
    v_lshlrev_b32 v98, 16, v13
    v_and_b32 v99, 0xffff0000, v13
    v_pk_add_f32 v[100:101], v[100:101], v[8:9] op_sel_hi:[1,0] neg_lo:[0,1] neg_hi:[0,1]
    v_cvt_pk_bf16_f32 v10, v100, v101
    v_lshlrev_b32 v100, 16, v10
    v_and_b32 v101, 0xffff0000, v10
    v_pk_mul_f32 v[100:101], v[100:101], v[8:9] op_sel:[0,1] op_sel_hi:[1,1]
    v_cvt_pk_bf16_f32 v12, v100, v101
    v_lshlrev_b32 v100, 16, v12
    v_and_b32 v101, 0xffff0000, v12
    v_pk_add_f32 v[102:103], v[102:103], v[8:9] op_sel_hi:[1,0] neg_lo:[0,1] neg_hi:[0,1]
    v_cvt_pk_bf16_f32 v11, v102, v103
    v_lshlrev_b32 v102, 16, v11
    v_and_b32 v103, 0xffff0000, v11
    v_pk_mul_f32 v[102:103], v[102:103], v[8:9] op_sel:[0,1] op_sel_hi:[1,1]
    v_cvt_pk_bf16_f32 v13, v102, v103
    v_lshlrev_b32 v102, 16, v13
    v_and_b32 v103, 0xffff0000, v13
    v_pk_add_f32 v[104:105], v[104:105], v[8:9] op_sel_hi:[1,0] neg_lo:[0,1] neg_hi:[0,1]
    v_cvt_pk_bf16_f32 v10, v104, v105
    v_lshlrev_b32 v104, 16, v10
    v_and_b32 v105, 0xffff0000, v10
    v_pk_mul_f32 v[104:105], v[104:105], v[8:9] op_sel:[0,1] op_sel_hi:[1,1]
    v_cvt_pk_bf16_f32 v12, v104, v105
    v_lshlrev_b32 v104, 16, v12
    v_and_b32 v105, 0xffff0000, v12
    v_pk_add_f32 v[106:107], v[106:107], v[8:9] op_sel_hi:[1,0] neg_lo:[0,1] neg_hi:[0,1]
    v_cvt_pk_bf16_f32 v11, v106, v107
    v_lshlrev_b32 v106, 16, v11
    v_and_b32 v107, 0xffff0000, v11
    v_pk_mul_f32 v[106:107], v[106:107], v[8:9] op_sel:[0,1] op_sel_hi:[1,1]
    v_cvt_pk_bf16_f32 v13, v106, v107
    v_lshlrev_b32 v106, 16, v13
    v_and_b32 v107, 0xffff0000, v13
    v_pk_add_f32 v[108:109], v[108:109], v[8:9] op_sel_hi:[1,0] neg_lo:[0,1] neg_hi:[0,1]
    v_cvt_pk_bf16_f32 v10, v108, v109
    v_lshlrev_b32 v108, 16, v10
    v_and_b32 v109, 0xffff0000, v10
    v_pk_mul_f32 v[108:109], v[108:109], v[8:9] op_sel:[0,1] op_sel_hi:[1,1]
    v_cvt_pk_bf16_f32 v12, v108, v109
    v_lshlrev_b32 v108, 16, v12
    v_and_b32 v109, 0xffff0000, v12
    v_pk_add_f32 v[110:111], v[110:111], v[8:9] op_sel_hi:[1,0] neg_lo:[0,1] neg_hi:[0,1]
    v_cvt_pk_bf16_f32 v11, v110, v111
    v_lshlrev_b32 v110, 16, v11
    v_and_b32 v111, 0xffff0000, v11
    v_pk_mul_f32 v[110:111], v[110:111], v[8:9] op_sel:[0,1] op_sel_hi:[1,1]
    v_cvt_pk_bf16_f32 v13, v110, v111
    v_lshlrev_b32 v110, 16, v13
    v_and_b32 v111, 0xffff0000, v13
    v_pk_add_f32 v[112:113], v[112:113], v[8:9] op_sel_hi:[1,0] neg_lo:[0,1] neg_hi:[0,1]
    v_cvt_pk_bf16_f32 v10, v112, v113
    v_lshlrev_b32 v112, 16, v10
    v_and_b32 v113, 0xffff0000, v10
    v_pk_mul_f32 v[112:113], v[112:113], v[8:9] op_sel:[0,1] op_sel_hi:[1,1]
    v_cvt_pk_bf16_f32 v12, v112, v113
    v_lshlrev_b32 v112, 16, v12
    v_and_b32 v113, 0xffff0000, v12
    v_pk_add_f32 v[114:115], v[114:115], v[8:9] op_sel_hi:[1,0] neg_lo:[0,1] neg_hi:[0,1]
    v_cvt_pk_bf16_f32 v11, v114, v115
    v_lshlrev_b32 v114, 16, v11
    v_and_b32 v115, 0xffff0000, v11
    v_pk_mul_f32 v[114:115], v[114:115], v[8:9] op_sel:[0,1] op_sel_hi:[1,1]
    v_cvt_pk_bf16_f32 v13, v114, v115
    v_lshlrev_b32 v114, 16, v13
    v_and_b32 v115, 0xffff0000, v13
    v_pk_add_f32 v[116:117], v[116:117], v[8:9] op_sel_hi:[1,0] neg_lo:[0,1] neg_hi:[0,1]
    v_cvt_pk_bf16_f32 v10, v116, v117
    v_lshlrev_b32 v116, 16, v10
    v_and_b32 v117, 0xffff0000, v10
    v_pk_mul_f32 v[116:117], v[116:117], v[8:9] op_sel:[0,1] op_sel_hi:[1,1]
    v_cvt_pk_bf16_f32 v12, v116, v117
    v_lshlrev_b32 v116, 16, v12
    v_and_b32 v117, 0xffff0000, v12
    v_pk_add_f32 v[118:119], v[118:119], v[8:9] op_sel_hi:[1,0] neg_lo:[0,1] neg_hi:[0,1]
    v_cvt_pk_bf16_f32 v11, v118, v119
    v_lshlrev_b32 v118, 16, v11
    v_and_b32 v119, 0xffff0000, v11
    v_pk_mul_f32 v[118:119], v[118:119], v[8:9] op_sel:[0,1] op_sel_hi:[1,1]
    v_cvt_pk_bf16_f32 v13, v118, v119
    v_lshlrev_b32 v118, 16, v13
    v_and_b32 v119, 0xffff0000, v13
    v_pk_add_f32 v[120:121], v[120:121], v[8:9] op_sel_hi:[1,0] neg_lo:[0,1] neg_hi:[0,1]
    v_cvt_pk_bf16_f32 v10, v120, v121
    v_lshlrev_b32 v120, 16, v10
    v_and_b32 v121, 0xffff0000, v10
    v_pk_mul_f32 v[120:121], v[120:121], v[8:9] op_sel:[0,1] op_sel_hi:[1,1]
    v_cvt_pk_bf16_f32 v12, v120, v121
    v_lshlrev_b32 v120, 16, v12
    v_and_b32 v121, 0xffff0000, v12
    v_pk_add_f32 v[122:123], v[122:123], v[8:9] op_sel_hi:[1,0] neg_lo:[0,1] neg_hi:[0,1]
    v_cvt_pk_bf16_f32 v11, v122, v123
    v_lshlrev_b32 v122, 16, v11
    v_and_b32 v123, 0xffff0000, v11
    v_pk_mul_f32 v[122:123], v[122:123], v[8:9] op_sel:[0,1] op_sel_hi:[1,1]
    v_cvt_pk_bf16_f32 v13, v122, v123
    v_lshlrev_b32 v122, 16, v13
    v_and_b32 v123, 0xffff0000, v13
    v_pk_add_f32 v[124:125], v[124:125], v[8:9] op_sel_hi:[1,0] neg_lo:[0,1] neg_hi:[0,1]
    v_cvt_pk_bf16_f32 v10, v124, v125
    v_lshlrev_b32 v124, 16, v10
    v_and_b32 v125, 0xffff0000, v10
    v_pk_mul_f32 v[124:125], v[124:125], v[8:9] op_sel:[0,1] op_sel_hi:[1,1]
    v_cvt_pk_bf16_f32 v12, v124, v125
    v_lshlrev_b32 v124, 16, v12
    v_and_b32 v125, 0xffff0000, v12
    v_pk_add_f32 v[126:127], v[126:127], v[8:9] op_sel_hi:[1,0] neg_lo:[0,1] neg_hi:[0,1]
    v_cvt_pk_bf16_f32 v11, v126, v127
    v_lshlrev_b32 v126, 16, v11
    v_and_b32 v127, 0xffff0000, v11
    v_pk_mul_f32 v[126:127], v[126:127], v[8:9] op_sel:[0,1] op_sel_hi:[1,1]
    v_cvt_pk_bf16_f32 v13, v126, v127
    v_lshlrev_b32 v126, 16, v13
    v_and_b32 v127, 0xffff0000, v13
    v_pk_add_f32 v[128:129], v[128:129], v[8:9] op_sel_hi:[1,0] neg_lo:[0,1] neg_hi:[0,1]
    v_cvt_pk_bf16_f32 v10, v128, v129
    v_lshlrev_b32 v128, 16, v10
    v_and_b32 v129, 0xffff0000, v10
    v_pk_mul_f32 v[128:129], v[128:129], v[8:9] op_sel:[0,1] op_sel_hi:[1,1]
    v_cvt_pk_bf16_f32 v12, v128, v129
    v_lshlrev_b32 v128, 16, v12
    v_and_b32 v129, 0xffff0000, v12
    v_pk_add_f32 v[130:131], v[130:131], v[8:9] op_sel_hi:[1,0] neg_lo:[0,1] neg_hi:[0,1]
    v_cvt_pk_bf16_f32 v11, v130, v131
    v_lshlrev_b32 v130, 16, v11
    v_and_b32 v131, 0xffff0000, v11
    v_pk_mul_f32 v[130:131], v[130:131], v[8:9] op_sel:[0,1] op_sel_hi:[1,1]
    v_cvt_pk_bf16_f32 v13, v130, v131
    v_lshlrev_b32 v130, 16, v13
    v_and_b32 v131, 0xffff0000, v13
    v_pk_add_f32 v[132:133], v[132:133], v[8:9] op_sel_hi:[1,0] neg_lo:[0,1] neg_hi:[0,1]
    v_cvt_pk_bf16_f32 v10, v132, v133
    v_lshlrev_b32 v132, 16, v10
    v_and_b32 v133, 0xffff0000, v10
    v_pk_mul_f32 v[132:133], v[132:133], v[8:9] op_sel:[0,1] op_sel_hi:[1,1]
    v_cvt_pk_bf16_f32 v12, v132, v133
    v_lshlrev_b32 v132, 16, v12
    v_and_b32 v133, 0xffff0000, v12
    v_pk_add_f32 v[134:135], v[134:135], v[8:9] op_sel_hi:[1,0] neg_lo:[0,1] neg_hi:[0,1]
    v_cvt_pk_bf16_f32 v11, v134, v135
    v_lshlrev_b32 v134, 16, v11
    v_and_b32 v135, 0xffff0000, v11
    v_pk_mul_f32 v[134:135], v[134:135], v[8:9] op_sel:[0,1] op_sel_hi:[1,1]
    v_cvt_pk_bf16_f32 v13, v134, v135
    v_lshlrev_b32 v134, 16, v13
    v_and_b32 v135, 0xffff0000, v13
    v_pk_mul_f32 v[96:97], v[96:97], v[16:17]
    v_cvt_pk_bf16_f32 v10, v96, v97
    v_lshlrev_b32 v96, 16, v10
    v_and_b32 v97, 0xffff0000, v10
    v_pk_add_f32 v[96:97], v[96:97], v[56:57]
    v_cvt_pk_bf16_f32 v136, v96, v97
    v_pk_mul_f32 v[98:99], v[98:99], v[18:19]
    v_cvt_pk_bf16_f32 v10, v98, v99
    v_lshlrev_b32 v98, 16, v10
    v_and_b32 v99, 0xffff0000, v10
    v_pk_add_f32 v[98:99], v[98:99], v[58:59]
    v_cvt_pk_bf16_f32 v137, v98, v99
    v_pk_mul_f32 v[100:101], v[100:101], v[20:21]
    v_cvt_pk_bf16_f32 v10, v100, v101
    v_lshlrev_b32 v100, 16, v10
    v_and_b32 v101, 0xffff0000, v10
    v_pk_add_f32 v[100:101], v[100:101], v[60:61]
    v_cvt_pk_bf16_f32 v138, v100, v101
    v_pk_mul_f32 v[102:103], v[102:103], v[22:23]
    v_cvt_pk_bf16_f32 v10, v102, v103
    v_lshlrev_b32 v102, 16, v10
    v_and_b32 v103, 0xffff0000, v10
    v_pk_add_f32 v[102:103], v[102:103], v[62:63]
    v_cvt_pk_bf16_f32 v139, v102, v103
    ds_write_b128 v177, v[136:139] offset:0
    v_pk_mul_f32 v[104:105], v[104:105], v[24:25]
    v_cvt_pk_bf16_f32 v10, v104, v105
    v_lshlrev_b32 v104, 16, v10
    v_and_b32 v105, 0xffff0000, v10
    v_pk_add_f32 v[104:105], v[104:105], v[64:65]
    v_cvt_pk_bf16_f32 v140, v104, v105
    v_pk_mul_f32 v[106:107], v[106:107], v[26:27]
    v_cvt_pk_bf16_f32 v10, v106, v107
    v_lshlrev_b32 v106, 16, v10
    v_and_b32 v107, 0xffff0000, v10
    v_pk_add_f32 v[106:107], v[106:107], v[66:67]
    v_cvt_pk_bf16_f32 v141, v106, v107
    v_pk_mul_f32 v[108:109], v[108:109], v[28:29]
    v_cvt_pk_bf16_f32 v10, v108, v109
    v_lshlrev_b32 v108, 16, v10
    v_and_b32 v109, 0xffff0000, v10
    v_pk_add_f32 v[108:109], v[108:109], v[68:69]
    v_cvt_pk_bf16_f32 v142, v108, v109
    v_pk_mul_f32 v[110:111], v[110:111], v[30:31]
    v_cvt_pk_bf16_f32 v10, v110, v111
    v_lshlrev_b32 v110, 16, v10
    v_and_b32 v111, 0xffff0000, v10
    v_pk_add_f32 v[110:111], v[110:111], v[70:71]
    v_cvt_pk_bf16_f32 v143, v110, v111
    ds_write_b128 v177, v[140:143] offset:4096
    v_pk_mul_f32 v[112:113], v[112:113], v[32:33]
    v_cvt_pk_bf16_f32 v10, v112, v113
    v_lshlrev_b32 v112, 16, v10
    v_and_b32 v113, 0xffff0000, v10
    v_pk_add_f32 v[112:113], v[112:113], v[72:73]
    v_cvt_pk_bf16_f32 v144, v112, v113
    v_pk_mul_f32 v[114:115], v[114:115], v[34:35]
    v_cvt_pk_bf16_f32 v10, v114, v115
    v_lshlrev_b32 v114, 16, v10
    v_and_b32 v115, 0xffff0000, v10
    v_pk_add_f32 v[114:115], v[114:115], v[74:75]
    v_cvt_pk_bf16_f32 v145, v114, v115
    v_pk_mul_f32 v[116:117], v[116:117], v[36:37]
    v_cvt_pk_bf16_f32 v10, v116, v117
    v_lshlrev_b32 v116, 16, v10
    v_and_b32 v117, 0xffff0000, v10
    v_pk_add_f32 v[116:117], v[116:117], v[76:77]
    v_cvt_pk_bf16_f32 v146, v116, v117
    v_pk_mul_f32 v[118:119], v[118:119], v[38:39]
    v_cvt_pk_bf16_f32 v10, v118, v119
    v_lshlrev_b32 v118, 16, v10
    v_and_b32 v119, 0xffff0000, v10
    v_pk_add_f32 v[118:119], v[118:119], v[78:79]
    v_cvt_pk_bf16_f32 v147, v118, v119
    ds_write_b128 v177, v[144:147] offset:8192
    v_pk_mul_f32 v[120:121], v[120:121], v[40:41]
    v_cvt_pk_bf16_f32 v10, v120, v121
    v_lshlrev_b32 v120, 16, v10
    v_and_b32 v121, 0xffff0000, v10
    v_pk_add_f32 v[120:121], v[120:121], v[80:81]
    v_cvt_pk_bf16_f32 v148, v120, v121
    v_pk_mul_f32 v[122:123], v[122:123], v[42:43]
    v_cvt_pk_bf16_f32 v10, v122, v123
    v_lshlrev_b32 v122, 16, v10
    v_and_b32 v123, 0xffff0000, v10
    v_pk_add_f32 v[122:123], v[122:123], v[82:83]
    v_cvt_pk_bf16_f32 v149, v122, v123
    v_pk_mul_f32 v[124:125], v[124:125], v[44:45]
    v_cvt_pk_bf16_f32 v10, v124, v125
    v_lshlrev_b32 v124, 16, v10
    v_and_b32 v125, 0xffff0000, v10
    v_pk_add_f32 v[124:125], v[124:125], v[84:85]
    v_cvt_pk_bf16_f32 v150, v124, v125
    v_pk_mul_f32 v[126:127], v[126:127], v[46:47]
    v_cvt_pk_bf16_f32 v10, v126, v127
    v_lshlrev_b32 v126, 16, v10
    v_and_b32 v127, 0xffff0000, v10
    v_pk_add_f32 v[126:127], v[126:127], v[86:87]
    v_cvt_pk_bf16_f32 v151, v126, v127
    ds_write_b128 v177, v[148:151] offset:12288
    v_pk_mul_f32 v[128:129], v[128:129], v[48:49]
    v_cvt_pk_bf16_f32 v10, v128, v129
    v_lshlrev_b32 v128, 16, v10
    v_and_b32 v129, 0xffff0000, v10
    v_pk_add_f32 v[128:129], v[128:129], v[88:89]
    v_cvt_pk_bf16_f32 v152, v128, v129
    v_pk_mul_f32 v[130:131], v[130:131], v[50:51]
    v_cvt_pk_bf16_f32 v10, v130, v131
    v_lshlrev_b32 v130, 16, v10
    v_and_b32 v131, 0xffff0000, v10
    v_pk_add_f32 v[130:131], v[130:131], v[90:91]
    v_cvt_pk_bf16_f32 v153, v130, v131
    v_pk_mul_f32 v[132:133], v[132:133], v[52:53]
    v_cvt_pk_bf16_f32 v10, v132, v133
    v_lshlrev_b32 v132, 16, v10
    v_and_b32 v133, 0xffff0000, v10
    v_pk_add_f32 v[132:133], v[132:133], v[92:93]
    v_cvt_pk_bf16_f32 v154, v132, v133
    v_pk_mul_f32 v[134:135], v[134:135], v[54:55]
    v_cvt_pk_bf16_f32 v10, v134, v135
    v_lshlrev_b32 v134, 16, v10
    v_and_b32 v135, 0xffff0000, v10
    v_pk_add_f32 v[134:135], v[134:135], v[94:95]
    v_cvt_pk_bf16_f32 v155, v134, v135
    ds_write_b128 v177, v[152:155] offset:16384
    s_cmp_eq_u32 s25, 0
    s_cbranch_scc0 L_mu_nf2
    s_waitcnt vmcnt(0)
    ds_write_b32 v179, v180
L_mu_nf2:
    s_waitcnt lgkmcnt(0)
    s_barrier
    ds_read_b32 v180, v179
    s_cmp_eq_u32 s51, 0
    s_cbranch_scc1 L_mu_nopend
    v_lshlrev_b32 v14, 9, v1
    v_mov_b32 v15, 1
    s_mov_b32 exec_lo, 1023
    s_mov_b32 exec_hi, 0
    buffer_atomic_add v15, v14, s[12:15], s51 offen sc1
    s_mov_b64 exec, -1
L_mu_nopend:
    v_add_u32 v9, s44, v5
    s_waitcnt lgkmcnt(0)
    v_readfirstlane_b32 s52, v180
    s_cmp_lt_u32 s33, 128
    s_cselect_b32 s52, s52, 0
    s_cmp_ge_u32 s52, 20
    s_cbranch_scc0 L_mu_nopf
    s_mul_i32 s41, s33, 20480
    s_add_u32 s41, s41, 79691776
    buffer_load_dwordx4 v[136:139], v176, s[12:15], s41 offen offset:0 sc1
    buffer_load_dwordx4 v[140:143], v176, s[12:15], s41 offen offset:256 sc1
    buffer_load_dwordx4 v[144:147], v176, s[12:15], s41 offen offset:512 sc1
    buffer_load_dwordx4 v[148:151], v176, s[12:15], s41 offen offset:768 sc1
    buffer_load_dwordx4 v[152:155], v176, s[12:15], s41 offen offset:1024 sc1
L_mu_nopf:
    ds_read_b128 v[96:99], v9 offset:0
    ds_read_b128 v[100:103], v9 offset:1024
    ds_read_b128 v[104:107], v9 offset:2048
    ds_read_b128 v[108:111], v9 offset:3072
    ds_read_b128 v[112:115], v9 offset:4096
    ds_read_b128 v[116:119], v9 offset:5120
    ds_read_b128 v[120:123], v9 offset:6144
    ds_read_b128 v[124:127], v9 offset:7168
    s_waitcnt lgkmcnt(7)
    v_mfma_f32_16x16x32_bf16 v[160:163], a[0:3], v[96:99], 0
    v_mfma_f32_16x16x32_bf16 v[164:167], a[4:7], v[96:99], 0
    v_mfma_f32_16x16x32_bf16 v[168:171], a[8:11], v[96:99], 0
    v_mfma_f32_16x16x32_bf16 v[172:175], a[12:15], v[96:99], 0
    ds_read_b128 v[96:99], v9 offset:8192
    s_waitcnt lgkmcnt(7)
    v_mfma_f32_16x16x32_bf16 v[160:163], a[16:19], v[100:103], v[160:163]
    v_mfma_f32_16x16x32_bf16 v[164:167], a[20:23], v[100:103], v[164:167]
    v_mfma_f32_16x16x32_bf16 v[168:171], a[24:27], v[100:103], v[168:171]
    v_mfma_f32_16x16x32_bf16 v[172:175], a[28:31], v[100:103], v[172:175]
    ds_read_b128 v[100:103], v9 offset:9216
    s_waitcnt lgkmcnt(7)
    v_mfma_f32_16x16x32_bf16 v[160:163], a[32:35], v[104:107], v[160:163]
    v_mfma_f32_16x16x32_bf16 v[164:167], a[36:39], v[104:107], v[164:167]
    v_mfma_f32_16x16x32_bf16 v[168:171], a[40:43], v[104:107], v[168:171]
    v_mfma_f32_16x16x32_bf16 v[172:175], a[44:47], v[104:107], v[172:175]
    ds_read_b128 v[104:107], v9 offset:10240
    s_waitcnt lgkmcnt(7)
    v_mfma_f32_16x16x32_bf16 v[160:163], a[48:51], v[108:111], v[160:163]
    v_mfma_f32_16x16x32_bf16 v[164:167], a[52:55], v[108:111], v[164:167]
    v_mfma_f32_16x16x32_bf16 v[168:171], a[56:59], v[108:111], v[168:171]
    v_mfma_f32_16x16x32_bf16 v[172:175], a[60:63], v[108:111], v[172:175]
    ds_read_b128 v[108:111], v9 offset:11264
    s_waitcnt lgkmcnt(7)
    v_mfma_f32_16x16x32_bf16 v[160:163], a[64:67], v[112:115], v[160:163]
    v_mfma_f32_16x16x32_bf16 v[164:167], a[68:71], v[112:115], v[164:167]
    v_mfma_f32_16x16x32_bf16 v[168:171], a[72:75], v[112:115], v[168:171]
    v_mfma_f32_16x16x32_bf16 v[172:175], a[76:79], v[112:115], v[172:175]
    ds_read_b128 v[112:115], v9 offset:12288
    s_waitcnt lgkmcnt(7)
    v_mfma_f32_16x16x32_bf16 v[160:163], a[80:83], v[116:119], v[160:163]
    v_mfma_f32_16x16x32_bf16 v[164:167], a[84:87], v[116:119], v[164:167]
    v_mfma_f32_16x16x32_bf16 v[168:171], a[88:91], v[116:119], v[168:171]
    v_mfma_f32_16x16x32_bf16 v[172:175], a[92:95], v[116:119], v[172:175]
    ds_read_b128 v[116:119], v9 offset:13312
    s_waitcnt lgkmcnt(7)
    v_mfma_f32_16x16x32_bf16 v[160:163], a[96:99], v[120:123], v[160:163]
    v_mfma_f32_16x16x32_bf16 v[164:167], a[100:103], v[120:123], v[164:167]
    v_mfma_f32_16x16x32_bf16 v[168:171], a[104:107], v[120:123], v[168:171]
    v_mfma_f32_16x16x32_bf16 v[172:175], a[108:111], v[120:123], v[172:175]
    ds_read_b128 v[120:123], v9 offset:14336
    s_waitcnt lgkmcnt(7)
    v_mfma_f32_16x16x32_bf16 v[160:163], a[112:115], v[124:127], v[160:163]
    v_mfma_f32_16x16x32_bf16 v[164:167], a[116:119], v[124:127], v[164:167]
    v_mfma_f32_16x16x32_bf16 v[168:171], a[120:123], v[124:127], v[168:171]
    v_mfma_f32_16x16x32_bf16 v[172:175], a[124:127], v[124:127], v[172:175]
    ds_read_b128 v[124:127], v9 offset:15360
    s_waitcnt lgkmcnt(7)
    v_mfma_f32_16x16x32_bf16 v[160:163], a[128:131], v[96:99], v[160:163]
    v_mfma_f32_16x16x32_bf16 v[164:167], a[132:135], v[96:99], v[164:167]
    v_mfma_f32_16x16x32_bf16 v[168:171], a[136:139], v[96:99], v[168:171]
    v_mfma_f32_16x16x32_bf16 v[172:175], a[140:143], v[96:99], v[172:175]
    ds_read_b128 v[96:99], v9 offset:16384
    s_waitcnt lgkmcnt(7)
    v_mfma_f32_16x16x32_bf16 v[160:163], a[144:147], v[100:103], v[160:163]
    v_mfma_f32_16x16x32_bf16 v[164:167], a[148:151], v[100:103], v[164:167]
    v_mfma_f32_16x16x32_bf16 v[168:171], a[152:155], v[100:103], v[168:171]
    v_mfma_f32_16x16x32_bf16 v[172:175], a[156:159], v[100:103], v[172:175]
    ds_read_b128 v[100:103], v9 offset:17408
    s_waitcnt lgkmcnt(7)
    v_mfma_f32_16x16x32_bf16 v[160:163], a[160:163], v[104:107], v[160:163]
    v_mfma_f32_16x16x32_bf16 v[164:167], a[164:167], v[104:107], v[164:167]
    v_mfma_f32_16x16x32_bf16 v[168:171], a[168:171], v[104:107], v[168:171]
    v_mfma_f32_16x16x32_bf16 v[172:175], a[172:175], v[104:107], v[172:175]
    ds_read_b128 v[104:107], v9 offset:18432
    s_waitcnt lgkmcnt(7)
    v_mfma_f32_16x16x32_bf16 v[160:163], a[176:179], v[108:111], v[160:163]
    v_mfma_f32_16x16x32_bf16 v[164:167], a[180:183], v[108:111], v[164:167]
    v_mfma_f32_16x16x32_bf16 v[168:171], a[184:187], v[108:111], v[168:171]
    v_mfma_f32_16x16x32_bf16 v[172:175], a[188:191], v[108:111], v[172:175]
    ds_read_b128 v[108:111], v9 offset:19456
    s_waitcnt lgkmcnt(7)
    v_mfma_f32_16x16x32_bf16 v[160:163], a[192:195], v[112:115], v[160:163]
    v_mfma_f32_16x16x32_bf16 v[164:167], a[196:199], v[112:115], v[164:167]
    v_mfma_f32_16x16x32_bf16 v[168:171], a[200:203], v[112:115], v[168:171]
    v_mfma_f32_16x16x32_bf16 v[172:175], a[204:207], v[112:115], v[172:175]
    s_waitcnt lgkmcnt(6)
    v_mfma_f32_16x16x32_bf16 v[160:163], a[208:211], v[116:119], v[160:163]
    v_mfma_f32_16x16x32_bf16 v[164:167], a[212:215], v[116:119], v[164:167]
    v_mfma_f32_16x16x32_bf16 v[168:171], a[216:219], v[116:119], v[168:171]
    v_mfma_f32_16x16x32_bf16 v[172:175], a[220:223], v[116:119], v[172:175]
    s_waitcnt lgkmcnt(5)
    v_mfma_f32_16x16x32_bf16 v[160:163], a[224:227], v[120:123], v[160:163]
    v_mfma_f32_16x16x32_bf16 v[164:167], a[228:231], v[120:123], v[164:167]
    v_mfma_f32_16x16x32_bf16 v[168:171], a[232:235], v[120:123], v[168:171]
    v_mfma_f32_16x16x32_bf16 v[172:175], a[236:239], v[120:123], v[172:175]
    s_waitcnt lgkmcnt(4)
    v_mfma_f32_16x16x32_bf16 v[160:163], a[240:243], v[124:127], v[160:163]
    v_mfma_f32_16x16x32_bf16 v[164:167], a[244:247], v[124:127], v[164:167]
    v_mfma_f32_16x16x32_bf16 v[168:171], a[248:251], v[124:127], v[168:171]
    v_mfma_f32_16x16x32_bf16 v[172:175], a[252:255], v[124:127], v[172:175]
    s_waitcnt lgkmcnt(3)
    v_mfma_f32_16x16x32_bf16 v[160:163], v[192:195], v[96:99], v[160:163]
    v_mfma_f32_16x16x32_bf16 v[164:167], v[196:199], v[96:99], v[164:167]
    v_mfma_f32_16x16x32_bf16 v[168:171], v[200:203], v[96:99], v[168:171]
    v_mfma_f32_16x16x32_bf16 v[172:175], v[204:207], v[96:99], v[172:175]
    s_waitcnt lgkmcnt(2)
    v_mfma_f32_16x16x32_bf16 v[160:163], v[208:211], v[100:103], v[160:163]
    v_mfma_f32_16x16x32_bf16 v[164:167], v[212:215], v[100:103], v[164:167]
    v_mfma_f32_16x16x32_bf16 v[168:171], v[216:219], v[100:103], v[168:171]
    v_mfma_f32_16x16x32_bf16 v[172:175], v[220:223], v[100:103], v[172:175]
    s_waitcnt lgkmcnt(1)
    v_mfma_f32_16x16x32_bf16 v[160:163], v[224:227], v[104:107], v[160:163]
    v_mfma_f32_16x16x32_bf16 v[164:167], v[228:231], v[104:107], v[164:167]
    v_mfma_f32_16x16x32_bf16 v[168:171], v[232:235], v[104:107], v[168:171]
    v_mfma_f32_16x16x32_bf16 v[172:175], v[236:239], v[104:107], v[172:175]
    s_waitcnt lgkmcnt(0)
    v_mfma_f32_16x16x32_bf16 v[160:163], v[240:243], v[108:111], v[160:163]
    v_mfma_f32_16x16x32_bf16 v[164:167], v[244:247], v[108:111], v[164:167]
    v_mfma_f32_16x16x32_bf16 v[168:171], v[248:251], v[108:111], v[168:171]
    v_mfma_f32_16x16x32_bf16 v[172:175], v[252:255], v[108:111], v[172:175]
    v_cvt_pk_bf16_f32 v10, v160, v164
    v_lshlrev_b32 v160, 16, v10
    v_and_b32 v164, 0xffff0000, v10
    s_nop 4
    v_cvt_pk_bf16_f32 v10, v168, v172
    v_lshlrev_b32 v168, 16, v10
    v_and_b32 v172, 0xffff0000, v10
    v_mul_f32 v11, s47, v160
    v_exp_f32 v11, v11
    s_nop 0
    v_add_f32 v11, 1.0, v11
    v_rcp_f32 v11, v11
    s_nop 0
    v_mul_f32 v160, v160, v11
    v_mul_f32 v12, s47, v164
    v_exp_f32 v12, v12
    s_nop 0
    v_add_f32 v12, 1.0, v12
    v_rcp_f32 v12, v12
    s_nop 0
    v_mul_f32 v164, v164, v12
    v_cvt_pk_bf16_f32 v10, v160, v164
    v_lshlrev_b32 v160, 16, v10
    v_and_b32 v164, 0xffff0000, v10
    v_mul_f32 v160, v160, v168
    v_mul_f32 v164, v164, v172
    v_cvt_pk_bf16_f32 v128, v160, v164
    v_cvt_pk_bf16_f32 v10, v161, v165
    v_lshlrev_b32 v161, 16, v10
    v_and_b32 v165, 0xffff0000, v10
    v_cvt_pk_bf16_f32 v10, v169, v173
    v_lshlrev_b32 v169, 16, v10
    v_and_b32 v173, 0xffff0000, v10
    v_mul_f32 v11, s47, v161
    v_exp_f32 v11, v11
    s_nop 0
    v_add_f32 v11, 1.0, v11
    v_rcp_f32 v11, v11
    s_nop 0
    v_mul_f32 v161, v161, v11
    v_mul_f32 v12, s47, v165
    v_exp_f32 v12, v12
    s_nop 0
    v_add_f32 v12, 1.0, v12
    v_rcp_f32 v12, v12
    s_nop 0
    v_mul_f32 v165, v165, v12
    v_cvt_pk_bf16_f32 v10, v161, v165
    v_lshlrev_b32 v161, 16, v10
    v_and_b32 v165, 0xffff0000, v10
    v_mul_f32 v161, v161, v169
    v_mul_f32 v165, v165, v173
    v_cvt_pk_bf16_f32 v129, v161, v165
    v_cvt_pk_bf16_f32 v10, v162, v166
    v_lshlrev_b32 v162, 16, v10
    v_and_b32 v166, 0xffff0000, v10
    v_cvt_pk_bf16_f32 v10, v170, v174
    v_lshlrev_b32 v170, 16, v10
    v_and_b32 v174, 0xffff0000, v10
    v_mul_f32 v11, s47, v162
    v_exp_f32 v11, v11
    s_nop 0
    v_add_f32 v11, 1.0, v11
    v_rcp_f32 v11, v11
    s_nop 0
    v_mul_f32 v162, v162, v11
    v_mul_f32 v12, s47, v166
    v_exp_f32 v12, v12
    s_nop 0
    v_add_f32 v12, 1.0, v12
    v_rcp_f32 v12, v12
    s_nop 0
    v_mul_f32 v166, v166, v12
    v_cvt_pk_bf16_f32 v10, v162, v166
    v_lshlrev_b32 v162, 16, v10
    v_and_b32 v166, 0xffff0000, v10
    v_mul_f32 v162, v162, v170
    v_mul_f32 v166, v166, v174
    v_cvt_pk_bf16_f32 v130, v162, v166
    v_cvt_pk_bf16_f32 v10, v163, v167
    v_lshlrev_b32 v163, 16, v10
    v_and_b32 v167, 0xffff0000, v10
    v_cvt_pk_bf16_f32 v10, v171, v175
    v_lshlrev_b32 v171, 16, v10
    v_and_b32 v175, 0xffff0000, v10
    v_mul_f32 v11, s47, v163
    v_exp_f32 v11, v11
    s_nop 0
    v_add_f32 v11, 1.0, v11
    v_rcp_f32 v11, v11
    s_nop 0
    v_mul_f32 v163, v163, v11
    v_mul_f32 v12, s47, v167
    v_exp_f32 v12, v12
    s_nop 0
    v_add_f32 v12, 1.0, v12
    v_rcp_f32 v12, v12
    s_nop 0
    v_mul_f32 v167, v167, v12
    v_cvt_pk_bf16_f32 v10, v163, v167
    v_lshlrev_b32 v163, 16, v10
    v_and_b32 v167, 0xffff0000, v10
    v_mul_f32 v163, v163, v171
    v_mul_f32 v167, v167, v175
    v_cvt_pk_bf16_f32 v131, v163, v167
    buffer_store_dwordx4 v[128:131], v5, s[12:15], s38 offen sc1
    s_add_u32 s49, s48, 116540416
    s_xor_b32 s44, s44, 20480
    v_xor_b32 v177, 0x5000, v177
    v_xor_b32 v179, 4, v179
    s_cmp_eq_u32 s25, 0
    s_cselect_b32 s51, s49, 0
    s_cmp_ge_u32 s52, 20
    s_cbranch_scc1 L_mu_loop
    s_mov_b32 s51, 0
    s_waitcnt vmcnt(0)
    s_barrier
    s_cmp_eq_u32 s25, 0
    s_cbranch_scc0 L_wgs_52
    v_lshlrev_b32 v14, 9, v1
    v_mov_b32 v15, 1
    s_mov_b32 exec_lo, 1023
    s_mov_b32 exec_hi, 0
    buffer_atomic_add v15, v14, s[12:15], s49 offen sc1
    s_mov_b64 exec, -1
L_wgs_52:
    s_cmp_lt_u32 s33, 128
    s_cbranch_scc1 L_mu_wait
    s_branch L_mega_done
L_mega_dn:
    s_sub_u32 s24, s2, 0
    s_mov_b32 s20, 429496730
    s_mul_hi_u32 s21, s24, s20
    s_mul_i32 s20, s21, 10
    s_sub_u32 s20, s24, s20
L_mega_dn2:
    s_load_dwordx2 s[4:5], s[0:1], 80
    s_load_dwordx2 s[16:17], s[0:1], 104
    s_mov_b32 s22, s25
    s_waitcnt lgkmcnt(0)
    s_mov_b32 s6, 2211840
    s_mov_b32 s7, 0x00020000
    s_mov_b32 s18, 2621440
    s_mov_b32 s19, 0x00020000
    s_mov_b32 s23, 0
    s_cmp_eq_u32 s22, 1
    s_cselect_b32 s23, 14, s23
    s_cmp_eq_u32 s22, 2
    s_cselect_b32 s23, 28, s23
    s_cmp_eq_u32 s22, 3
    s_cselect_b32 s23, 41, s23
    s_mov_b32 s24, 10240
    v_mul_lo_u32 v4, v3, s24
    v_lshl_add_u32 v4, v2, 3, v4
    s_lshl_b32 s24, s20, 7
    v_add_u32 v4, s24, v4
    s_mul_i32 s32, s23, 40960
    s_mov_b32 s34, 0x05040100
    s_mov_b32 s35, 0x07060302
    buffer_load_dwordx2 v[32:33], v4, s[4:7], s32 offen
    s_add_u32 s32, s32, 1280
    buffer_load_dwordx2 v[34:35], v4, s[4:7], s32 offen
    s_add_u32 s32, s32, 1280
    buffer_load_dwordx2 v[36:37], v4, s[4:7], s32 offen
    s_add_u32 s32, s32, 1280
    buffer_load_dwordx2 v[38:39], v4, s[4:7], s32 offen
    s_add_u32 s32, s32, 1280
    buffer_load_dwordx2 v[40:41], v4, s[4:7], s32 offen
    s_add_u32 s32, s32, 1280
    buffer_load_dwordx2 v[42:43], v4, s[4:7], s32 offen
    s_add_u32 s32, s32, 1280
    buffer_load_dwordx2 v[44:45], v4, s[4:7], s32 offen
    s_add_u32 s32, s32, 1280
    buffer_load_dwordx2 v[46:47], v4, s[4:7], s32 offen
    s_add_u32 s32, s32, 32000
    buffer_load_dwordx2 v[48:49], v4, s[4:7], s32 offen
    s_add_u32 s32, s32, 1280
    buffer_load_dwordx2 v[50:51], v4, s[4:7], s32 offen
    s_add_u32 s32, s32, 1280
    buffer_load_dwordx2 v[52:53], v4, s[4:7], s32 offen
    s_add_u32 s32, s32, 1280
    buffer_load_dwordx2 v[54:55], v4, s[4:7], s32 offen
    s_add_u32 s32, s32, 1280
    buffer_load_dwordx2 v[56:57], v4, s[4:7], s32 offen
    s_add_u32 s32, s32, 1280
    buffer_load_dwordx2 v[58:59], v4, s[4:7], s32 offen
    s_add_u32 s32, s32, 1280
    buffer_load_dwordx2 v[60:61], v4, s[4:7], s32 offen
    s_add_u32 s32, s32, 1280
    buffer_load_dwordx2 v[62:63], v4, s[4:7], s32 offen
    s_add_u32 s32, s32, 32000
    buffer_load_dwordx2 v[64:65], v4, s[4:7], s32 offen
    s_add_u32 s32, s32, 1280
    buffer_load_dwordx2 v[66:67], v4, s[4:7], s32 offen
    s_add_u32 s32, s32, 1280
    buffer_load_dwordx2 v[68:69], v4, s[4:7], s32 offen
    s_add_u32 s32, s32, 1280
    buffer_load_dwordx2 v[70:71], v4, s[4:7], s32 offen
    s_add_u32 s32, s32, 1280
    buffer_load_dwordx2 v[72:73], v4, s[4:7], s32 offen
    s_add_u32 s32, s32, 1280
    buffer_load_dwordx2 v[74:75], v4, s[4:7], s32 offen
    s_add_u32 s32, s32, 1280
    buffer_load_dwordx2 v[76:77], v4, s[4:7], s32 offen
    s_add_u32 s32, s32, 1280
    buffer_load_dwordx2 v[78:79], v4, s[4:7], s32 offen
    s_add_u32 s32, s32, 32000
    buffer_load_dwordx2 v[80:81], v4, s[4:7], s32 offen
    s_add_u32 s32, s32, 1280
    buffer_load_dwordx2 v[82:83], v4, s[4:7], s32 offen
    s_add_u32 s32, s32, 1280
    buffer_load_dwordx2 v[84:85], v4, s[4:7], s32 offen
    s_add_u32 s32, s32, 1280
    buffer_load_dwordx2 v[86:87], v4, s[4:7], s32 offen
    s_add_u32 s32, s32, 1280
    buffer_load_dwordx2 v[88:89], v4, s[4:7], s32 offen
    s_add_u32 s32, s32, 1280
    buffer_load_dwordx2 v[90:91], v4, s[4:7], s32 offen
    s_add_u32 s32, s32, 1280
    buffer_load_dwordx2 v[92:93], v4, s[4:7], s32 offen
    s_add_u32 s32, s32, 1280
    buffer_load_dwordx2 v[94:95], v4, s[4:7], s32 offen
    s_add_u32 s32, s32, 32000
    s_waitcnt vmcnt(16)
    v_perm_b32 v96, v34, v32, s34
    v_accvgpr_write_b32 a0, v96
    v_perm_b32 v97, v38, v36, s34
    v_accvgpr_write_b32 a1, v97
    v_perm_b32 v96, v42, v40, s34
    v_accvgpr_write_b32 a2, v96
    v_perm_b32 v97, v46, v44, s34
    v_accvgpr_write_b32 a3, v97
    v_perm_b32 v96, v34, v32, s35
    v_accvgpr_write_b32 a4, v96
    v_perm_b32 v97, v38, v36, s35
    v_accvgpr_write_b32 a5, v97
    v_perm_b32 v96, v42, v40, s35
    v_accvgpr_write_b32 a6, v96
    v_perm_b32 v97, v46, v44, s35
    v_accvgpr_write_b32 a7, v97
    v_perm_b32 v96, v35, v33, s34
    v_accvgpr_write_b32 a8, v96
    v_perm_b32 v97, v39, v37, s34
    v_accvgpr_write_b32 a9, v97
    v_perm_b32 v96, v43, v41, s34
    v_accvgpr_write_b32 a10, v96
    v_perm_b32 v97, v47, v45, s34
    v_accvgpr_write_b32 a11, v97
    v_perm_b32 v96, v35, v33, s35
    v_accvgpr_write_b32 a12, v96
    v_perm_b32 v97, v39, v37, s35
    v_accvgpr_write_b32 a13, v97
    v_perm_b32 v96, v43, v41, s35
    v_accvgpr_write_b32 a14, v96
    v_perm_b32 v97, v47, v45, s35
    v_accvgpr_write_b32 a15, v97
    v_perm_b32 v96, v50, v48, s34
    v_accvgpr_write_b32 a16, v96
    v_perm_b32 v97, v54, v52, s34
    v_accvgpr_write_b32 a17, v97
    v_perm_b32 v96, v58, v56, s34
    v_accvgpr_write_b32 a18, v96
    v_perm_b32 v97, v62, v60, s34
    v_accvgpr_write_b32 a19, v97
    v_perm_b32 v96, v50, v48, s35
    v_accvgpr_write_b32 a20, v96
    v_perm_b32 v97, v54, v52, s35
    v_accvgpr_write_b32 a21, v97
    v_perm_b32 v96, v58, v56, s35
    v_accvgpr_write_b32 a22, v96
    v_perm_b32 v97, v62, v60, s35
    v_accvgpr_write_b32 a23, v97
    v_perm_b32 v96, v51, v49, s34
    v_accvgpr_write_b32 a24, v96
    v_perm_b32 v97, v55, v53, s34
    v_accvgpr_write_b32 a25, v97
    v_perm_b32 v96, v59, v57, s34
    v_accvgpr_write_b32 a26, v96
    v_perm_b32 v97, v63, v61, s34
    v_accvgpr_write_b32 a27, v97
    v_perm_b32 v96, v51, v49, s35
    v_accvgpr_write_b32 a28, v96
    v_perm_b32 v97, v55, v53, s35
    v_accvgpr_write_b32 a29, v97
    v_perm_b32 v96, v59, v57, s35
    v_accvgpr_write_b32 a30, v96
    v_perm_b32 v97, v63, v61, s35
    v_accvgpr_write_b32 a31, v97
    buffer_load_dwordx2 v[32:33], v4, s[4:7], s32 offen
    s_add_u32 s32, s32, 1280
    buffer_load_dwordx2 v[34:35], v4, s[4:7], s32 offen
    s_add_u32 s32, s32, 1280
    buffer_load_dwordx2 v[36:37], v4, s[4:7], s32 offen
    s_add_u32 s32, s32, 1280
    buffer_load_dwordx2 v[38:39], v4, s[4:7], s32 offen
    s_add_u32 s32, s32, 1280
    buffer_load_dwordx2 v[40:41], v4, s[4:7], s32 offen
    s_add_u32 s32, s32, 1280
    buffer_load_dwordx2 v[42:43], v4, s[4:7], s32 offen
    s_add_u32 s32, s32, 1280
    buffer_load_dwordx2 v[44:45], v4, s[4:7], s32 offen
    s_add_u32 s32, s32, 1280
    buffer_load_dwordx2 v[46:47], v4, s[4:7], s32 offen
    s_add_u32 s32, s32, 32000
    buffer_load_dwordx2 v[48:49], v4, s[4:7], s32 offen
    s_add_u32 s32, s32, 1280
    buffer_load_dwordx2 v[50:51], v4, s[4:7], s32 offen
    s_add_u32 s32, s32, 1280
    buffer_load_dwordx2 v[52:53], v4, s[4:7], s32 offen
    s_add_u32 s32, s32, 1280
    buffer_load_dwordx2 v[54:55], v4, s[4:7], s32 offen
    s_add_u32 s32, s32, 1280
    buffer_load_dwordx2 v[56:57], v4, s[4:7], s32 offen
    s_add_u32 s32, s32, 1280
    buffer_load_dwordx2 v[58:59], v4, s[4:7], s32 offen
    s_add_u32 s32, s32, 1280
    buffer_load_dwordx2 v[60:61], v4, s[4:7], s32 offen
    s_add_u32 s32, s32, 1280
    buffer_load_dwordx2 v[62:63], v4, s[4:7], s32 offen
    s_add_u32 s32, s32, 32000
    s_waitcnt vmcnt(16)
    v_perm_b32 v96, v66, v64, s34
    v_accvgpr_write_b32 a32, v96
    v_perm_b32 v97, v70, v68, s34
    v_accvgpr_write_b32 a33, v97
    v_perm_b32 v96, v74, v72, s34
    v_accvgpr_write_b32 a34, v96
    v_perm_b32 v97, v78, v76, s34
    v_accvgpr_write_b32 a35, v97
    v_perm_b32 v96, v66, v64, s35
    v_accvgpr_write_b32 a36, v96
    v_perm_b32 v97, v70, v68, s35
    v_accvgpr_write_b32 a37, v97
    v_perm_b32 v96, v74, v72, s35
    v_accvgpr_write_b32 a38, v96
    v_perm_b32 v97, v78, v76, s35
    v_accvgpr_write_b32 a39, v97
    v_perm_b32 v96, v67, v65, s34
    v_accvgpr_write_b32 a40, v96
    v_perm_b32 v97, v71, v69, s34
    v_accvgpr_write_b32 a41, v97
    v_perm_b32 v96, v75, v73, s34
    v_accvgpr_write_b32 a42, v96
    v_perm_b32 v97, v79, v77, s34
    v_accvgpr_write_b32 a43, v97
    v_perm_b32 v96, v67, v65, s35
    v_accvgpr_write_b32 a44, v96
    v_perm_b32 v97, v71, v69, s35
    v_accvgpr_write_b32 a45, v97
    v_perm_b32 v96, v75, v73, s35
    v_accvgpr_write_b32 a46, v96
    v_perm_b32 v97, v79, v77, s35
    v_accvgpr_write_b32 a47, v97
    v_perm_b32 v96, v82, v80, s34
    v_accvgpr_write_b32 a48, v96
    v_perm_b32 v97, v86, v84, s34
    v_accvgpr_write_b32 a49, v97
    v_perm_b32 v96, v90, v88, s34
    v_accvgpr_write_b32 a50, v96
    v_perm_b32 v97, v94, v92, s34
    v_accvgpr_write_b32 a51, v97
    v_perm_b32 v96, v82, v80, s35
    v_accvgpr_write_b32 a52, v96
    v_perm_b32 v97, v86, v84, s35
    v_accvgpr_write_b32 a53, v97
    v_perm_b32 v96, v90, v88, s35
    v_accvgpr_write_b32 a54, v96
    v_perm_b32 v97, v94, v92, s35
    v_accvgpr_write_b32 a55, v97
    v_perm_b32 v96, v83, v81, s34
    v_accvgpr_write_b32 a56, v96
    v_perm_b32 v97, v87, v85, s34
    v_accvgpr_write_b32 a57, v97
    v_perm_b32 v96, v91, v89, s34
    v_accvgpr_write_b32 a58, v96
    v_perm_b32 v97, v95, v93, s34
    v_accvgpr_write_b32 a59, v97
    v_perm_b32 v96, v83, v81, s35
    v_accvgpr_write_b32 a60, v96
    v_perm_b32 v97, v87, v85, s35
    v_accvgpr_write_b32 a61, v97
    v_perm_b32 v96, v91, v89, s35
    v_accvgpr_write_b32 a62, v96
    v_perm_b32 v97, v95, v93, s35
    v_accvgpr_write_b32 a63, v97
    buffer_load_dwordx2 v[64:65], v4, s[4:7], s32 offen
    s_add_u32 s32, s32, 1280
    buffer_load_dwordx2 v[66:67], v4, s[4:7], s32 offen
    s_add_u32 s32, s32, 1280
    buffer_load_dwordx2 v[68:69], v4, s[4:7], s32 offen
    s_add_u32 s32, s32, 1280
    buffer_load_dwordx2 v[70:71], v4, s[4:7], s32 offen
    s_add_u32 s32, s32, 1280
    buffer_load_dwordx2 v[72:73], v4, s[4:7], s32 offen
    s_add_u32 s32, s32, 1280
    buffer_load_dwordx2 v[74:75], v4, s[4:7], s32 offen
    s_add_u32 s32, s32, 1280
    buffer_load_dwordx2 v[76:77], v4, s[4:7], s32 offen
    s_add_u32 s32, s32, 1280
    buffer_load_dwordx2 v[78:79], v4, s[4:7], s32 offen
    s_add_u32 s32, s32, 32000
    buffer_load_dwordx2 v[80:81], v4, s[4:7], s32 offen
    s_add_u32 s32, s32, 1280
    buffer_load_dwordx2 v[82:83], v4, s[4:7], s32 offen
    s_add_u32 s32, s32, 1280
    buffer_load_dwordx2 v[84:85], v4, s[4:7], s32 offen
    s_add_u32 s32, s32, 1280
    buffer_load_dwordx2 v[86:87], v4, s[4:7], s32 offen
    s_add_u32 s32, s32, 1280
    buffer_load_dwordx2 v[88:89], v4, s[4:7], s32 offen
    s_add_u32 s32, s32, 1280
    buffer_load_dwordx2 v[90:91], v4, s[4:7], s32 offen
    s_add_u32 s32, s32, 1280
    buffer_load_dwordx2 v[92:93], v4, s[4:7], s32 offen
    s_add_u32 s32, s32, 1280
    buffer_load_dwordx2 v[94:95], v4, s[4:7], s32 offen
    s_add_u32 s32, s32, 32000
    s_waitcnt vmcnt(16)
    v_perm_b32 v96, v34, v32, s34
    v_accvgpr_write_b32 a64, v96
    v_perm_b32 v97, v38, v36, s34
    v_accvgpr_write_b32 a65, v97
    v_perm_b32 v96, v42, v40, s34
    v_accvgpr_write_b32 a66, v96
    v_perm_b32 v97, v46, v44, s34
    v_accvgpr_write_b32 a67, v97
    v_perm_b32 v96, v34, v32, s35
    v_accvgpr_write_b32 a68, v96
    v_perm_b32 v97, v38, v36, s35
    v_accvgpr_write_b32 a69, v97
    v_perm_b32 v96, v42, v40, s35
    v_accvgpr_write_b32 a70, v96
    v_perm_b32 v97, v46, v44, s35
    v_accvgpr_write_b32 a71, v97
    v_perm_b32 v96, v35, v33, s34
    v_accvgpr_write_b32 a72, v96
    v_perm_b32 v97, v39, v37, s34
    v_accvgpr_write_b32 a73, v97
    v_perm_b32 v96, v43, v41, s34
    v_accvgpr_write_b32 a74, v96
    v_perm_b32 v97, v47, v45, s34
    v_accvgpr_write_b32 a75, v97
    v_perm_b32 v96, v35, v33, s35
    v_accvgpr_write_b32 a76, v96
    v_perm_b32 v97, v39, v37, s35
    v_accvgpr_write_b32 a77, v97
    v_perm_b32 v96, v43, v41, s35
    v_accvgpr_write_b32 a78, v96
    v_perm_b32 v97, v47, v45, s35
    v_accvgpr_write_b32 a79, v97
    v_perm_b32 v96, v50, v48, s34
    v_accvgpr_write_b32 a80, v96
    v_perm_b32 v97, v54, v52, s34
    v_accvgpr_write_b32 a81, v97
    v_perm_b32 v96, v58, v56, s34
    v_accvgpr_write_b32 a82, v96
    v_perm_b32 v97, v62, v60, s34
    v_accvgpr_write_b32 a83, v97
    v_perm_b32 v96, v50, v48, s35
    v_accvgpr_write_b32 a84, v96
    v_perm_b32 v97, v54, v52, s35
    v_accvgpr_write_b32 a85, v97
    v_perm_b32 v96, v58, v56, s35
    v_accvgpr_write_b32 a86, v96
    v_perm_b32 v97, v62, v60, s35
    v_accvgpr_write_b32 a87, v97
    v_perm_b32 v96, v51, v49, s34
    v_accvgpr_write_b32 a88, v96
    v_perm_b32 v97, v55, v53, s34
    v_accvgpr_write_b32 a89, v97
    v_perm_b32 v96, v59, v57, s34
    v_accvgpr_write_b32 a90, v96
    v_perm_b32 v97, v63, v61, s34
    v_accvgpr_write_b32 a91, v97
    v_perm_b32 v96, v51, v49, s35
    v_accvgpr_write_b32 a92, v96
    v_perm_b32 v97, v55, v53, s35
    v_accvgpr_write_b32 a93, v97
    v_perm_b32 v96, v59, v57, s35
    v_accvgpr_write_b32 a94, v96
    v_perm_b32 v97, v63, v61, s35
    v_accvgpr_write_b32 a95, v97
    buffer_load_dwordx2 v[32:33], v4, s[4:7], s32 offen
    s_add_u32 s32, s32, 1280
    buffer_load_dwordx2 v[34:35], v4, s[4:7], s32 offen
    s_add_u32 s32, s32, 1280
    buffer_load_dwordx2 v[36:37], v4, s[4:7], s32 offen
    s_add_u32 s32, s32, 1280
    buffer_load_dwordx2 v[38:39], v4, s[4:7], s32 offen
    s_add_u32 s32, s32, 1280
    buffer_load_dwordx2 v[40:41], v4, s[4:7], s32 offen
    s_add_u32 s32, s32, 1280
    buffer_load_dwordx2 v[42:43], v4, s[4:7], s32 offen
    s_add_u32 s32, s32, 1280
    buffer_load_dwordx2 v[44:45], v4, s[4:7], s32 offen
    s_add_u32 s32, s32, 1280
    buffer_load_dwordx2 v[46:47], v4, s[4:7], s32 offen
    s_add_u32 s32, s32, 32000
    buffer_load_dwordx2 v[48:49], v4, s[4:7], s32 offen
    s_add_u32 s32, s32, 1280
    buffer_load_dwordx2 v[50:51], v4, s[4:7], s32 offen
    s_add_u32 s32, s32, 1280
    buffer_load_dwordx2 v[52:53], v4, s[4:7], s32 offen
    s_add_u32 s32, s32, 1280
    buffer_load_dwordx2 v[54:55], v4, s[4:7], s32 offen
    s_add_u32 s32, s32, 1280
    buffer_load_dwordx2 v[56:57], v4, s[4:7], s32 offen
    s_add_u32 s32, s32, 1280
    buffer_load_dwordx2 v[58:59], v4, s[4:7], s32 offen
    s_add_u32 s32, s32, 1280
    buffer_load_dwordx2 v[60:61], v4, s[4:7], s32 offen
    s_add_u32 s32, s32, 1280
    buffer_load_dwordx2 v[62:63], v4, s[4:7], s32 offen
    s_add_u32 s32, s32, 32000
    s_waitcnt vmcnt(16)
    v_perm_b32 v96, v66, v64, s34
    v_accvgpr_write_b32 a96, v96
    v_perm_b32 v97, v70, v68, s34
    v_accvgpr_write_b32 a97, v97
    v_perm_b32 v96, v74, v72, s34
    v_accvgpr_write_b32 a98, v96
    v_perm_b32 v97, v78, v76, s34
    v_accvgpr_write_b32 a99, v97
    v_perm_b32 v96, v66, v64, s35
    v_accvgpr_write_b32 a100, v96
    v_perm_b32 v97, v70, v68, s35
    v_accvgpr_write_b32 a101, v97
    v_perm_b32 v96, v74, v72, s35
    v_accvgpr_write_b32 a102, v96
    v_perm_b32 v97, v78, v76, s35
    v_accvgpr_write_b32 a103, v97
    v_perm_b32 v96, v67, v65, s34
    v_accvgpr_write_b32 a104, v96
    v_perm_b32 v97, v71, v69, s34
    v_accvgpr_write_b32 a105, v97
    v_perm_b32 v96, v75, v73, s34
    v_accvgpr_write_b32 a106, v96
    v_perm_b32 v97, v79, v77, s34
    v_accvgpr_write_b32 a107, v97
    v_perm_b32 v96, v67, v65, s35
    v_accvgpr_write_b32 a108, v96
    v_perm_b32 v97, v71, v69, s35
    v_accvgpr_write_b32 a109, v97
    v_perm_b32 v96, v75, v73, s35
    v_accvgpr_write_b32 a110, v96
    v_perm_b32 v97, v79, v77, s35
    v_accvgpr_write_b32 a111, v97
    v_perm_b32 v96, v82, v80, s34
    v_accvgpr_write_b32 a112, v96
    v_perm_b32 v97, v86, v84, s34
    v_accvgpr_write_b32 a113, v97
    v_perm_b32 v96, v90, v88, s34
    v_accvgpr_write_b32 a114, v96
    v_perm_b32 v97, v94, v92, s34
    v_accvgpr_write_b32 a115, v97
    v_perm_b32 v96, v82, v80, s35
    v_accvgpr_write_b32 a116, v96
    v_perm_b32 v97, v86, v84, s35
    v_accvgpr_write_b32 a117, v97
    v_perm_b32 v96, v90, v88, s35
    v_accvgpr_write_b32 a118, v96
    v_perm_b32 v97, v94, v92, s35
    v_accvgpr_write_b32 a119, v97
    v_perm_b32 v96, v83, v81, s34
    v_accvgpr_write_b32 a120, v96
    v_perm_b32 v97, v87, v85, s34
    v_accvgpr_write_b32 a121, v97
    v_perm_b32 v96, v91, v89, s34
    v_accvgpr_write_b32 a122, v96
    v_perm_b32 v97, v95, v93, s34
    v_accvgpr_write_b32 a123, v97
    v_perm_b32 v96, v83, v81, s35
    v_accvgpr_write_b32 a124, v96
    v_perm_b32 v97, v87, v85, s35
    v_accvgpr_write_b32 a125, v97
    v_perm_b32 v96, v91, v89, s35
    v_accvgpr_write_b32 a126, v96
    v_perm_b32 v97, v95, v93, s35
    v_accvgpr_write_b32 a127, v97
    buffer_load_dwordx2 v[64:65], v4, s[4:7], s32 offen
    s_add_u32 s32, s32, 1280
    buffer_load_dwordx2 v[66:67], v4, s[4:7], s32 offen
    s_add_u32 s32, s32, 1280
    buffer_load_dwordx2 v[68:69], v4, s[4:7], s32 offen
    s_add_u32 s32, s32, 1280
    buffer_load_dwordx2 v[70:71], v4, s[4:7], s32 offen
    s_add_u32 s32, s32, 1280
    buffer_load_dwordx2 v[72:73], v4, s[4:7], s32 offen
    s_add_u32 s32, s32, 1280
    buffer_load_dwordx2 v[74:75], v4, s[4:7], s32 offen
    s_add_u32 s32, s32, 1280
    buffer_load_dwordx2 v[76:77], v4, s[4:7], s32 offen
    s_add_u32 s32, s32, 1280
    buffer_load_dwordx2 v[78:79], v4, s[4:7], s32 offen
    s_add_u32 s32, s32, 32000
    buffer_load_dwordx2 v[80:81], v4, s[4:7], s32 offen
    s_add_u32 s32, s32, 1280
    buffer_load_dwordx2 v[82:83], v4, s[4:7], s32 offen
    s_add_u32 s32, s32, 1280
    buffer_load_dwordx2 v[84:85], v4, s[4:7], s32 offen
    s_add_u32 s32, s32, 1280
    buffer_load_dwordx2 v[86:87], v4, s[4:7], s32 offen
    s_add_u32 s32, s32, 1280
    buffer_load_dwordx2 v[88:89], v4, s[4:7], s32 offen
    s_add_u32 s32, s32, 1280
    buffer_load_dwordx2 v[90:91], v4, s[4:7], s32 offen
    s_add_u32 s32, s32, 1280
    buffer_load_dwordx2 v[92:93], v4, s[4:7], s32 offen
    s_add_u32 s32, s32, 1280
    buffer_load_dwordx2 v[94:95], v4, s[4:7], s32 offen
    s_add_u32 s32, s32, 32000
    s_waitcnt vmcnt(16)
    v_perm_b32 v96, v34, v32, s34
    v_accvgpr_write_b32 a128, v96
    v_perm_b32 v97, v38, v36, s34
    v_accvgpr_write_b32 a129, v97
    v_perm_b32 v96, v42, v40, s34
    v_accvgpr_write_b32 a130, v96
    v_perm_b32 v97, v46, v44, s34
    v_accvgpr_write_b32 a131, v97
    v_perm_b32 v96, v34, v32, s35
    v_accvgpr_write_b32 a132, v96
    v_perm_b32 v97, v38, v36, s35
    v_accvgpr_write_b32 a133, v97
    v_perm_b32 v96, v42, v40, s35
    v_accvgpr_write_b32 a134, v96
    v_perm_b32 v97, v46, v44, s35
    v_accvgpr_write_b32 a135, v97
    v_perm_b32 v96, v35, v33, s34
    v_accvgpr_write_b32 a136, v96
    v_perm_b32 v97, v39, v37, s34
    v_accvgpr_write_b32 a137, v97
    v_perm_b32 v96, v43, v41, s34
    v_accvgpr_write_b32 a138, v96
    v_perm_b32 v97, v47, v45, s34
    v_accvgpr_write_b32 a139, v97
    v_perm_b32 v96, v35, v33, s35
    v_accvgpr_write_b32 a140, v96
    v_perm_b32 v97, v39, v37, s35
    v_accvgpr_write_b32 a141, v97
    v_perm_b32 v96, v43, v41, s35
    v_accvgpr_write_b32 a142, v96
    v_perm_b32 v97, v47, v45, s35
    v_accvgpr_write_b32 a143, v97
    v_perm_b32 v96, v50, v48, s34
    v_accvgpr_write_b32 a144, v96
    v_perm_b32 v97, v54, v52, s34
    v_accvgpr_write_b32 a145, v97
    v_perm_b32 v96, v58, v56, s34
    v_accvgpr_write_b32 a146, v96
    v_perm_b32 v97, v62, v60, s34
    v_accvgpr_write_b32 a147, v97
    v_perm_b32 v96, v50, v48, s35
    v_accvgpr_write_b32 a148, v96
    v_perm_b32 v97, v54, v52, s35
    v_accvgpr_write_b32 a149, v97
    v_perm_b32 v96, v58, v56, s35
    v_accvgpr_write_b32 a150, v96
    v_perm_b32 v97, v62, v60, s35
    v_accvgpr_write_b32 a151, v97
    v_perm_b32 v96, v51, v49, s34
    v_accvgpr_write_b32 a152, v96
    v_perm_b32 v97, v55, v53, s34
    v_accvgpr_write_b32 a153, v97
    v_perm_b32 v96, v59, v57, s34
    v_accvgpr_write_b32 a154, v96
    v_perm_b32 v97, v63, v61, s34
    v_accvgpr_write_b32 a155, v97
    v_perm_b32 v96, v51, v49, s35
    v_accvgpr_write_b32 a156, v96
    v_perm_b32 v97, v55, v53, s35
    v_accvgpr_write_b32 a157, v97
    v_perm_b32 v96, v59, v57, s35
    v_accvgpr_write_b32 a158, v96
    v_perm_b32 v97, v63, v61, s35
    v_accvgpr_write_b32 a159, v97
    buffer_load_dwordx2 v[32:33], v4, s[4:7], s32 offen
    s_add_u32 s32, s32, 1280
    buffer_load_dwordx2 v[34:35], v4, s[4:7], s32 offen
    s_add_u32 s32, s32, 1280
    buffer_load_dwordx2 v[36:37], v4, s[4:7], s32 offen
    s_add_u32 s32, s32, 1280
    buffer_load_dwordx2 v[38:39], v4, s[4:7], s32 offen
    s_add_u32 s32, s32, 1280
    buffer_load_dwordx2 v[40:41], v4, s[4:7], s32 offen
    s_add_u32 s32, s32, 1280
    buffer_load_dwordx2 v[42:43], v4, s[4:7], s32 offen
    s_add_u32 s32, s32, 1280
    buffer_load_dwordx2 v[44:45], v4, s[4:7], s32 offen
    s_add_u32 s32, s32, 1280
    buffer_load_dwordx2 v[46:47], v4, s[4:7], s32 offen
    s_add_u32 s32, s32, 32000
    buffer_load_dwordx2 v[48:49], v4, s[4:7], s32 offen
    s_add_u32 s32, s32, 1280
    buffer_load_dwordx2 v[50:51], v4, s[4:7], s32 offen
    s_add_u32 s32, s32, 1280
    buffer_load_dwordx2 v[52:53], v4, s[4:7], s32 offen
    s_add_u32 s32, s32, 1280
    buffer_load_dwordx2 v[54:55], v4, s[4:7], s32 offen
    s_add_u32 s32, s32, 1280
    buffer_load_dwordx2 v[56:57], v4, s[4:7], s32 offen
    s_add_u32 s32, s32, 1280
    buffer_load_dwordx2 v[58:59], v4, s[4:7], s32 offen
    s_add_u32 s32, s32, 1280
    buffer_load_dwordx2 v[60:61], v4, s[4:7], s32 offen
    s_add_u32 s32, s32, 1280
    buffer_load_dwordx2 v[62:63], v4, s[4:7], s32 offen
    s_add_u32 s32, s32, 32000
    s_waitcnt vmcnt(16)
    v_perm_b32 v96, v66, v64, s34
    v_accvgpr_write_b32 a160, v96
    v_perm_b32 v97, v70, v68, s34
    v_accvgpr_write_b32 a161, v97
    v_perm_b32 v96, v74, v72, s34
    v_accvgpr_write_b32 a162, v96
    v_perm_b32 v97, v78, v76, s34
    v_accvgpr_write_b32 a163, v97
    v_perm_b32 v96, v66, v64, s35
    v_accvgpr_write_b32 a164, v96
    v_perm_b32 v97, v70, v68, s35
    v_accvgpr_write_b32 a165, v97
    v_perm_b32 v96, v74, v72, s35
    v_accvgpr_write_b32 a166, v96
    v_perm_b32 v97, v78, v76, s35
    v_accvgpr_write_b32 a167, v97
    v_perm_b32 v96, v67, v65, s34
    v_accvgpr_write_b32 a168, v96
    v_perm_b32 v97, v71, v69, s34
    v_accvgpr_write_b32 a169, v97
    v_perm_b32 v96, v75, v73, s34
    v_accvgpr_write_b32 a170, v96
    v_perm_b32 v97, v79, v77, s34
    v_accvgpr_write_b32 a171, v97
    v_perm_b32 v96, v67, v65, s35
    v_accvgpr_write_b32 a172, v96
    v_perm_b32 v97, v71, v69, s35
    v_accvgpr_write_b32 a173, v97
    v_perm_b32 v96, v75, v73, s35
    v_accvgpr_write_b32 a174, v96
    v_perm_b32 v97, v79, v77, s35
    v_accvgpr_write_b32 a175, v97
    v_perm_b32 v96, v82, v80, s34
    v_accvgpr_write_b32 a176, v96
    v_perm_b32 v97, v86, v84, s34
    v_accvgpr_write_b32 a177, v97
    v_perm_b32 v96, v90, v88, s34
    v_accvgpr_write_b32 a178, v96
    v_perm_b32 v97, v94, v92, s34
    v_accvgpr_write_b32 a179, v97
    v_perm_b32 v96, v82, v80, s35
    v_accvgpr_write_b32 a180, v96
    v_perm_b32 v97, v86, v84, s35
    v_accvgpr_write_b32 a181, v97
    v_perm_b32 v96, v90, v88, s35
    v_accvgpr_write_b32 a182, v96
    v_perm_b32 v97, v94, v92, s35
    v_accvgpr_write_b32 a183, v97
    v_perm_b32 v96, v83, v81, s34
    v_accvgpr_write_b32 a184, v96
    v_perm_b32 v97, v87, v85, s34
    v_accvgpr_write_b32 a185, v97
    v_perm_b32 v96, v91, v89, s34
    v_accvgpr_write_b32 a186, v96
    v_perm_b32 v97, v95, v93, s34
    v_accvgpr_write_b32 a187, v97
    v_perm_b32 v96, v83, v81, s35
    v_accvgpr_write_b32 a188, v96
    v_perm_b32 v97, v87, v85, s35
    v_accvgpr_write_b32 a189, v97
    v_perm_b32 v96, v91, v89, s35
    v_accvgpr_write_b32 a190, v96
    v_perm_b32 v97, v95, v93, s35
    v_accvgpr_write_b32 a191, v97
    s_waitcnt vmcnt(0)
    v_perm_b32 v96, v34, v32, s34
    v_accvgpr_write_b32 a192, v96
    v_perm_b32 v97, v38, v36, s34
    v_accvgpr_write_b32 a193, v97
    v_perm_b32 v96, v42, v40, s34
    v_accvgpr_write_b32 a194, v96
    v_perm_b32 v97, v46, v44, s34
    v_accvgpr_write_b32 a195, v97
    v_perm_b32 v96, v34, v32, s35
    v_accvgpr_write_b32 a196, v96
    v_perm_b32 v97, v38, v36, s35
    v_accvgpr_write_b32 a197, v97
    v_perm_b32 v96, v42, v40, s35
    v_accvgpr_write_b32 a198, v96
    v_perm_b32 v97, v46, v44, s35
    v_accvgpr_write_b32 a199, v97
    v_perm_b32 v96, v35, v33, s34
    v_accvgpr_write_b32 a200, v96
    v_perm_b32 v97, v39, v37, s34
    v_accvgpr_write_b32 a201, v97
    v_perm_b32 v96, v43, v41, s34
    v_accvgpr_write_b32 a202, v96
    v_perm_b32 v97, v47, v45, s34
    v_accvgpr_write_b32 a203, v97
    v_perm_b32 v96, v35, v33, s35
    v_accvgpr_write_b32 a204, v96
    v_perm_b32 v97, v39, v37, s35
    v_accvgpr_write_b32 a205, v97
    v_perm_b32 v96, v43, v41, s35
    v_accvgpr_write_b32 a206, v96
    v_perm_b32 v97, v47, v45, s35
    v_accvgpr_write_b32 a207, v97
    v_perm_b32 v96, v50, v48, s34
    v_accvgpr_write_b32 a208, v96
    v_perm_b32 v97, v54, v52, s34
    v_accvgpr_write_b32 a209, v97
    v_perm_b32 v96, v58, v56, s34
    v_accvgpr_write_b32 a210, v96
    v_perm_b32 v97, v62, v60, s34
    v_accvgpr_write_b32 a211, v97
    v_perm_b32 v96, v50, v48, s35
    v_accvgpr_write_b32 a212, v96
    v_perm_b32 v97, v54, v52, s35
    v_accvgpr_write_b32 a213, v97
    v_perm_b32 v96, v58, v56, s35
    v_accvgpr_write_b32 a214, v96
    v_perm_b32 v97, v62, v60, s35
    v_accvgpr_write_b32 a215, v97
    v_perm_b32 v96, v51, v49, s34
    v_accvgpr_write_b32 a216, v96
    v_perm_b32 v97, v55, v53, s34
    v_accvgpr_write_b32 a217, v97
    v_perm_b32 v96, v59, v57, s34
    v_accvgpr_write_b32 a218, v96
    v_perm_b32 v97, v63, v61, s34
    v_accvgpr_write_b32 a219, v97
    v_perm_b32 v96, v51, v49, s35
    v_accvgpr_write_b32 a220, v96
    v_perm_b32 v97, v55, v53, s35
    v_accvgpr_write_b32 a221, v97
    v_perm_b32 v96, v59, v57, s35
    v_accvgpr_write_b32 a222, v96
    v_perm_b32 v97, v63, v61, s35
    v_accvgpr_write_b32 a223, v97
    v_lshlrev_b32 v5, 4, v1
    s_mul_i32 s25, s21, 55296
    s_lshl_b32 s26, s23, 10
    s_add_u32 s25, s25, s26
    s_add_u32 s25, s25, 88080384
    s_mov_b32 s27, s21
    s_mov_b32 s28, 0
    s_lshl_b32 s29, s22, 12
    v_lshlrev_b32 v6, 5, v3
    s_and_b32 s30, s22, 1
    s_lshl_b32 s30, s30, 4
    v_add_u32 v6, s30, v6
    v_add_u32 v6, s24, v6
    v_lshlrev_b32 v7, 1, v6
    s_mov_b32 s31, 12800
    buffer_load_dwordx4 v[8:11], v7, s[12:15], s31 offen sc1
    buffer_load_dwordx4 v[12:15], v7, s[12:15], s31 offen offset:16 sc1
    s_mov_b32 s31, 1280
    v_mul_lo_u32 v7, v2, s31
    v_add_u32 v6, v6, v7
L_mdn_loop:
    s_lshl_b32 s40, s27, 2
    s_lshl_b32 s41, s20, 9
    s_add_u32 s41, s41, s40
    s_add_u32 s41, s41, 116540416
    s_cmp_eq_u32 s22, 2
    s_cbranch_scc0 L_wgw_53
    s_mov_b32 s98, 0
    v_mov_b32 v250, 0
L_wait_54:
    buffer_load_dword v251, v250, s[12:15], s41 offen sc1
    s_waitcnt vmcnt(0)
    v_readfirstlane_b32 s99, v251
    s_cmp_ge_u32 s99, 14
    s_cbranch_scc1 L_ok_55
    s_sleep 1
    s_add_u32 s98, s98, 1
    s_cmp_lt_u32 s98, 1048576
    s_cbranch_scc1 L_wait_54
    s_branch L_mega_done
L_ok_55:
L_wgw_53:
    s_barrier
L_mdn_w3:
    s_mov_b32 s98, 0
L_mdn_ld:
    s_mul_i32 s38, s27, 20480
    s_add_u32 s39, s38, 79691776
    buffer_load_dwordx4 v[96:99], v6, s[12:15], s39 offen sc1
    s_mov_b32 s36, s25
    buffer_load_dwordx4 v[32:35], v5, s[12:15], s36 offen offset:0 sc1
    buffer_load_dwordx4 v[36:39], v5, s[12:15], s36 offen offset:1024 sc1
    buffer_load_dwordx4 v[40:43], v5, s[12:15], s36 offen offset:2048 sc1
    buffer_load_dwordx4 v[44:47], v5, s[12:15], s36 offen offset:3072 sc1
    s_add_u32 s36, s36, 4096
    buffer_load_dwordx4 v[48:51], v5, s[12:15], s36 offen offset:0 sc1
    buffer_load_dwordx4 v[52:55], v5, s[12:15], s36 offen offset:1024 sc1
    buffer_load_dwordx4 v[56:59], v5, s[12:15], s36 offen offset:2048 sc1
    buffer_load_dwordx4 v[60:63], v5, s[12:15], s36 offen offset:3072 sc1
    s_add_u32 s36, s36, 4096
    buffer_load_dwordx4 v[64:67], v5, s[12:15], s36 offen offset:0 sc1
    buffer_load_dwordx4 v[68:71], v5, s[12:15], s36 offen offset:1024 sc1
    buffer_load_dwordx4 v[72:75], v5, s[12:15], s36 offen offset:2048 sc1
    buffer_load_dwordx4 v[76:79], v5, s[12:15], s36 offen offset:3072 sc1
    s_add_u32 s36, s36, 4096
    buffer_load_dwordx4 v[80:83], v5, s[12:15], s36 offen offset:0 sc1
    s_cmp_ge_u32 s22, 2
    s_cbranch_scc1 L_mdn_short
    buffer_load_dwordx4 v[84:87], v5, s[12:15], s36 offen offset:1024 sc1
    s_waitcnt vmcnt(0)
    v_mfma_f32_16x16x32_bf16 v[16:19], a[208:211], v[84:87], 0
    v_mfma_f32_16x16x32_bf16 v[20:23], a[212:215], v[84:87], 0
    v_mfma_f32_16x16x32_bf16 v[24:27], a[216:219], v[84:87], 0
    v_mfma_f32_16x16x32_bf16 v[28:31], a[220:223], v[84:87], 0
    s_branch L_mdn_main
L_mdn_short:
    v_mov_b32 v16, 0
    v_mov_b32 v17, 0
    v_mov_b32 v18, 0
    v_mov_b32 v19, 0
    v_mov_b32 v20, 0
    v_mov_b32 v21, 0
    v_mov_b32 v22, 0
    v_mov_b32 v23, 0
    v_mov_b32 v24, 0
    v_mov_b32 v25, 0
    v_mov_b32 v26, 0
    v_mov_b32 v27, 0
    v_mov_b32 v28, 0
    v_mov_b32 v29, 0
    v_mov_b32 v30, 0
    v_mov_b32 v31, 0
    v_mov_b32 v84, 0
    s_waitcnt vmcnt(0)
L_mdn_main:
    v_mfma_f32_16x16x32_bf16 v[16:19], a[0:3], v[32:35], v[16:19]
    v_mfma_f32_16x16x32_bf16 v[20:23], a[4:7], v[32:35], v[20:23]
    v_mfma_f32_16x16x32_bf16 v[24:27], a[8:11], v[32:35], v[24:27]
    v_mfma_f32_16x16x32_bf16 v[28:31], a[12:15], v[32:35], v[28:31]
    v_mfma_f32_16x16x32_bf16 v[16:19], a[16:19], v[36:39], v[16:19]
    v_mfma_f32_16x16x32_bf16 v[20:23], a[20:23], v[36:39], v[20:23]
    v_mfma_f32_16x16x32_bf16 v[24:27], a[24:27], v[36:39], v[24:27]
    v_mfma_f32_16x16x32_bf16 v[28:31], a[28:31], v[36:39], v[28:31]
    v_mfma_f32_16x16x32_bf16 v[16:19], a[32:35], v[40:43], v[16:19]
    v_mfma_f32_16x16x32_bf16 v[20:23], a[36:39], v[40:43], v[20:23]
    v_mfma_f32_16x16x32_bf16 v[24:27], a[40:43], v[40:43], v[24:27]
    v_mfma_f32_16x16x32_bf16 v[28:31], a[44:47], v[40:43], v[28:31]
    v_mfma_f32_16x16x32_bf16 v[16:19], a[48:51], v[44:47], v[16:19]
    v_mfma_f32_16x16x32_bf16 v[20:23], a[52:55], v[44:47], v[20:23]
    v_mfma_f32_16x16x32_bf16 v[24:27], a[56:59], v[44:47], v[24:27]
    v_mfma_f32_16x16x32_bf16 v[28:31], a[60:63], v[44:47], v[28:31]
    v_mfma_f32_16x16x32_bf16 v[16:19], a[64:67], v[48:51], v[16:19]
    v_mfma_f32_16x16x32_bf16 v[20:23], a[68:71], v[48:51], v[20:23]
    v_mfma_f32_16x16x32_bf16 v[24:27], a[72:75], v[48:51], v[24:27]
    v_mfma_f32_16x16x32_bf16 v[28:31], a[76:79], v[48:51], v[28:31]
    v_mfma_f32_16x16x32_bf16 v[16:19], a[80:83], v[52:55], v[16:19]
    v_mfma_f32_16x16x32_bf16 v[20:23], a[84:87], v[52:55], v[20:23]
    v_mfma_f32_16x16x32_bf16 v[24:27], a[88:91], v[52:55], v[24:27]
    v_mfma_f32_16x16x32_bf16 v[28:31], a[92:95], v[52:55], v[28:31]
    v_mfma_f32_16x16x32_bf16 v[16:19], a[96:99], v[56:59], v[16:19]
    v_mfma_f32_16x16x32_bf16 v[20:23], a[100:103], v[56:59], v[20:23]
    v_mfma_f32_16x16x32_bf16 v[24:27], a[104:107], v[56:59], v[24:27]
    v_mfma_f32_16x16x32_bf16 v[28:31], a[108:111], v[56:59], v[28:31]
    v_mfma_f32_16x16x32_bf16 v[16:19], a[112:115], v[60:63], v[16:19]
    v_mfma_f32_16x16x32_bf16 v[20:23], a[116:119], v[60:63], v[20:23]
    v_mfma_f32_16x16x32_bf16 v[24:27], a[120:123], v[60:63], v[24:27]
    v_mfma_f32_16x16x32_bf16 v[28:31], a[124:127], v[60:63], v[28:31]
    v_mfma_f32_16x16x32_bf16 v[16:19], a[128:131], v[64:67], v[16:19]
    v_mfma_f32_16x16x32_bf16 v[20:23], a[132:135], v[64:67], v[20:23]
    v_mfma_f32_16x16x32_bf16 v[24:27], a[136:139], v[64:67], v[24:27]
    v_mfma_f32_16x16x32_bf16 v[28:31], a[140:143], v[64:67], v[28:31]
    v_mfma_f32_16x16x32_bf16 v[16:19], a[144:147], v[68:71], v[16:19]
    v_mfma_f32_16x16x32_bf16 v[20:23], a[148:151], v[68:71], v[20:23]
    v_mfma_f32_16x16x32_bf16 v[24:27], a[152:155], v[68:71], v[24:27]
    v_mfma_f32_16x16x32_bf16 v[28:31], a[156:159], v[68:71], v[28:31]
    v_mfma_f32_16x16x32_bf16 v[16:19], a[160:163], v[72:75], v[16:19]
    v_mfma_f32_16x16x32_bf16 v[20:23], a[164:167], v[72:75], v[20:23]
    v_mfma_f32_16x16x32_bf16 v[24:27], a[168:171], v[72:75], v[24:27]
    v_mfma_f32_16x16x32_bf16 v[28:31], a[172:175], v[72:75], v[28:31]
    v_mfma_f32_16x16x32_bf16 v[16:19], a[176:179], v[76:79], v[16:19]
    v_mfma_f32_16x16x32_bf16 v[20:23], a[180:183], v[76:79], v[20:23]
    v_mfma_f32_16x16x32_bf16 v[24:27], a[184:187], v[76:79], v[24:27]
    v_mfma_f32_16x16x32_bf16 v[28:31], a[188:191], v[76:79], v[28:31]
    v_mfma_f32_16x16x32_bf16 v[16:19], a[192:195], v[80:83], v[16:19]
    v_mfma_f32_16x16x32_bf16 v[20:23], a[196:199], v[80:83], v[20:23]
    v_mfma_f32_16x16x32_bf16 v[24:27], a[200:203], v[80:83], v[24:27]
    v_mfma_f32_16x16x32_bf16 v[28:31], a[204:207], v[80:83], v[28:31]
    s_add_u32 s31, s28, s29
    v_add_u32 v7, s31, v5
    ds_write_b128 v7, v[16:19] offset:0
    ds_write_b128 v7, v[20:23] offset:1024
    ds_write_b128 v7, v[24:27] offset:2048
    s_nop 2
    ds_write_b128 v7, v[28:31] offset:3072
    s_waitcnt lgkmcnt(0)
    s_barrier
    s_cmp_ge_u32 s22, 2
    s_cbranch_scc1 L_mdn_next
    s_lshl_b32 s33, s22, 3
    s_add_u32 s31, s28, s33
    v_add_u32 v7, s31, v5
    ds_read_b64 v[32:33], v7 offset:0
    ds_read_b64 v[34:35], v7 offset:1024
    ds_read_b64 v[36:37], v7 offset:2048
    ds_read_b64 v[38:39], v7 offset:3072
    ds_read_b64 v[40:41], v7 offset:4096
    ds_read_b64 v[42:43], v7 offset:5120
    ds_read_b64 v[44:45], v7 offset:6144
    ds_read_b64 v[46:47], v7 offset:7168
    ds_read_b64 v[48:49], v7 offset:8192
    ds_read_b64 v[50:51], v7 offset:9216
    ds_read_b64 v[52:53], v7 offset:10240
    ds_read_b64 v[54:55], v7 offset:11264
    ds_read_b64 v[56:57], v7 offset:12288
    ds_read_b64 v[58:59], v7 offset:13312
    ds_read_b64 v[60:61], v7 offset:14336
    ds_read_b64 v[62:63], v7 offset:15360
    s_waitcnt lgkmcnt(0)
    v_add_f32 v32, v32, v40
    v_add_f32 v33, v33, v41
    v_add_f32 v34, v34, v42
    v_add_f32 v35, v35, v43
    v_add_f32 v36, v36, v44
    v_add_f32 v37, v37, v45
    v_add_f32 v38, v38, v46
    v_add_f32 v39, v39, v47
    v_add_f32 v32, v32, v48
    v_add_f32 v33, v33, v49
    v_add_f32 v34, v34, v50
    v_add_f32 v35, v35, v51
    v_add_f32 v36, v36, v52
    v_add_f32 v37, v37, v53
    v_add_f32 v38, v38, v54
    v_add_f32 v39, v39, v55
    v_add_f32 v32, v32, v56
    v_add_f32 v33, v33, v57
    v_add_f32 v34, v34, v58
    v_add_f32 v35, v35, v59
    v_add_f32 v36, v36, v60
    v_add_f32 v37, v37, v61
    v_add_f32 v38, v38, v62
    v_add_f32 v39, v39, v63
    v_cvt_pk_bf16_f32 v64, v32, v34
    v_lshlrev_b32 v32, 16, v64
    v_and_b32 v34, 0xffff0000, v64
    v_mul_f32 v32, v32, v8
    v_mul_f32 v34, v34, v9
    v_cvt_pk_bf16_f32 v64, v32, v34
    v_lshlrev_b32 v32, 16, v64
    v_and_b32 v34, 0xffff0000, v64
    v_lshlrev_b32 v64, 16, v96
    v_and_b32 v65, 0xffff0000, v96
    v_add_f32 v32, v32, v64
    v_add_f32 v34, v34, v65
    v_cvt_pk_bf16_f32 v68, v32, v34
    v_cvt_pk_bf16_f32 v64, v36, v38
    v_lshlrev_b32 v36, 16, v64
    v_and_b32 v38, 0xffff0000, v64
    v_mul_f32 v36, v36, v10
    v_mul_f32 v38, v38, v11
    v_cvt_pk_bf16_f32 v64, v36, v38
    v_lshlrev_b32 v36, 16, v64
    v_and_b32 v38, 0xffff0000, v64
    v_lshlrev_b32 v64, 16, v97
    v_and_b32 v65, 0xffff0000, v97
    v_add_f32 v36, v36, v64
    v_add_f32 v38, v38, v65
    v_cvt_pk_bf16_f32 v69, v36, v38
    v_cvt_pk_bf16_f32 v64, v33, v35
    v_lshlrev_b32 v33, 16, v64
    v_and_b32 v35, 0xffff0000, v64
    v_mul_f32 v33, v33, v12
    v_mul_f32 v35, v35, v13
    v_cvt_pk_bf16_f32 v64, v33, v35
    v_lshlrev_b32 v33, 16, v64
    v_and_b32 v35, 0xffff0000, v64
    v_lshlrev_b32 v64, 16, v98
    v_and_b32 v65, 0xffff0000, v98
    v_add_f32 v33, v33, v64
    v_add_f32 v35, v35, v65
    v_cvt_pk_bf16_f32 v70, v33, v35
    v_cvt_pk_bf16_f32 v64, v37, v39
    v_lshlrev_b32 v37, 16, v64
    v_and_b32 v39, 0xffff0000, v64
    v_mul_f32 v37, v37, v14
    v_mul_f32 v39, v39, v15
    v_cvt_pk_bf16_f32 v64, v37, v39
    v_lshlrev_b32 v37, 16, v64
    v_and_b32 v39, 0xffff0000, v64
    v_lshlrev_b32 v64, 16, v99
    v_and_b32 v65, 0xffff0000, v99
    v_add_f32 v37, v37, v64
    v_add_f32 v39, v39, v65
    v_cvt_pk_bf16_f32 v71, v37, v39
    buffer_store_dwordx4 v[68:71], v6, s[16:19], s38 offen sc1
L_mdn_next:
    s_xor_b32 s28, s28, 16384
    s_add_u32 s25, s25, 165888
    s_add_u32 s27, s27, 3
    s_cmp_lt_u32 s27, 128
    s_cbranch_scc1 L_mdn_loop
    s_branch L_mega_done
L_mega_xa:
    s_sub_u32 s20, s2, 166
    s_cmp_ge_u32 s20, 24
    s_cbranch_scc1 L_mega_done
    s_mov_b32 s26, s20
    s_mov_b32 s75, 0
L_mx_loop:
    s_lshl_b32 s27, s26, 2
    s_add_u32 s27, s27, s25
    s_lshr_b32 s28, s27, 5
    s_and_b32 s29, s27, 31
    s_cmp_lt_u32 s28, s75
    s_cbranch_scc1 L_mx_hok
    s_lshr_b32 s30, s29, 1
    s_lshl_b32 s30, s30, 6
    s_add_u32 s30, s30, 116555776
    v_and_b32 v252, 3, v1
    v_lshrrev_b32 v250, 2, v1
    v_min_u32 v250, 2, v250
    v_lshlrev_b32 v250, 10, v250
    v_lshl_add_u32 v250, v252, 2, v250
    s_mov_b32 s98, 0
L_mx_hp:
    buffer_load_dword v251, v250, s[12:15], s30 offen sc1
    s_add_u32 s98, s98, 1
    s_cmp_ge_u32 s98, 1048576
    s_cbranch_scc1 L_mega_done
    s_waitcnt vmcnt(0)
    v_lshl_add_u32 v251, v251, 2, v252
    s_nop 1
    v_min_u32_dpp v251, v251, v251 row_ror:8 row_mask:0xf bank_mask:0xf
    s_nop 1
    v_min_u32_dpp v251, v251, v251 row_ror:4 row_mask:0xf bank_mask:0xf
    s_nop 1
    v_min_u32_dpp v251, v251, v251 row_ror:2 row_mask:0xf bank_mask:0xf
    s_nop 1
    v_min_u32_dpp v251, v251, v251 row_ror:1 row_mask:0xf bank_mask:0xf
    s_nop 0
    v_readfirstlane_b32 s75, v251
    s_cmp_lt_u32 s28, s75
    s_cbranch_scc1 L_mx_hok
    s_sleep 4
    s_branch L_mx_hp
L_mx_hok:
    v_lshlrev_b32 v4, 4, v1
    s_lshl_b32 s50, s27, 13
    s_add_u32 s51, s50, 4194304
    s_add_u32 s52, s50, 20971520
    s_add_u32 s53, s50, 37748736
    s_lshl_b32 s50, s27, 11
    s_add_u32 s54, s50, 112328704
    s_add_u32 s55, s50, 108134400
    v_and_b32 v5, 7, v2
    v_lshlrev_b32 v5, 4, v5
    v_lshl_add_u32 v5, v3, 7, v5
    v_and_b32 v6, 1, v3
    v_lshlrev_b32 v6, 7, v6
    v_lshl_add_u32 v6, v2, 3, v6
    buffer_load_dwordx4 v[16:19], v4, s[12:15], s51 offen offset:0 sc1
    buffer_load_dwordx4 v[48:51], v4, s[12:15], s52 offen offset:0 sc1
    buffer_load_dwordx4 v[20:23], v4, s[12:15], s51 offen offset:1024 sc1
    buffer_load_dwordx4 v[52:55], v4, s[12:15], s52 offen offset:1024 sc1
    buffer_load_dwordx4 v[24:27], v4, s[12:15], s51 offen offset:2048 sc1
    buffer_load_dwordx4 v[56:59], v4, s[12:15], s52 offen offset:2048 sc1
    buffer_load_dwordx4 v[28:31], v4, s[12:15], s51 offen offset:3072 sc1
    buffer_load_dwordx4 v[60:63], v4, s[12:15], s52 offen offset:3072 sc1
    s_add_u32 s51, s51, 4096
    s_add_u32 s52, s52, 4096
    buffer_load_dwordx4 v[32:35], v4, s[12:15], s51 offen offset:0 sc1
    buffer_load_dwordx4 v[64:67], v4, s[12:15], s52 offen offset:0 sc1
    buffer_load_dwordx4 v[36:39], v4, s[12:15], s51 offen offset:1024 sc1
    buffer_load_dwordx4 v[68:71], v4, s[12:15], s52 offen offset:1024 sc1
    buffer_load_dwordx4 v[40:43], v4, s[12:15], s51 offen offset:2048 sc1
    buffer_load_dwordx4 v[72:75], v4, s[12:15], s52 offen offset:2048 sc1
    buffer_load_dwordx4 v[44:47], v4, s[12:15], s51 offen offset:3072 sc1
    buffer_load_dwordx4 v[76:79], v4, s[12:15], s52 offen offset:3072 sc1
    buffer_load_dwordx4 v[96:99], v4, s[12:15], s53 offen offset:0 sc1
    buffer_load_dwordx4 v[100:103], v4, s[12:15], s53 offen offset:1024 sc1
    buffer_load_dwordx4 v[104:107], v4, s[12:15], s53 offen offset:2048 sc1
    buffer_load_dwordx4 v[108:111], v4, s[12:15], s53 offen offset:3072 sc1
    s_add_u32 s53, s53, 4096
    buffer_load_dwordx4 v[112:115], v4, s[12:15], s53 offen offset:0 sc1
    buffer_load_dwordx4 v[116:119], v4, s[12:15], s53 offen offset:1024 sc1
    buffer_load_dwordx4 v[120:123], v4, s[12:15], s53 offen offset:2048 sc1
    buffer_load_dwordx4 v[124:127], v4, s[12:15], s53 offen offset:3072 sc1
    s_mov_b32 s98, 0
L_xp_56:
    buffer_load_dwordx4 v[80:83], v5, s[12:15], s54 offen offset:0 sc1
    buffer_load_dwordx4 v[84:87], v5, s[12:15], s54 offen offset:512 sc1
    buffer_load_dwordx4 v[88:91], v5, s[12:15], s54 offen offset:1024 sc1
    buffer_load_dwordx4 v[92:95], v5, s[12:15], s54 offen offset:1536 sc1
    buffer_load_dwordx2 v[128:129], v6, s[12:15], s55 offen offset:0 sc1
    buffer_load_dwordx2 v[130:131], v6, s[12:15], s55 offen offset:256 sc1
    buffer_load_dwordx2 v[132:133], v6, s[12:15], s55 offen offset:512 sc1
    buffer_load_dwordx2 v[134:135], v6, s[12:15], s55 offen offset:768 sc1
    buffer_load_dwordx2 v[136:137], v6, s[12:15], s55 offen offset:1024 sc1
    buffer_load_dwordx2 v[138:139], v6, s[12:15], s55 offen offset:1280 sc1
    buffer_load_dwordx2 v[140:141], v6, s[12:15], s55 offen offset:1536 sc1
    buffer_load_dwordx2 v[142:143], v6, s[12:15], s55 offen offset:1792 sc1
    s_add_u32 s98, s98, 1
    s_cmp_ge_u32 s98, 1048576
    s_cbranch_scc1 L_mega_done
    s_waitcnt vmcnt(0)
    v_max3_u32 v7, v80, v81, v82
    v_max3_u32 v7, v7, v83, v84
    v_max3_u32 v7, v7, v85, v86
    v_max3_u32 v7, v7, v87, v88
    v_max3_u32 v7, v7, v89, v90
    v_max3_u32 v7, v7, v91, v92
    v_max3_u32 v7, v7, v93, v94
    v_max3_u32 v7, v7, v95, v128
    v_max3_u32 v7, v7, v129, v130
    v_max3_u32 v7, v7, v131, v132
    v_max3_u32 v7, v7, v133, v134
    v_max3_u32 v7, v7, v135, v136
    v_max3_u32 v7, v7, v137, v138
    v_max3_u32 v7, v7, v139, v140
    v_max3_u32 v7, v7, v141, v142
    v_max_u32 v7, v7, v143
    v_cmp_eq_u32 vcc, -1, v7
    s_cbranch_vccz L_xpok_57
    s_sleep 2
    s_branch L_xp_56
L_xpok_57:
    v_lshlrev_b32 v7, 2, v3
    v_add_u32 v8, 0, v7
    v_cmp_le_u32 s[56:57], v8, v2
    v_add_u32 v8, 1, v7
    v_cmp_le_u32 s[58:59], v8, v2
    v_add_u32 v8, 2, v7
    v_cmp_le_u32 s[60:61], v8, v2
    v_add_u32 v8, 3, v7
    v_cmp_le_u32 s[62:63], v8, v2
    v_cmp_gt_u32 s[64:65], 2, v3
    v_mov_b32 v9, 0xce6e6b28
    s_mov_b32 s66, 0x3db504f3
    s_mov_b32 s67, 0x3fb8aa3b
    s_waitcnt vmcnt(8)
    v_mfma_f32_16x16x32_bf16 v[144:147], v[80:83], v[16:19], 0
    v_mfma_f32_16x16x32_bf16 v[148:151], v[48:51], v[16:19], 0
    v_mfma_f32_16x16x32_bf16 v[152:155], v[80:83], v[32:35], 0
    v_mfma_f32_16x16x32_bf16 v[156:159], v[48:51], v[32:35], 0
    v_mfma_f32_16x16x32_bf16 v[160:163], v[64:67], v[32:35], 0
    v_mfma_f32_16x16x32_bf16 v[144:147], v[84:87], v[20:23], v[144:147]
    v_mfma_f32_16x16x32_bf16 v[148:151], v[52:55], v[20:23], v[148:151]
    v_mfma_f32_16x16x32_bf16 v[152:155], v[84:87], v[36:39], v[152:155]
    v_mfma_f32_16x16x32_bf16 v[156:159], v[52:55], v[36:39], v[156:159]
    v_mfma_f32_16x16x32_bf16 v[160:163], v[68:71], v[36:39], v[160:163]
    v_mfma_f32_16x16x32_bf16 v[144:147], v[88:91], v[24:27], v[144:147]
    v_mfma_f32_16x16x32_bf16 v[148:151], v[56:59], v[24:27], v[148:151]
    v_mfma_f32_16x16x32_bf16 v[152:155], v[88:91], v[40:43], v[152:155]
    v_mfma_f32_16x16x32_bf16 v[156:159], v[56:59], v[40:43], v[156:159]
    v_mfma_f32_16x16x32_bf16 v[160:163], v[72:75], v[40:43], v[160:163]
    v_mfma_f32_16x16x32_bf16 v[144:147], v[92:95], v[28:31], v[144:147]
    v_mfma_f32_16x16x32_bf16 v[148:151], v[60:63], v[28:31], v[148:151]
    v_mfma_f32_16x16x32_bf16 v[152:155], v[92:95], v[44:47], v[152:155]
    v_mfma_f32_16x16x32_bf16 v[156:159], v[60:63], v[44:47], v[156:159]
    v_mfma_f32_16x16x32_bf16 v[160:163], v[76:79], v[44:47], v[160:163]
    v_cvt_pk_bf16_f32 v8, v144, v145
    v_lshlrev_b32 v144, 16, v8
    v_and_b32 v145, 0xffff0000, v8
    v_mul_f32 v144, s66, v144
    v_mul_f32 v145, s66, v145
    v_cvt_pk_bf16_f32 v8, v144, v145
    v_lshlrev_b32 v144, 16, v8
    v_and_b32 v145, 0xffff0000, v8
    v_cvt_pk_bf16_f32 v8, v146, v147
    v_lshlrev_b32 v146, 16, v8
    v_and_b32 v147, 0xffff0000, v8
    v_mul_f32 v146, s66, v146
    v_mul_f32 v147, s66, v147
    v_cvt_pk_bf16_f32 v8, v146, v147
    v_lshlrev_b32 v146, 16, v8
    v_and_b32 v147, 0xffff0000, v8
    v_cvt_pk_bf16_f32 v8, v148, v149
    v_lshlrev_b32 v148, 16, v8
    v_and_b32 v149, 0xffff0000, v8
    v_mul_f32 v148, s66, v148
    v_mul_f32 v149, s66, v149
    v_cvt_pk_bf16_f32 v8, v148, v149
    v_lshlrev_b32 v148, 16, v8
    v_and_b32 v149, 0xffff0000, v8
    v_cvt_pk_bf16_f32 v8, v150, v151
    v_lshlrev_b32 v150, 16, v8
    v_and_b32 v151, 0xffff0000, v8
    v_mul_f32 v150, s66, v150
    v_mul_f32 v151, s66, v151
    v_cvt_pk_bf16_f32 v8, v150, v151
    v_lshlrev_b32 v150, 16, v8
    v_and_b32 v151, 0xffff0000, v8
    v_cvt_pk_bf16_f32 v8, v152, v153
    v_lshlrev_b32 v152, 16, v8
    v_and_b32 v153, 0xffff0000, v8
    v_mul_f32 v152, s66, v152
    v_mul_f32 v153, s66, v153
    v_cvt_pk_bf16_f32 v8, v152, v153
    v_lshlrev_b32 v152, 16, v8
    v_and_b32 v153, 0xffff0000, v8
    v_cvt_pk_bf16_f32 v8, v154, v155
    v_lshlrev_b32 v154, 16, v8
    v_and_b32 v155, 0xffff0000, v8
    v_mul_f32 v154, s66, v154
    v_mul_f32 v155, s66, v155
    v_cvt_pk_bf16_f32 v8, v154, v155
    v_lshlrev_b32 v154, 16, v8
    v_and_b32 v155, 0xffff0000, v8
    v_cvt_pk_bf16_f32 v8, v156, v157
    v_lshlrev_b32 v156, 16, v8
    v_and_b32 v157, 0xffff0000, v8
    v_mul_f32 v156, s66, v156
    v_mul_f32 v157, s66, v157
    v_cvt_pk_bf16_f32 v8, v156, v157
    v_lshlrev_b32 v156, 16, v8
    v_and_b32 v157, 0xffff0000, v8
    v_cvt_pk_bf16_f32 v8, v158, v159
    v_lshlrev_b32 v158, 16, v8
    v_and_b32 v159, 0xffff0000, v8
    v_mul_f32 v158, s66, v158
    v_mul_f32 v159, s66, v159
    v_cvt_pk_bf16_f32 v8, v158, v159
    v_lshlrev_b32 v158, 16, v8
    v_and_b32 v159, 0xffff0000, v8
    v_cvt_pk_bf16_f32 v8, v160, v161
    v_lshlrev_b32 v160, 16, v8
    v_and_b32 v161, 0xffff0000, v8
    v_mul_f32 v160, s66, v160
    v_mul_f32 v161, s66, v161
    v_cvt_pk_bf16_f32 v8, v160, v161
    v_lshlrev_b32 v160, 16, v8
    v_and_b32 v161, 0xffff0000, v8
    v_cvt_pk_bf16_f32 v8, v162, v163
    v_lshlrev_b32 v162, 16, v8
    v_and_b32 v163, 0xffff0000, v8
    v_mul_f32 v162, s66, v162
    v_mul_f32 v163, s66, v163
    v_cvt_pk_bf16_f32 v8, v162, v163
    v_lshlrev_b32 v162, 16, v8
    v_and_b32 v163, 0xffff0000, v8
    v_cndmask_b32 v144, v9, v144, s[64:65]
    v_cndmask_b32 v145, v9, v145, s[64:65]
    v_cndmask_b32 v146, v9, v146, s[64:65]
    v_cndmask_b32 v147, v9, v147, s[64:65]
    v_cndmask_b32 v148, v9, v148, s[56:57]
    v_cndmask_b32 v149, v9, v149, s[58:59]
    v_cndmask_b32 v150, v9, v150, s[60:61]
    v_cndmask_b32 v151, v9, v151, s[62:63]
    v_cndmask_b32 v152, v9, v152, s[64:65]
    v_cndmask_b32 v153, v9, v153, s[64:65]
    v_cndmask_b32 v154, v9, v154, s[64:65]
    v_cndmask_b32 v155, v9, v155, s[64:65]
    v_cndmask_b32 v160, v9, v160, s[56:57]
    v_cndmask_b32 v161, v9, v161, s[58:59]
    v_cndmask_b32 v162, v9, v162, s[60:61]
    v_cndmask_b32 v163, v9, v163, s[62:63]
    v_max3_f32 v12, v144, v145, v146
    v_max3_f32 v12, v12, v147, v148
    v_max3_f32 v12, v12, v149, v150
    v_max_f32 v12, v12, v151
    v_mov_b32 v13, v12
    s_nop 1
    v_permlane32_swap_b32 v12, v13
    v_max_f32 v12, v12, v13
    v_mov_b32 v13, v12
    s_nop 1
    v_permlane16_swap_b32 v12, v13
    v_max_f32 v12, v12, v13
    v_sub_f32 v144, v144, v12
    v_mul_f32 v144, s67, v144
    v_exp_f32 v144, v144
    v_sub_f32 v145, v145, v12
    v_mul_f32 v145, s67, v145
    v_exp_f32 v145, v145
    v_sub_f32 v146, v146, v12
    v_mul_f32 v146, s67, v146
    v_exp_f32 v146, v146
    v_sub_f32 v147, v147, v12
    v_mul_f32 v147, s67, v147
    v_exp_f32 v147, v147
    v_sub_f32 v148, v148, v12
    v_mul_f32 v148, s67, v148
    v_exp_f32 v148, v148
    v_sub_f32 v149, v149, v12
    v_mul_f32 v149, s67, v149
    v_exp_f32 v149, v149
    v_sub_f32 v150, v150, v12
    v_mul_f32 v150, s67, v150
    v_exp_f32 v150, v150
    v_sub_f32 v151, v151, v12
    v_mul_f32 v151, s67, v151
    v_exp_f32 v151, v151
    v_add_f32 v12, v144, v145
    v_add_f32 v12, v12, v146
    v_add_f32 v12, v12, v147
    v_add_f32 v12, v12, v148
    v_add_f32 v12, v12, v149
    v_add_f32 v12, v12, v150
    v_add_f32 v12, v12, v151
    v_mov_b32 v13, v12
    s_nop 1
    v_permlane32_swap_b32 v12, v13
    v_add_f32 v12, v12, v13
    v_mov_b32 v13, v12
    s_nop 1
    v_permlane16_swap_b32 v12, v13
    v_add_f32 v12, v12, v13
    v_rcp_f32 v12, v12
    s_nop 0
    v_mul_f32 v144, v144, v12
    v_mul_f32 v145, v145, v12
    v_mul_f32 v146, v146, v12
    v_mul_f32 v147, v147, v12
    v_mul_f32 v148, v148, v12
    v_mul_f32 v149, v149, v12
    v_mul_f32 v150, v150, v12
    v_mul_f32 v151, v151, v12
    v_cvt_pk_bf16_f32 v164, v144, v145
    v_cvt_pk_bf16_f32 v165, v146, v147
    v_cvt_pk_bf16_f32 v168, v148, v149
    v_cvt_pk_bf16_f32 v169, v150, v151
    v_mov_b32 v170, 0
    v_mov_b32 v171, 0
    v_max3_f32 v12, v152, v153, v154
    v_max3_f32 v12, v12, v155, v156
    v_max3_f32 v12, v12, v157, v158
    v_max3_f32 v12, v12, v159, v160
    v_max3_f32 v12, v12, v161, v162
    v_max_f32 v12, v12, v163
    v_mov_b32 v13, v12
    s_nop 1
    v_permlane32_swap_b32 v12, v13
    v_max_f32 v12, v12, v13
    v_mov_b32 v13, v12
    s_nop 1
    v_permlane16_swap_b32 v12, v13
    v_max_f32 v12, v12, v13
    v_sub_f32 v152, v152, v12
    v_mul_f32 v152, s67, v152
    v_exp_f32 v152, v152
    v_sub_f32 v153, v153, v12
    v_mul_f32 v153, s67, v153
    v_exp_f32 v153, v153
    v_sub_f32 v154, v154, v12
    v_mul_f32 v154, s67, v154
    v_exp_f32 v154, v154
    v_sub_f32 v155, v155, v12
    v_mul_f32 v155, s67, v155
    v_exp_f32 v155, v155
    v_sub_f32 v156, v156, v12
    v_mul_f32 v156, s67, v156
    v_exp_f32 v156, v156
    v_sub_f32 v157, v157, v12
    v_mul_f32 v157, s67, v157
    v_exp_f32 v157, v157
    v_sub_f32 v158, v158, v12
    v_mul_f32 v158, s67, v158
    v_exp_f32 v158, v158
    v_sub_f32 v159, v159, v12
    v_mul_f32 v159, s67, v159
    v_exp_f32 v159, v159
    v_sub_f32 v160, v160, v12
    v_mul_f32 v160, s67, v160
    v_exp_f32 v160, v160
    v_sub_f32 v161, v161, v12
    v_mul_f32 v161, s67, v161
    v_exp_f32 v161, v161
    v_sub_f32 v162, v162, v12
    v_mul_f32 v162, s67, v162
    v_exp_f32 v162, v162
    v_sub_f32 v163, v163, v12
    v_mul_f32 v163, s67, v163
    v_exp_f32 v163, v163
    v_add_f32 v12, v152, v153
    v_add_f32 v12, v12, v154
    v_add_f32 v12, v12, v155
    v_add_f32 v12, v12, v156
    v_add_f32 v12, v12, v157
    v_add_f32 v12, v12, v158
    v_add_f32 v12, v12, v159
    v_add_f32 v12, v12, v160
    v_add_f32 v12, v12, v161
    v_add_f32 v12, v12, v162
    v_add_f32 v12, v12, v163
    v_mov_b32 v13, v12
    s_nop 1
    v_permlane32_swap_b32 v12, v13
    v_add_f32 v12, v12, v13
    v_mov_b32 v13, v12
    s_nop 1
    v_permlane16_swap_b32 v12, v13
    v_add_f32 v12, v12, v13
    v_rcp_f32 v12, v12
    s_nop 0
    v_mul_f32 v152, v152, v12
    v_mul_f32 v153, v153, v12
    v_mul_f32 v154, v154, v12
    v_mul_f32 v155, v155, v12
    v_mul_f32 v156, v156, v12
    v_mul_f32 v157, v157, v12
    v_mul_f32 v158, v158, v12
    v_mul_f32 v159, v159, v12
    v_mul_f32 v160, v160, v12
    v_mul_f32 v161, v161, v12
    v_mul_f32 v162, v162, v12
    v_mul_f32 v163, v163, v12
    v_cvt_pk_bf16_f32 v166, v152, v153
    v_cvt_pk_bf16_f32 v167, v154, v155
    v_cvt_pk_bf16_f32 v8, v156, v157
    v_cvt_pk_bf16_f32 v9, v158, v159
    v_cvt_pk_bf16_f32 v10, v160, v161
    v_cvt_pk_bf16_f32 v11, v162, v163
    s_waitcnt vmcnt(0)
    v_mfma_f32_16x16x32_bf16 v[16:19], v[96:99], v[168:171], 0
    v_mfma_f32_16x16x32_bf16 v[20:23], v[100:103], v[168:171], 0
    v_mfma_f32_16x16x32_bf16 v[24:27], v[104:107], v[168:171], 0
    v_mfma_f32_16x16x32_bf16 v[28:31], v[108:111], v[168:171], 0
    v_mfma_f32_16x16x32_bf16 v[32:35], v[112:115], v[168:171], 0
    v_mfma_f32_16x16x32_bf16 v[36:39], v[116:119], v[168:171], 0
    v_mfma_f32_16x16x32_bf16 v[40:43], v[120:123], v[168:171], 0
    v_mfma_f32_16x16x32_bf16 v[44:47], v[124:127], v[168:171], 0
    v_mfma_f32_16x16x32_bf16 v[48:51], v[96:99], v[8:11], 0
    v_mfma_f32_16x16x32_bf16 v[52:55], v[100:103], v[8:11], 0
    v_mfma_f32_16x16x32_bf16 v[56:59], v[104:107], v[8:11], 0
    v_mfma_f32_16x16x32_bf16 v[60:63], v[108:111], v[8:11], 0
    v_mfma_f32_16x16x32_bf16 v[64:67], v[112:115], v[8:11], 0
    v_mfma_f32_16x16x32_bf16 v[68:71], v[116:119], v[8:11], 0
    v_mfma_f32_16x16x32_bf16 v[72:75], v[120:123], v[8:11], 0
    v_mfma_f32_16x16x32_bf16 v[76:79], v[124:127], v[8:11], 0
    v_mfma_f32_16x16x16_bf16 v[16:19], v[128:129], v[164:165], v[16:19]
    v_mfma_f32_16x16x16_bf16 v[20:23], v[130:131], v[164:165], v[20:23]
    v_mfma_f32_16x16x16_bf16 v[24:27], v[132:133], v[164:165], v[24:27]
    v_mfma_f32_16x16x16_bf16 v[28:31], v[134:135], v[164:165], v[28:31]
    v_mfma_f32_16x16x16_bf16 v[32:35], v[136:137], v[164:165], v[32:35]
    v_mfma_f32_16x16x16_bf16 v[36:39], v[138:139], v[164:165], v[36:39]
    v_mfma_f32_16x16x16_bf16 v[40:43], v[140:141], v[164:165], v[40:43]
    v_mfma_f32_16x16x16_bf16 v[44:47], v[142:143], v[164:165], v[44:47]
    v_mfma_f32_16x16x16_bf16 v[48:51], v[128:129], v[166:167], v[48:51]
    v_mfma_f32_16x16x16_bf16 v[52:55], v[130:131], v[166:167], v[52:55]
    v_mfma_f32_16x16x16_bf16 v[56:59], v[132:133], v[166:167], v[56:59]
    v_mfma_f32_16x16x16_bf16 v[60:63], v[134:135], v[166:167], v[60:63]
    v_mfma_f32_16x16x16_bf16 v[64:67], v[136:137], v[166:167], v[64:67]
    v_mfma_f32_16x16x16_bf16 v[68:71], v[138:139], v[166:167], v[68:71]
    v_mfma_f32_16x16x16_bf16 v[72:75], v[140:141], v[166:167], v[72:75]
    v_mfma_f32_16x16x16_bf16 v[76:79], v[142:143], v[166:167], v[76:79]
    v_lshrrev_b32 v12, 1, v3
    v_lshlrev_b32 v12, 8, v12
    v_lshl_add_u32 v12, v2, 4, v12
    v_and_b32 v13, 1, v3
    v_lshl_add_u32 v12, v13, 3, v12
    s_lshr_b32 s50, s27, 5
    s_lshl_b32 s50, s50, 18
    s_and_b32 s51, s27, 31
    s_lshl_b32 s51, s51, 12
    s_add_u32 s50, s50, s51
    s_add_u32 s50, s50, 62914560
    v_cvt_pk_bf16_f32 v80, v16, v17
    v_cvt_pk_bf16_f32 v81, v18, v19
    buffer_store_dwordx2 v[80:81], v12, s[12:15], s50 offen offset:0 sc1
    v_cvt_pk_bf16_f32 v82, v20, v21
    v_cvt_pk_bf16_f32 v83, v22, v23
    buffer_store_dwordx2 v[82:83], v12, s[12:15], s50 offen offset:512 sc1
    v_cvt_pk_bf16_f32 v84, v24, v25
    v_cvt_pk_bf16_f32 v85, v26, v27
    buffer_store_dwordx2 v[84:85], v12, s[12:15], s50 offen offset:1024 sc1
    v_cvt_pk_bf16_f32 v86, v28, v29
    v_cvt_pk_bf16_f32 v87, v30, v31
    buffer_store_dwordx2 v[86:87], v12, s[12:15], s50 offen offset:1536 sc1
    v_cvt_pk_bf16_f32 v88, v32, v33
    v_cvt_pk_bf16_f32 v89, v34, v35
    buffer_store_dwordx2 v[88:89], v12, s[12:15], s50 offen offset:2048 sc1
    v_cvt_pk_bf16_f32 v90, v36, v37
    v_cvt_pk_bf16_f32 v91, v38, v39
    buffer_store_dwordx2 v[90:91], v12, s[12:15], s50 offen offset:2560 sc1
    v_cvt_pk_bf16_f32 v92, v40, v41
    v_cvt_pk_bf16_f32 v93, v42, v43
    buffer_store_dwordx2 v[92:93], v12, s[12:15], s50 offen offset:3072 sc1
    v_cvt_pk_bf16_f32 v94, v44, v45
    v_cvt_pk_bf16_f32 v95, v46, v47
    buffer_store_dwordx2 v[94:95], v12, s[12:15], s50 offen offset:3584 sc1
    s_add_u32 s50, s50, 131072
    v_cvt_pk_bf16_f32 v96, v48, v49
    v_cvt_pk_bf16_f32 v97, v50, v51
    buffer_store_dwordx2 v[96:97], v12, s[12:15], s50 offen offset:0 sc1
    v_cvt_pk_bf16_f32 v98, v52, v53
    v_cvt_pk_bf16_f32 v99, v54, v55
    buffer_store_dwordx2 v[98:99], v12, s[12:15], s50 offen offset:512 sc1
    v_cvt_pk_bf16_f32 v100, v56, v57
    v_cvt_pk_bf16_f32 v101, v58, v59
    buffer_store_dwordx2 v[100:101], v12, s[12:15], s50 offen offset:1024 sc1
    v_cvt_pk_bf16_f32 v102, v60, v61
    v_cvt_pk_bf16_f32 v103, v62, v63
    buffer_store_dwordx2 v[102:103], v12, s[12:15], s50 offen offset:1536 sc1
    v_cvt_pk_bf16_f32 v104, v64, v65
    v_cvt_pk_bf16_f32 v105, v66, v67
    buffer_store_dwordx2 v[104:105], v12, s[12:15], s50 offen offset:2048 sc1
    v_cvt_pk_bf16_f32 v106, v68, v69
    v_cvt_pk_bf16_f32 v107, v70, v71
    buffer_store_dwordx2 v[106:107], v12, s[12:15], s50 offen offset:2560 sc1
    v_cvt_pk_bf16_f32 v108, v72, v73
    v_cvt_pk_bf16_f32 v109, v74, v75
    buffer_store_dwordx2 v[108:109], v12, s[12:15], s50 offen offset:3072 sc1
    v_cvt_pk_bf16_f32 v110, v76, v77
    v_cvt_pk_bf16_f32 v111, v78, v79
    buffer_store_dwordx2 v[110:111], v12, s[12:15], s50 offen offset:3584 sc1
    s_lshl_b32 s28, s28, 3
    s_add_u32 s28, s28, 116523008
    s_waitcnt vmcnt(0)
    s_barrier
    s_cmp_eq_u32 s25, 0
    s_cbranch_scc0 L_wgs_58
    v_subrev_u32 v250, 20, v1
    v_lshl_add_u32 v250, v250, 9, 4
    v_lshlrev_b32 v251, 9, v1
    v_cmp_gt_u32 vcc, 20, v1
    s_nop 1
    v_cndmask_b32 v250, v250, v251, vcc
    v_mov_b32 v251, 1
    s_mov_b32 exec_lo, 4294967295
    s_mov_b32 exec_hi, 255
    buffer_atomic_add v251, v250, s[12:15], s28 offen sc1
    s_mov_b64 exec, -1
L_wgs_58:
    s_add_u32 s26, s26, 24
    s_cmp_lt_u32 s26, 512
    s_cbranch_scc1 L_mx_loop
    s_branch L_mega_done
L_mega_done:
L_mega_exit:
    s_endpgm
.section .rodata,"a"
.p2align 6
.amdhsa_kernel mega_kernel
  .amdhsa_next_free_vgpr 512
  .amdhsa_next_free_sgpr 102
  .amdhsa_accum_offset 256
  .amdhsa_group_segment_fixed_size 0
  .amdhsa_kernarg_size 128
  .amdhsa_user_sgpr_count 2
  .amdhsa_user_sgpr_kernarg_segment_ptr 1
  .amdhsa_system_sgpr_workgroup_id_x 1
.end_amdhsa_kernel
```
